```python
import torch

def _softmax(x, axis=-1):
    return torch.softmax(x, dim=axis)
def _gelu(x):
    return torch.nn.functional.gelu(x, approximate="tanh")
def _silu(x):
    return torch.nn.functional.silu(x)
def _sigmoid(x):
    return torch.sigmoid(x)
def _layernorm(x, axis=-1, eps=1e-5):
    m = x.mean(dim=axis, keepdim=True)
    v = x.var(dim=axis, keepdim=True, unbiased=False)
    return (x - m) / torch.sqrt(v + eps)
def _scatter_add(tgt, idx, src, axis=0):
    return tgt.clone().index_add_(axis, idx, src)
def _segment_sum(src, seg, n):
    out = torch.zeros((n,) + src.shape[1:], dtype=src.dtype)
    return out.index_add_(0, seg, src)
def _pad(x, pw):
    flat = tuple(v for pair in reversed(pw) for v in pair)
    return torch.nn.functional.pad(x, flat)

kernel_name = 'sequential_preLN__grouped_kv_mqa__dense_activation_squared_relu__prompt'

def setup_inputs():

    _w = (lambda a: (lambda t: t.to(torch.bfloat16) if t.is_floating_point() else t)(torch.as_tensor(a)))
    def _A_setup():
        B, S, D, H = 1, 2048, 512, 32
        Dh = D // H
        return {
            "x": _w((lambda *s: torch.randn(*s, dtype=torch.bfloat16) * 0.05)(B, S, D)),
            "wq": _w((lambda *s: torch.randn(*s, dtype=torch.bfloat16) * 0.05)(D, H * Dh)),
            "wk": _w((lambda *s: torch.randn(*s, dtype=torch.bfloat16) * 0.05)(D, Dh)),
            "wv": _w((lambda *s: torch.randn(*s, dtype=torch.bfloat16) * 0.05)(D, Dh)),
            "wo": _w((lambda *s: torch.randn(*s, dtype=torch.bfloat16) * 0.05)(H * Dh, D)),
        }
    _A_in = _A_setup()

    def _B_setup():
        B, S, D, F = 1, 2048, 512, 1376
        return {
            "x": _w((lambda *s: torch.randn(*s, dtype=torch.bfloat16) * 0.05)(B, S, D)),
            "w1": _w((lambda *s: torch.randn(*s, dtype=torch.bfloat16) * 0.05)(D, F)),
            "b1": _w((lambda *s: torch.randn(*s, dtype=torch.bfloat16) * 0.4)(F)),
            "w2": _w((lambda *s: torch.randn(*s, dtype=torch.bfloat16) * 0.05)(F, D)),
            "b2": _w((lambda *s: torch.randn(*s, dtype=torch.bfloat16) * 1.6)(D)),
        }
    _B_in = _B_setup()

    return {
        "A_x": _A_in["x"],
        "A_wq": _A_in["wq"],
        "A_wk": _A_in["wk"],
        "A_wv": _A_in["wv"],
        "A_wo": _A_in["wo"],
        "B_x": _B_in["x"],
        "B_w1": _B_in["w1"],
        "B_b1": _B_in["b1"],
        "B_w2": _B_in["w2"],
        "B_b2": _B_in["b2"],
    }

def reference(A_x, A_wq, A_wk, A_wv, A_wo, B_x, B_w1, B_b1, B_w2, B_b2):
    def _A_ref(x, wq, wk, wv, wo):
        B, S, D = x.shape
        H = 32
        Dh = D // H
        q = (lambda x, *d: x.permute(*d))((x @ wq).reshape(B, S, H, Dh), 0, 2, 1, 3)
        k = x @ wk
        v = x @ wv
        scores = torch.einsum("bhqd,bkd->bhqk", q, k) * (Dh ** -0.5)
        p = _softmax(scores, axis=-1)
        o = torch.einsum("bhqk,bkd->bhqd", p, v)
        return (lambda x, *d: x.permute(*d))(o, 0, 2, 1, 3).reshape(B, S, H * Dh) @ wo

    def _B_ref(x, w1, b1, w2, b2):
        h = torch.einsum("bsd,df->bsf", x, w1) + b1
        zero = torch.zeros_like(h)
        r = torch.where(h > zero, h, zero)
        h = r * r
        out = torch.einsum("bsf,fd->bsd", h, w2) + b2
        return out

    x = A_x
    h = x + _A_ref(_layernorm(x, axis=-1), A_wq, A_wk, A_wv, A_wo)
    h2 = h + _B_ref(_layernorm(h, axis=-1), B_w1, B_b1, B_w2, B_b2)
    return h2
```

```asm
; @launch grid=(256,1,1) block=(512,1,1) lds=163840
.amdgcn_target "amdgcn-amd-amdhsa--gfx950"
.text
.globl sequential_preLN__grouped_kv_mqa__dense_activation_squared_relu__prompt_kernel
.p2align 8
.type sequential_preLN__grouped_kv_mqa__dense_activation_squared_relu__prompt_kernel,@function
sequential_preLN__grouped_kv_mqa__dense_activation_squared_relu__prompt_kernel:
.set CODE_KB, (L_codeend - sequential_preLN__grouped_kv_mqa__dense_activation_squared_relu__prompt_kernel) / 1024
    s_cmp_ge_u32 s2, 256
    s_cbranch_scc1 L_end
    s_load_dwordx16 s[4:19], s[0:1], 0
    s_load_dwordx8 s[20:27], s[0:1], 64
    s_load_dwordx2 s[28:29], s[0:1], 96
    v_and_b32 v1, 63, v0
    v_lshrrev_b32 v22, 6, v0
    s_lshr_b32 s81, s2, 3
    v_readfirstlane_b32 s66, v22
    s_and_b32 s65, s81, 7
    s_and_b32 s64, s2, 7
    s_lshl_b32 s64, s64, 2
    s_lshr_b32 s70, s81, 3
    s_add_u32 s64, s64, s70
    v_lshlrev_b32 v4, 4, v1
    s_lshr_b32 s91, s66, 2
    s_and_b32 s77, s66, 3
    v_lshrrev_b32 v22, 5, v1
    s_lshl_b32 s70, s77, 1
    v_add_u32 v22, s70, v22
    v_and_b32 v23, 31, v1
    v_lshlrev_b32 v24, 4, v23
    v_lshl_add_u32 v200, v22, 10, v24
    s_lshr_b32 s70, s65, 1
    s_lshl_b32 s71, s64, 16
    s_lshl_b32 s89, s91, 1
    s_add_u32 s89, s89, s70
    v_mov_b32 v25, 0
    v_mov_b32 v26, 147456
    ds_write_b32 v26, v25
    s_waitcnt lgkmcnt(0)
    s_mov_b32 s32, s4
    s_mov_b32 s33, s5
    s_mov_b32 s34, 2097152
    s_mov_b32 s35, 0x20000
    s_mov_b32 s56, s28
    s_mov_b32 s57, s29
    s_mov_b32 s58, 33554432
    s_mov_b32 s59, 0x20000
    s_lshl_b32 s69, s66, 10
    s_cmp_ge_u32 s66, 4
    s_cbranch_scc1 L_hiw
    s_add_u32 s72, s89, 0
    s_and_b32 s72, s72, 3
    s_lshl_b32 s72, s72, 14
    s_add_u32 s72, s72, s71
    buffer_load_dwordx4 v[32:35], v200, s[32:35], s72 offen
    buffer_load_dwordx4 v[36:39], v200, s[32:35], s72 offen offset:512
    s_add_u32 s72, s89, 0
    s_and_b32 s72, s72, 3
    s_lshl_b32 s72, s72, 14
    s_add_u32 s72, s72, s71
    s_add_u32 s72, s72, 8192
    buffer_load_dwordx4 v[40:43], v200, s[32:35], s72 offen
    buffer_load_dwordx4 v[44:47], v200, s[32:35], s72 offen offset:512
    s_bitcmp1_b32 s65, 0
    s_cselect_b32 s40, s10, s8
    s_cselect_b32 s41, s11, s9
    s_mov_b32 s42, 16384
    s_mov_b32 s43, 0x20000
    s_add_u32 m0, s69, 131072
    s_add_u32 s75, s69, 0
    buffer_load_dwordx4 v4, s[40:43], s75 offen lds
    s_add_u32 m0, s69, 135168
    s_add_u32 s75, s69, 4096
    buffer_load_dwordx4 v4, s[40:43], s75 offen lds
    s_add_u32 m0, s69, 139264
    s_add_u32 s75, s69, 8192
    buffer_load_dwordx4 v4, s[40:43], s75 offen lds
    s_add_u32 m0, s69, 143360
    s_add_u32 s75, s69, 12288
    buffer_load_dwordx4 v4, s[40:43], s75 offen lds
L_hiw:
    buffer_load_dword v202, v25, s[56:59], 0 offen sc1
    s_barrier
    s_mov_b32 s36, s6
    s_mov_b32 s37, s7
    s_mov_b32 s38, 524288
    s_mov_b32 s39, 0x20000
    s_mov_b32 s82, 0x3f803f80
    s_getreg_b32 s95, hwreg(HW_REG_XCC_ID)
    s_and_b32 s95, s95, 15
    v_lshrrev_b32 v26, 2, v1
    v_and_b32 v27, 3, v1
    v_lshlrev_b32 v27, 4, v27
    v_lshl_add_u32 v2, v26, 10, v27
    v_mul_u32_u24 v3, 2752, v26
    v_add_u32 v3, v3, v27
    s_cmp_ge_u32 s66, 4
    s_cbranch_scc1 L_hiw2
    v_and_b32 v24, 7, v1
    v_xor_b32 v24, v22, v24
    v_lshlrev_b32 v24, 4, v24
    v_lshl_add_u32 v24, v22, 7, v24
    v_bfe_u32 v25, v1, 3, 2
    v_lshl_add_u32 v244, v25, 10, v24
    s_lshl_b32 s72, s70, 14
    v_add_u32 v244, s72, v244
    v_xor_b32 v246, 128, v244
    v_lshrrev_b32 v239, 4, v1
    v_bfe_u32 v23, v1, 2, 2
    v_lshl_add_u32 v23, v239, 3, v23
    v_and_b32 v24, 3, v1
    v_lshlrev_b32 v24, 3, v24
    v_lshl_add_u32 v236, v23, 5, v24
    v_add_u32 v236, 131072, v236
    v_and_b32 v23, 7, v1
    v_bfe_u32 v24, v1, 3, 1
    v_xor_b32 v25, v23, v24
    v_lshlrev_b32 v25, 7, v25
    v_lshl_add_u32 v25, v24, 13, v25
    v_add_u32 v25, s72, v25
    v_xor_b32 v23, v23, v239
    v_lshl_add_u32 v237, v23, 4, v25
    v_xor_b32 v238, 64, v237
    v_lshrrev_b32 v25, 1, v239
    v_lshlrev_b32 v25, 3, v25
    v_and_b32 v26, 1, v239
    v_and_b32 v23, 1, v1
    v_bfe_u32 v24, v1, 1, 1
    v_lshl_add_u32 v23, v24, 3, v23
    v_bfe_u32 v24, v1, 2, 2
    v_lshl_add_u32 v23, v24, 1, v23
    v_lshl_add_u32 v241, v23, 4, v25
    v_lshl_add_u32 v241, v26, 9, v241
    s_lshl_b32 s73, s64, 1
    s_lshr_b32 s74, s70, 1
    s_add_u32 s73, s73, s74
    s_mul_i32 s68, s73, 2048
    s_add_u32 s68, s68, 65536
    s_and_b32 s74, s70, 1
    s_lshl_b32 s74, s74, 8
    s_add_u32 s68, s68, s74
    s_bitcmp1_b32 s65, 0
    s_cbranch_scc0 L_1
    v_and_b32 v23, 15, v1
    v_lshl_add_u32 v241, v23, 4, v25
    v_lshl_add_u32 v241, v26, 8, v241
    s_add_u32 s68, s68, s74
    s_add_u32 s68, s68, 1024
L_1:
    s_and_b32 s78, s66, 1
    s_lshr_b32 s72, s66, 1
    s_and_b32 s76, s72, 1
    s_lshr_b32 s79, s66, 2
    v_and_b32 v22, 7, v1
    v_bfe_u32 v23, v1, 3, 2
    v_and_b32 v24, 1, v23
    v_xor_b32 v24, v24, v22
    v_lshlrev_b32 v24, 7, v24
    v_lshl_add_u32 v24, v23, 13, v24
    s_lshl_b32 s72, s76, 15
    s_lshl_b32 s73, s78, 12
    s_add_u32 s72, s72, s73
    v_add_u32 v24, s72, v24
    v_lshrrev_b32 v23, 5, v1
    v_xor_b32 v22, v22, v23
    v_lshl_add_u32 v248, v22, 4, v24
    v_xor_b32 v249, 32, v248
    v_xor_b32 v250, 64, v248
    v_xor_b32 v251, 96, v248
    s_mov_b32 s44, s12
    s_mov_b32 s45, s13
    s_mov_b32 s46, 524288
    s_mov_b32 s47, 0x20000
    s_mov_b32 s48, s16
    s_mov_b32 s49, s17
    s_mov_b32 s50, 1409024
    s_mov_b32 s51, 0x20000
    s_mov_b32 s52, s20
    s_mov_b32 s53, s21
    s_mov_b32 s54, 1409024
    s_mov_b32 s55, 0x20000
    s_mov_b32 s60, s24
    s_mov_b32 s61, s25
    s_mov_b32 s62, 2097152
    s_mov_b32 s63, 0x20000
    s_mul_i32 s89, s65, 346431
    s_lshr_b32 s89, s89, 16
    s_lshr_b32 s72, s66, 1
    s_add_u32 s72, s72, 2
    s_cmp_lt_u32 s66, 4
    s_cselect_b32 s80, s66, s72
    v_bfe_u32 v26, v1, 2, 2
    v_lshrrev_b32 v23, 5, v1
    v_bfe_u32 v24, v1, 4, 1
    v_lshlrev_b32 v24, 5, v24
    v_and_b32 v25, 3, v1
    v_lshl_add_u32 v24, v25, 3, v24
    v_lshl_add_u32 v25, v23, 2, v26
    v_lshl_add_u32 v5, v25, 6, v24
    v_lshl_add_u32 v25, v23, 3, v26
    v_lshl_add_u32 v252, v25, 6, v24
    s_lshl_b32 s72, s79, 15
    s_lshl_b32 s73, s78, 14
    s_add_u32 s72, s72, s73
    s_add_u32 s72, s72, 65536
    v_add_u32 v252, s72, v252
    v_mov_b32 v23, 0x4444
    v_mov_b32 v24, 0xeeee
    v_mov_b32 v25, s82
    v_and_b32 v26, 16, v1
    v_cmp_eq_u32 vcc, 0, v26
    v_and_b32 v26, 1, v1
    s_nop 0
    v_cndmask_b32 v10, v24, v23, vcc
    v_cmp_eq_u32 vcc, 0, v26
    v_and_b32 v26, 6, v1
    s_nop 0
    v_cndmask_b32 v11, v24, v23, vcc
    v_cmp_eq_u32 vcc, 0, v26
    s_nop 1
    v_cndmask_b32 v6, 0, v25, vcc
    v_cndmask_b32 v7, 0, v25, vcc
    v_cmp_eq_u32 vcc, 4, v26
    s_nop 1
    v_cndmask_b32 v8, 0, v25, vcc
    v_cndmask_b32 v9, 0, v25, vcc
    v_mov_b32 v216, 0
    v_mov_b32 v217, 0
    v_mov_b32 v218, 0
    v_mov_b32 v219, 0
    s_lshl_b32 s72, s66, 7
    s_add_u32 s72, s72, 152576
    v_and_b32 v220, 31, v1
    v_lshlrev_b32 v220, 2, v220
    v_add_u32 v220, s72, v220
    v_lshrrev_b32 v221, 5, v1
    v_lshlrev_b32 v221, 4, v221
    v_add_u32 v221, s72, v221
    v_and_b32 v222, 31, v1
    v_lshlrev_b32 v222, 3, v222
    s_lshl_b32 s72, s76, 10
    s_add_u32 s72, s72, 148480
    v_add_u32 v222, s72, v222
    s_lshl_b32 s72, s79, 9
    s_lshl_b32 s73, s78, 8
    s_add_u32 s72, s72, s73
    v_add_u32 v223, s72, v222
    v_mov_b32 v208, 0
    v_mov_b32 v209, 0
    v_mov_b32 v212, 0
    v_mov_b32 v213, 0
    s_waitcnt vmcnt(7)
    v_dot2c_f32_bf16 v208, s82, v32
    v_dot2c_f32_bf16 v209, v32, v32
    v_dot2c_f32_bf16 v208, s82, v33
    v_dot2c_f32_bf16 v209, v33, v33
    v_dot2c_f32_bf16 v208, s82, v34
    v_dot2c_f32_bf16 v209, v34, v34
    v_dot2c_f32_bf16 v208, s82, v35
    v_dot2c_f32_bf16 v209, v35, v35
    v_dot2c_f32_bf16 v208, s82, v36
    v_dot2c_f32_bf16 v209, v36, v36
    v_dot2c_f32_bf16 v208, s82, v37
    v_dot2c_f32_bf16 v209, v37, v37
    v_dot2c_f32_bf16 v208, s82, v38
    v_dot2c_f32_bf16 v209, v38, v38
    v_dot2c_f32_bf16 v208, s82, v39
    v_dot2c_f32_bf16 v209, v39, v39
    s_waitcnt vmcnt(5)
    v_dot2c_f32_bf16 v212, s82, v40
    v_dot2c_f32_bf16 v213, v40, v40
    v_dot2c_f32_bf16 v212, s82, v41
    v_dot2c_f32_bf16 v213, v41, v41
    v_dot2c_f32_bf16 v212, s82, v42
    v_dot2c_f32_bf16 v213, v42, v42
    v_dot2c_f32_bf16 v212, s82, v43
    v_dot2c_f32_bf16 v213, v43, v43
    v_dot2c_f32_bf16 v212, s82, v44
    v_dot2c_f32_bf16 v213, v44, v44
    v_dot2c_f32_bf16 v212, s82, v45
    v_dot2c_f32_bf16 v213, v45, v45
    v_dot2c_f32_bf16 v212, s82, v46
    v_dot2c_f32_bf16 v213, v46, v46
    v_dot2c_f32_bf16 v212, s82, v47
    v_dot2c_f32_bf16 v213, v47, v47
    s_nop 1
    v_add_f32_dpp v208, v208, v208 row_ror:8 row_mask:0xf bank_mask:0xf
    v_add_f32_dpp v209, v209, v209 row_ror:8 row_mask:0xf bank_mask:0xf
    v_add_f32_dpp v212, v212, v212 row_ror:8 row_mask:0xf bank_mask:0xf
    v_add_f32_dpp v213, v213, v213 row_ror:8 row_mask:0xf bank_mask:0xf
    v_add_f32_dpp v208, v208, v208 row_ror:4 row_mask:0xf bank_mask:0xf
    v_add_f32_dpp v209, v209, v209 row_ror:4 row_mask:0xf bank_mask:0xf
    v_add_f32_dpp v212, v212, v212 row_ror:4 row_mask:0xf bank_mask:0xf
    v_add_f32_dpp v213, v213, v213 row_ror:4 row_mask:0xf bank_mask:0xf
    v_add_f32_dpp v208, v208, v208 row_ror:2 row_mask:0xf bank_mask:0xf
    v_add_f32_dpp v209, v209, v209 row_ror:2 row_mask:0xf bank_mask:0xf
    v_add_f32_dpp v212, v212, v212 row_ror:2 row_mask:0xf bank_mask:0xf
    v_add_f32_dpp v213, v213, v213 row_ror:2 row_mask:0xf bank_mask:0xf
    v_add_f32_dpp v208, v208, v208 row_ror:1 row_mask:0xf bank_mask:0xf
    v_add_f32_dpp v209, v209, v209 row_ror:1 row_mask:0xf bank_mask:0xf
    v_add_f32_dpp v212, v212, v212 row_ror:1 row_mask:0xf bank_mask:0xf
    v_add_f32_dpp v213, v213, v213 row_ror:1 row_mask:0xf bank_mask:0xf
    v_mov_b32 v210, v208
    v_mov_b32 v211, v209
    v_mov_b32 v214, v212
    v_mov_b32 v215, v213
    s_nop 0
    v_permlane16_swap_b32 v208, v210
    v_permlane16_swap_b32 v209, v211
    v_permlane16_swap_b32 v212, v214
    v_permlane16_swap_b32 v213, v215
    v_add_f32 v208, v208, v210
    v_add_f32 v209, v209, v211
    v_mul_f32 v211, 0xbb000000, v208
    v_mul_f32 v209, 0x3b000000, v209
    v_fma_f32 v209, -v211, v211, v209
    v_max_f32 v209, 0, v209
    v_add_f32 v209, 0x3727c5ac, v209
    v_rsq_f32 v210, v209
    s_nop 0
    v_mul_f32 v211, v211, v210
    v_add_f32 v212, v212, v214
    v_add_f32 v213, v213, v215
    v_mul_f32 v215, 0xbb000000, v212
    v_mul_f32 v213, 0x3b000000, v213
    v_fma_f32 v213, -v215, v215, v213
    v_max_f32 v213, 0, v213
    v_add_f32 v213, 0x3727c5ac, v213
    v_rsq_f32 v214, v213
    s_nop 0
    v_mul_f32 v215, v215, v214
    v_lshlrev_b32 v224, 16, v32
    v_and_b32 v225, 0xffff0000, v32
    v_pk_fma_f32 v[224:225], v[224:225], v[210:211], v[210:211] op_sel:[0,0,1] op_sel_hi:[1,0,1]
    v_cvt_pk_bf16_f32 v32, v224, v225
    v_lshlrev_b32 v226, 16, v33
    v_and_b32 v227, 0xffff0000, v33
    v_pk_fma_f32 v[226:227], v[226:227], v[210:211], v[210:211] op_sel:[0,0,1] op_sel_hi:[1,0,1]
    v_cvt_pk_bf16_f32 v33, v226, v227
    v_lshlrev_b32 v224, 16, v34
    v_and_b32 v225, 0xffff0000, v34
    v_pk_fma_f32 v[224:225], v[224:225], v[210:211], v[210:211] op_sel:[0,0,1] op_sel_hi:[1,0,1]
    v_cvt_pk_bf16_f32 v34, v224, v225
    v_lshlrev_b32 v226, 16, v35
    v_and_b32 v227, 0xffff0000, v35
    v_pk_fma_f32 v[226:227], v[226:227], v[210:211], v[210:211] op_sel:[0,0,1] op_sel_hi:[1,0,1]
    v_cvt_pk_bf16_f32 v35, v226, v227
    ds_write_b128 v244, v[32:35] offset:0
    v_lshlrev_b32 v224, 16, v36
    v_and_b32 v225, 0xffff0000, v36
    v_pk_fma_f32 v[224:225], v[224:225], v[210:211], v[210:211] op_sel:[0,0,1] op_sel_hi:[1,0,1]
    v_cvt_pk_bf16_f32 v36, v224, v225
    v_lshlrev_b32 v226, 16, v37
    v_and_b32 v227, 0xffff0000, v37
    v_pk_fma_f32 v[226:227], v[226:227], v[210:211], v[210:211] op_sel:[0,0,1] op_sel_hi:[1,0,1]
    v_cvt_pk_bf16_f32 v37, v226, v227
    v_lshlrev_b32 v224, 16, v38
    v_and_b32 v225, 0xffff0000, v38
    v_pk_fma_f32 v[224:225], v[224:225], v[210:211], v[210:211] op_sel:[0,0,1] op_sel_hi:[1,0,1]
    v_cvt_pk_bf16_f32 v38, v224, v225
    v_lshlrev_b32 v226, 16, v39
    v_and_b32 v227, 0xffff0000, v39
    v_pk_fma_f32 v[226:227], v[226:227], v[210:211], v[210:211] op_sel:[0,0,1] op_sel_hi:[1,0,1]
    v_cvt_pk_bf16_f32 v39, v226, v227
    ds_write_b128 v244, v[36:39] offset:4096
    v_lshlrev_b32 v224, 16, v40
    v_and_b32 v225, 0xffff0000, v40
    v_pk_fma_f32 v[224:225], v[224:225], v[214:215], v[214:215] op_sel:[0,0,1] op_sel_hi:[1,0,1]
    v_cvt_pk_bf16_f32 v40, v224, v225
    v_lshlrev_b32 v226, 16, v41
    v_and_b32 v227, 0xffff0000, v41
    v_pk_fma_f32 v[226:227], v[226:227], v[214:215], v[214:215] op_sel:[0,0,1] op_sel_hi:[1,0,1]
    v_cvt_pk_bf16_f32 v41, v226, v227
    v_lshlrev_b32 v224, 16, v42
    v_and_b32 v225, 0xffff0000, v42
    v_pk_fma_f32 v[224:225], v[224:225], v[214:215], v[214:215] op_sel:[0,0,1] op_sel_hi:[1,0,1]
    v_cvt_pk_bf16_f32 v42, v224, v225
    v_lshlrev_b32 v226, 16, v43
    v_and_b32 v227, 0xffff0000, v43
    v_pk_fma_f32 v[226:227], v[226:227], v[214:215], v[214:215] op_sel:[0,0,1] op_sel_hi:[1,0,1]
    v_cvt_pk_bf16_f32 v43, v226, v227
    ds_write_b128 v246, v[40:43] offset:8192
    v_lshlrev_b32 v224, 16, v44
    v_and_b32 v225, 0xffff0000, v44
    v_pk_fma_f32 v[224:225], v[224:225], v[214:215], v[214:215] op_sel:[0,0,1] op_sel_hi:[1,0,1]
    v_cvt_pk_bf16_f32 v44, v224, v225
    v_lshlrev_b32 v226, 16, v45
    v_and_b32 v227, 0xffff0000, v45
    v_pk_fma_f32 v[226:227], v[226:227], v[214:215], v[214:215] op_sel:[0,0,1] op_sel_hi:[1,0,1]
    v_cvt_pk_bf16_f32 v45, v226, v227
    v_lshlrev_b32 v224, 16, v46
    v_and_b32 v225, 0xffff0000, v46
    v_pk_fma_f32 v[224:225], v[224:225], v[214:215], v[214:215] op_sel:[0,0,1] op_sel_hi:[1,0,1]
    v_cvt_pk_bf16_f32 v46, v224, v225
    v_lshlrev_b32 v226, 16, v47
    v_and_b32 v227, 0xffff0000, v47
    v_pk_fma_f32 v[226:227], v[226:227], v[214:215], v[214:215] op_sel:[0,0,1] op_sel_hi:[1,0,1]
    v_cvt_pk_bf16_f32 v47, v226, v227
    ds_write_b128 v246, v[44:47] offset:12288
    v_mov_b32 v26, 147456
    v_mov_b32 v27, 1
    s_waitcnt vmcnt(0)
    s_waitcnt lgkmcnt(0)
    s_mov_b64 exec, 1
    ds_add_u32 v26, v27
    s_mov_b64 exec, -1
    s_cmp_lg_u32 s66, 0
    s_cbranch_scc1 L_lnjoin
    s_setprio 3
L_sync:
    ds_read_b32 v27, v26
    s_waitcnt lgkmcnt(0)
    v_cmp_ne_u32 vcc, 4, v27
    s_cbranch_vccnz L_sync
    ds_read_b64_tr_b16 v[64:65], v236 offset:0
    ds_read_b64_tr_b16 v[66:67], v236 offset:128
    ds_read_b128 v[68:71], v237 offset:0
    ds_read_b64_tr_b16 v[72:73], v236 offset:1024
    ds_read_b64_tr_b16 v[74:75], v236 offset:1152
    ds_read_b128 v[76:79], v238 offset:0
    ds_read_b64_tr_b16 v[80:81], v236 offset:2048
    ds_read_b64_tr_b16 v[82:83], v236 offset:2176
    ds_read_b128 v[84:87], v237 offset:1024
    ds_read_b64_tr_b16 v[88:89], v236 offset:3072
    ds_read_b64_tr_b16 v[90:91], v236 offset:3200
    ds_read_b128 v[92:95], v238 offset:1024
    ds_read_b64_tr_b16 v[96:97], v236 offset:4096
    ds_read_b64_tr_b16 v[98:99], v236 offset:4224
    ds_read_b128 v[100:103], v237 offset:2048
    s_bitcmp1_b32 s65, 0
    s_cbranch_scc1 L_isv_2
    s_waitcnt lgkmcnt(12)
    v_mfma_f32_16x16x32_bf16 v[228:231], v[64:67], v[68:71], 0
    ds_read_b64_tr_b16 v[104:105], v236 offset:5120
    ds_read_b64_tr_b16 v[106:107], v236 offset:5248
    ds_read_b128 v[108:111], v238 offset:2048
    s_waitcnt lgkmcnt(12)
    v_mfma_f32_16x16x32_bf16 v[228:231], v[72:75], v[76:79], v[228:231]
    ds_read_b64_tr_b16 v[112:113], v236 offset:6144
    ds_read_b64_tr_b16 v[114:115], v236 offset:6272
    ds_read_b128 v[116:119], v237 offset:3072
    s_waitcnt lgkmcnt(12)
    v_mfma_f32_16x16x32_bf16 v[228:231], v[80:83], v[84:87], v[228:231]
    ds_read_b64_tr_b16 v[120:121], v236 offset:7168
    ds_read_b64_tr_b16 v[122:123], v236 offset:7296
    ds_read_b128 v[124:127], v238 offset:3072
    s_waitcnt lgkmcnt(12)
    v_mfma_f32_16x16x32_bf16 v[228:231], v[88:91], v[92:95], v[228:231]
    ds_read_b64_tr_b16 v[128:129], v236 offset:8192
    ds_read_b64_tr_b16 v[130:131], v236 offset:8320
    ds_read_b128 v[132:135], v237 offset:4096
    s_waitcnt lgkmcnt(12)
    v_mfma_f32_16x16x32_bf16 v[228:231], v[96:99], v[100:103], v[228:231]
    ds_read_b64_tr_b16 v[136:137], v236 offset:9216
    ds_read_b64_tr_b16 v[138:139], v236 offset:9344
    ds_read_b128 v[140:143], v238 offset:4096
    s_waitcnt lgkmcnt(12)
    v_mfma_f32_16x16x32_bf16 v[228:231], v[104:107], v[108:111], v[228:231]
    ds_read_b64_tr_b16 v[144:145], v236 offset:10240
    ds_read_b64_tr_b16 v[146:147], v236 offset:10368
    ds_read_b128 v[148:151], v237 offset:5120
    s_waitcnt lgkmcnt(12)
    v_mfma_f32_16x16x32_bf16 v[228:231], v[112:115], v[116:119], v[228:231]
    ds_read_b64_tr_b16 v[152:153], v236 offset:11264
    ds_read_b64_tr_b16 v[154:155], v236 offset:11392
    ds_read_b128 v[156:159], v238 offset:5120
    s_waitcnt lgkmcnt(12)
    v_mfma_f32_16x16x32_bf16 v[228:231], v[120:123], v[124:127], v[228:231]
    ds_read_b64_tr_b16 v[160:161], v236 offset:12288
    ds_read_b64_tr_b16 v[162:163], v236 offset:12416
    ds_read_b128 v[164:167], v237 offset:6144
    s_waitcnt lgkmcnt(12)
    v_mfma_f32_16x16x32_bf16 v[228:231], v[128:131], v[132:135], v[228:231]
    ds_read_b64_tr_b16 v[168:169], v236 offset:13312
    ds_read_b64_tr_b16 v[170:171], v236 offset:13440
    ds_read_b128 v[172:175], v238 offset:6144
    s_waitcnt lgkmcnt(12)
    v_mfma_f32_16x16x32_bf16 v[228:231], v[136:139], v[140:143], v[228:231]
    ds_read_b64_tr_b16 v[176:177], v236 offset:14336
    ds_read_b64_tr_b16 v[178:179], v236 offset:14464
    ds_read_b128 v[180:183], v237 offset:7168
    s_waitcnt lgkmcnt(12)
    v_mfma_f32_16x16x32_bf16 v[228:231], v[144:147], v[148:151], v[228:231]
    ds_read_b64_tr_b16 v[184:185], v236 offset:15360
    ds_read_b64_tr_b16 v[186:187], v236 offset:15488
    ds_read_b128 v[188:191], v238 offset:7168
    s_waitcnt lgkmcnt(12)
    v_mfma_f32_16x16x32_bf16 v[228:231], v[152:155], v[156:159], v[228:231]
    s_waitcnt lgkmcnt(9)
    v_mfma_f32_16x16x32_bf16 v[228:231], v[160:163], v[164:167], v[228:231]
    s_waitcnt lgkmcnt(6)
    v_mfma_f32_16x16x32_bf16 v[228:231], v[168:171], v[172:175], v[228:231]
    s_waitcnt lgkmcnt(3)
    v_mfma_f32_16x16x32_bf16 v[228:231], v[176:179], v[180:183], v[228:231]
    s_waitcnt lgkmcnt(0)
    v_mfma_f32_16x16x32_bf16 v[228:231], v[184:187], v[188:191], v[228:231]
    s_nop 7
    v_cvt_pk_bf16_f32 v28, v228, v229
    v_cvt_pk_bf16_f32 v29, v230, v231
    buffer_store_dwordx2 v[28:29], v241, s[56:59], s68 offen sc1
    v_mul_f32 v228, v228, v228
    v_fmac_f32 v228, v229, v229
    v_fmac_f32 v228, v230, v230
    v_fmac_f32 v228, v231, v231
    v_mov_b32 v229, v228
    s_nop 1
    v_permlane16_swap_b32 v228, v229
    v_add_f32 v228, v228, v229
    v_mov_b32 v229, v228
    s_nop 1
    v_permlane32_swap_b32 v228, v229
    v_add_f32 v229, v228, v229
    s_nop 1
    v_max_u32_dpp v229, v229, v229 row_ror:8 row_mask:0xf bank_mask:0xf
    s_nop 1
    v_max_u32_dpp v229, v229, v229 row_ror:4 row_mask:0xf bank_mask:0xf
    s_nop 1
    v_max_u32_dpp v229, v229, v229 row_ror:2 row_mask:0xf bank_mask:0xf
    s_nop 1
    v_max_u32_dpp v229, v229, v229 row_ror:1 row_mask:0xf bank_mask:0xf
    s_branch L_kvst_3
L_isv_2:
    s_waitcnt lgkmcnt(12)
    v_mfma_f32_16x16x32_bf16 v[228:231], v[68:71], v[64:67], 0
    ds_read_b64_tr_b16 v[104:105], v236 offset:5120
    ds_read_b64_tr_b16 v[106:107], v236 offset:5248
    ds_read_b128 v[108:111], v238 offset:2048
    s_waitcnt lgkmcnt(12)
    v_mfma_f32_16x16x32_bf16 v[228:231], v[76:79], v[72:75], v[228:231]
    ds_read_b64_tr_b16 v[112:113], v236 offset:6144
    ds_read_b64_tr_b16 v[114:115], v236 offset:6272
    ds_read_b128 v[116:119], v237 offset:3072
    s_waitcnt lgkmcnt(12)
    v_mfma_f32_16x16x32_bf16 v[228:231], v[84:87], v[80:83], v[228:231]
    ds_read_b64_tr_b16 v[120:121], v236 offset:7168
    ds_read_b64_tr_b16 v[122:123], v236 offset:7296
    ds_read_b128 v[124:127], v238 offset:3072
    s_waitcnt lgkmcnt(12)
    v_mfma_f32_16x16x32_bf16 v[228:231], v[92:95], v[88:91], v[228:231]
    ds_read_b64_tr_b16 v[128:129], v236 offset:8192
    ds_read_b64_tr_b16 v[130:131], v236 offset:8320
    ds_read_b128 v[132:135], v237 offset:4096
    s_waitcnt lgkmcnt(12)
    v_mfma_f32_16x16x32_bf16 v[228:231], v[100:103], v[96:99], v[228:231]
    ds_read_b64_tr_b16 v[136:137], v236 offset:9216
    ds_read_b64_tr_b16 v[138:139], v236 offset:9344
    ds_read_b128 v[140:143], v238 offset:4096
    s_waitcnt lgkmcnt(12)
    v_mfma_f32_16x16x32_bf16 v[228:231], v[108:111], v[104:107], v[228:231]
    ds_read_b64_tr_b16 v[144:145], v236 offset:10240
    ds_read_b64_tr_b16 v[146:147], v236 offset:10368
    ds_read_b128 v[148:151], v237 offset:5120
    s_waitcnt lgkmcnt(12)
    v_mfma_f32_16x16x32_bf16 v[228:231], v[116:119], v[112:115], v[228:231]
    ds_read_b64_tr_b16 v[152:153], v236 offset:11264
    ds_read_b64_tr_b16 v[154:155], v236 offset:11392
    ds_read_b128 v[156:159], v238 offset:5120
    s_waitcnt lgkmcnt(12)
    v_mfma_f32_16x16x32_bf16 v[228:231], v[124:127], v[120:123], v[228:231]
    ds_read_b64_tr_b16 v[160:161], v236 offset:12288
    ds_read_b64_tr_b16 v[162:163], v236 offset:12416
    ds_read_b128 v[164:167], v237 offset:6144
    s_waitcnt lgkmcnt(12)
    v_mfma_f32_16x16x32_bf16 v[228:231], v[132:135], v[128:131], v[228:231]
    ds_read_b64_tr_b16 v[168:169], v236 offset:13312
    ds_read_b64_tr_b16 v[170:171], v236 offset:13440
    ds_read_b128 v[172:175], v238 offset:6144
    s_waitcnt lgkmcnt(12)
    v_mfma_f32_16x16x32_bf16 v[228:231], v[140:143], v[136:139], v[228:231]
    ds_read_b64_tr_b16 v[176:177], v236 offset:14336
    ds_read_b64_tr_b16 v[178:179], v236 offset:14464
    ds_read_b128 v[180:183], v237 offset:7168
    s_waitcnt lgkmcnt(12)
    v_mfma_f32_16x16x32_bf16 v[228:231], v[148:151], v[144:147], v[228:231]
    ds_read_b64_tr_b16 v[184:185], v236 offset:15360
    ds_read_b64_tr_b16 v[186:187], v236 offset:15488
    ds_read_b128 v[188:191], v238 offset:7168
    s_waitcnt lgkmcnt(12)
    v_mfma_f32_16x16x32_bf16 v[228:231], v[156:159], v[152:155], v[228:231]
    s_waitcnt lgkmcnt(9)
    v_mfma_f32_16x16x32_bf16 v[228:231], v[164:167], v[160:163], v[228:231]
    s_waitcnt lgkmcnt(6)
    v_mfma_f32_16x16x32_bf16 v[228:231], v[172:175], v[168:171], v[228:231]
    s_waitcnt lgkmcnt(3)
    v_mfma_f32_16x16x32_bf16 v[228:231], v[180:183], v[176:179], v[228:231]
    s_waitcnt lgkmcnt(0)
    v_mfma_f32_16x16x32_bf16 v[228:231], v[188:191], v[184:187], v[228:231]
    s_nop 7
    v_cvt_pk_bf16_f32 v28, v228, v229
    v_cvt_pk_bf16_f32 v29, v230, v231
    buffer_store_dwordx2 v[28:29], v241, s[56:59], s68 offen sc1
    v_mov_b32 v229, 0
L_kvst_3:
    v_add_u32 v243, 16, v229
    v_and_b32 v243, -16, v243
    v_or_b32 v243, s95, v243
    v_add_u32 v242, 1, v202
    s_lshl_b32 s73, s64, 3
    s_add_u32 s73, s73, s65
    s_lshl_b32 s73, s73, 3
    v_mov_b32 v26, 4096
    s_waitcnt vmcnt(0)
    s_mov_b64 exec, 1
    buffer_store_dwordx2 v[242:243], v26, s[56:59], s73 offen sc1
    s_mov_b64 exec, -1
    s_setprio 0
    s_branch L_lnjoin
L_hiw2:
    v_lshlrev_b32 v26, 6, v1
    s_lshl_b32 s72, s81, 14
    s_lshl_b32 s73, s77, 12
    s_add_u32 s72, s72, s73
    buffer_load_dword v203, v26, s[36:39], s72 offen
    s_lshl_b32 s86, s77, 14
    s_lshl_b32 s73, s65, 7
    s_add_u32 s86, s86, s73
    s_lshl_b32 s88, s77, 10
    v_lshrrev_b32 v26, 3, v1
    v_and_b32 v27, 7, v1
    v_xor_b32 v28, v26, v27
    v_lshlrev_b32 v28, 4, v28
    v_lshl_add_u32 v204, v26, 10, v28
    v_xor_b32 v26, 1, v26
    v_xor_b32 v28, v26, v27
    v_lshlrev_b32 v28, 4, v28
    v_lshl_add_u32 v205, v26, 10, v28
    s_add_u32 s72, s70, 1
    s_and_b32 s72, s72, 3
    s_lshl_b32 s72, s72, 14
    s_lshl_b32 s73, s77, 10
    s_add_u32 s73, s73, s72
    s_lshl_b32 s74, s77, 7
    s_add_u32 s72, s72, s74
    s_add_u32 s72, s72, s71
    s_add_u32 m0, s73, 0
    s_add_u32 s75, s72, 0
    buffer_load_dwordx4 v204, s[32:35], s75 offen lds
    s_add_u32 m0, s73, 4096
    s_add_u32 s75, s72, 512
    buffer_load_dwordx4 v204, s[32:35], s75 offen lds
    s_add_u32 m0, s73, 8192
    s_add_u32 s75, s72, 8192
    buffer_load_dwordx4 v205, s[32:35], s75 offen lds
    s_add_u32 m0, s73, 12288
    s_add_u32 s75, s72, 8704
    buffer_load_dwordx4 v205, s[32:35], s75 offen lds
    s_add_u32 s72, s70, 2
    s_and_b32 s72, s72, 3
    s_lshl_b32 s72, s72, 14
    s_lshl_b32 s73, s77, 10
    s_add_u32 s73, s73, s72
    s_lshl_b32 s74, s77, 7
    s_add_u32 s72, s72, s74
    s_add_u32 s72, s72, s71
    s_add_u32 m0, s73, 0
    s_add_u32 s75, s72, 0
    buffer_load_dwordx4 v204, s[32:35], s75 offen lds
    s_add_u32 m0, s73, 4096
    s_add_u32 s75, s72, 512
    buffer_load_dwordx4 v204, s[32:35], s75 offen lds
    s_add_u32 m0, s73, 8192
    s_add_u32 s75, s72, 8192
    buffer_load_dwordx4 v205, s[32:35], s75 offen lds
    s_add_u32 m0, s73, 12288
    s_add_u32 s75, s72, 8704
    buffer_load_dwordx4 v205, s[32:35], s75 offen lds
    s_add_u32 s72, s70, 3
    s_and_b32 s72, s72, 3
    s_lshl_b32 s72, s72, 14
    s_lshl_b32 s73, s77, 10
    s_add_u32 s73, s73, s72
    s_lshl_b32 s74, s77, 7
    s_add_u32 s72, s72, s74
    s_add_u32 s72, s72, s71
    s_add_u32 m0, s73, 0
    s_add_u32 s75, s72, 0
    buffer_load_dwordx4 v204, s[32:35], s75 offen lds
    s_add_u32 m0, s73, 4096
    s_add_u32 s75, s72, 512
    buffer_load_dwordx4 v204, s[32:35], s75 offen lds
    s_add_u32 m0, s73, 8192
    s_add_u32 s75, s72, 8192
    buffer_load_dwordx4 v205, s[32:35], s75 offen lds
    s_add_u32 m0, s73, 12288
    s_add_u32 s75, s72, 8704
    buffer_load_dwordx4 v205, s[32:35], s75 offen lds
    s_add_u32 m0, s88, 65536
    s_add_u32 s75, s86, 0
    buffer_load_dwordx4 v2, s[36:39], s75 offen lds
    s_add_u32 m0, s88, 98304
    s_add_u32 s75, s86, 64
    buffer_load_dwordx4 v2, s[36:39], s75 offen lds
    s_add_u32 m0, s88, 81920
    s_add_u32 s75, s86, 262144
    buffer_load_dwordx4 v2, s[36:39], s75 offen lds
    s_add_u32 m0, s88, 114688
    s_add_u32 s75, s86, 262208
    buffer_load_dwordx4 v2, s[36:39], s75 offen lds
    s_add_u32 m0, s88, 69632
    s_add_u32 s75, s86, 65536
    buffer_load_dwordx4 v2, s[36:39], s75 offen lds
    s_add_u32 m0, s88, 102400
    s_add_u32 s75, s86, 65600
    buffer_load_dwordx4 v2, s[36:39], s75 offen lds
    s_add_u32 m0, s88, 86016
    s_add_u32 s75, s86, 327680
    buffer_load_dwordx4 v2, s[36:39], s75 offen lds
    s_add_u32 m0, s88, 118784
    s_add_u32 s75, s86, 327744
    buffer_load_dwordx4 v2, s[36:39], s75 offen lds
    s_and_b32 s78, s66, 1
    s_lshr_b32 s72, s66, 1
    s_and_b32 s76, s72, 1
    s_lshr_b32 s79, s66, 2
    v_and_b32 v22, 7, v1
    v_bfe_u32 v23, v1, 3, 2
    v_and_b32 v24, 1, v23
    v_xor_b32 v24, v24, v22
    v_lshlrev_b32 v24, 7, v24
    v_lshl_add_u32 v24, v23, 13, v24
    s_lshl_b32 s72, s76, 15
    s_lshl_b32 s73, s78, 12
    s_add_u32 s72, s72, s73
    v_add_u32 v24, s72, v24
    v_lshrrev_b32 v23, 5, v1
    v_xor_b32 v22, v22, v23
    v_lshl_add_u32 v248, v22, 4, v24
    v_xor_b32 v249, 32, v248
    v_xor_b32 v250, 64, v248
    v_xor_b32 v251, 96, v248
    s_mov_b32 s44, s12
    s_mov_b32 s45, s13
    s_mov_b32 s46, 524288
    s_mov_b32 s47, 0x20000
    s_mov_b32 s48, s16
    s_mov_b32 s49, s17
    s_mov_b32 s50, 1409024
    s_mov_b32 s51, 0x20000
    s_mov_b32 s52, s20
    s_mov_b32 s53, s21
    s_mov_b32 s54, 1409024
    s_mov_b32 s55, 0x20000
    s_mov_b32 s60, s24
    s_mov_b32 s61, s25
    s_mov_b32 s62, 2097152
    s_mov_b32 s63, 0x20000
    s_mul_i32 s89, s65, 346431
    s_lshr_b32 s89, s89, 16
    s_lshr_b32 s72, s66, 1
    s_add_u32 s72, s72, 2
    s_cmp_lt_u32 s66, 4
    s_cselect_b32 s80, s66, s72
    v_bfe_u32 v26, v1, 2, 2
    v_lshrrev_b32 v23, 5, v1
    v_bfe_u32 v24, v1, 4, 1
    v_lshlrev_b32 v24, 5, v24
    v_and_b32 v25, 3, v1
    v_lshl_add_u32 v24, v25, 3, v24
    v_lshl_add_u32 v25, v23, 2, v26
    v_lshl_add_u32 v5, v25, 6, v24
    v_lshl_add_u32 v25, v23, 3, v26
    v_lshl_add_u32 v252, v25, 6, v24
    s_lshl_b32 s72, s79, 15
    s_lshl_b32 s73, s78, 14
    s_add_u32 s72, s72, s73
    s_add_u32 s72, s72, 65536
    v_add_u32 v252, s72, v252
    v_mov_b32 v23, 0x4444
    v_mov_b32 v24, 0xeeee
    v_mov_b32 v25, s82
    v_and_b32 v26, 16, v1
    v_cmp_eq_u32 vcc, 0, v26
    v_and_b32 v26, 1, v1
    s_nop 0
    v_cndmask_b32 v10, v24, v23, vcc
    v_cmp_eq_u32 vcc, 0, v26
    v_and_b32 v26, 6, v1
    s_nop 0
    v_cndmask_b32 v11, v24, v23, vcc
    v_cmp_eq_u32 vcc, 0, v26
    s_nop 1
    v_cndmask_b32 v6, 0, v25, vcc
    v_cndmask_b32 v7, 0, v25, vcc
    v_cmp_eq_u32 vcc, 4, v26
    s_nop 1
    v_cndmask_b32 v8, 0, v25, vcc
    v_cndmask_b32 v9, 0, v25, vcc
    v_mov_b32 v216, 0
    v_mov_b32 v217, 0
    v_mov_b32 v218, 0
    v_mov_b32 v219, 0
    s_lshl_b32 s72, s66, 7
    s_add_u32 s72, s72, 152576
    v_and_b32 v220, 31, v1
    v_lshlrev_b32 v220, 2, v220
    v_add_u32 v220, s72, v220
    v_lshrrev_b32 v221, 5, v1
    v_lshlrev_b32 v221, 4, v221
    v_add_u32 v221, s72, v221
    v_and_b32 v222, 31, v1
    v_lshlrev_b32 v222, 3, v222
    s_lshl_b32 s72, s76, 10
    s_add_u32 s72, s72, 148480
    v_add_u32 v222, s72, v222
    s_lshl_b32 s72, s79, 9
    s_lshl_b32 s73, s78, 8
    s_add_u32 s72, s72, s73
    v_add_u32 v223, s72, v222
    s_waitcnt vmcnt(8)
L_lnjoin:
    s_waitcnt lgkmcnt(0)
    s_barrier
    v_readfirstlane_b32 s67, v202
    v_mov_b32 v232, 0
    v_mov_b32 v233, 0
    s_cmp_lg_u32 s79, 0
    s_cbranch_scc1 L_4
    ds_read_b128 v[32:35], v248 offset:0
    ds_read_b128 v[36:39], v249 offset:0
    ds_read_b128 v[40:43], v250 offset:0
    ds_read_b128 v[44:47], v251 offset:0
    ds_read_b128 v[48:51], v248 offset:1024
    ds_read_b128 v[52:55], v249 offset:1024
    ds_read_b128 v[56:59], v250 offset:1024
    ds_read_b128 v[60:63], v251 offset:1024
    ds_read_b128 v[64:67], v248 offset:2048
    ds_read_b128 v[68:71], v249 offset:2048
    ds_read_b128 v[72:75], v250 offset:2048
    ds_read_b128 v[76:79], v251 offset:2048
    s_waitcnt lgkmcnt(11)
    ds_read_b128 v[80:83], v248 offset:3072
    v_dot2c_f32_bf16 v232, s82, v32
    v_dot2c_f32_bf16 v233, v32, v32
    v_dot2c_f32_bf16 v232, s82, v33
    v_dot2c_f32_bf16 v233, v33, v33
    v_dot2c_f32_bf16 v232, s82, v34
    v_dot2c_f32_bf16 v233, v34, v34
    v_dot2c_f32_bf16 v232, s82, v35
    v_dot2c_f32_bf16 v233, v35, v35
    s_waitcnt lgkmcnt(11)
    ds_read_b128 v[84:87], v249 offset:3072
    v_dot2c_f32_bf16 v232, s82, v36
    v_dot2c_f32_bf16 v233, v36, v36
    v_dot2c_f32_bf16 v232, s82, v37
    v_dot2c_f32_bf16 v233, v37, v37
    v_dot2c_f32_bf16 v232, s82, v38
    v_dot2c_f32_bf16 v233, v38, v38
    v_dot2c_f32_bf16 v232, s82, v39
    v_dot2c_f32_bf16 v233, v39, v39
    s_waitcnt lgkmcnt(11)
    ds_read_b128 v[88:91], v250 offset:3072
    v_dot2c_f32_bf16 v232, s82, v40
    v_dot2c_f32_bf16 v233, v40, v40
    v_dot2c_f32_bf16 v232, s82, v41
    v_dot2c_f32_bf16 v233, v41, v41
    v_dot2c_f32_bf16 v232, s82, v42
    v_dot2c_f32_bf16 v233, v42, v42
    v_dot2c_f32_bf16 v232, s82, v43
    v_dot2c_f32_bf16 v233, v43, v43
    s_waitcnt lgkmcnt(11)
    ds_read_b128 v[92:95], v251 offset:3072
    v_dot2c_f32_bf16 v232, s82, v44
    v_dot2c_f32_bf16 v233, v44, v44
    v_dot2c_f32_bf16 v232, s82, v45
    v_dot2c_f32_bf16 v233, v45, v45
    v_dot2c_f32_bf16 v232, s82, v46
    v_dot2c_f32_bf16 v233, v46, v46
    v_dot2c_f32_bf16 v232, s82, v47
    v_dot2c_f32_bf16 v233, v47, v47
    s_waitcnt lgkmcnt(11)
    v_dot2c_f32_bf16 v232, s82, v48
    v_dot2c_f32_bf16 v233, v48, v48
    v_dot2c_f32_bf16 v232, s82, v49
    v_dot2c_f32_bf16 v233, v49, v49
    v_dot2c_f32_bf16 v232, s82, v50
    v_dot2c_f32_bf16 v233, v50, v50
    v_dot2c_f32_bf16 v232, s82, v51
    v_dot2c_f32_bf16 v233, v51, v51
    s_waitcnt lgkmcnt(10)
    v_dot2c_f32_bf16 v232, s82, v52
    v_dot2c_f32_bf16 v233, v52, v52
    v_dot2c_f32_bf16 v232, s82, v53
    v_dot2c_f32_bf16 v233, v53, v53
    v_dot2c_f32_bf16 v232, s82, v54
    v_dot2c_f32_bf16 v233, v54, v54
    v_dot2c_f32_bf16 v232, s82, v55
    v_dot2c_f32_bf16 v233, v55, v55
    s_waitcnt lgkmcnt(9)
    v_dot2c_f32_bf16 v232, s82, v56
    v_dot2c_f32_bf16 v233, v56, v56
    v_dot2c_f32_bf16 v232, s82, v57
    v_dot2c_f32_bf16 v233, v57, v57
    v_dot2c_f32_bf16 v232, s82, v58
    v_dot2c_f32_bf16 v233, v58, v58
    v_dot2c_f32_bf16 v232, s82, v59
    v_dot2c_f32_bf16 v233, v59, v59
    s_waitcnt lgkmcnt(8)
    v_dot2c_f32_bf16 v232, s82, v60
    v_dot2c_f32_bf16 v233, v60, v60
    v_dot2c_f32_bf16 v232, s82, v61
    v_dot2c_f32_bf16 v233, v61, v61
    v_dot2c_f32_bf16 v232, s82, v62
    v_dot2c_f32_bf16 v233, v62, v62
    v_dot2c_f32_bf16 v232, s82, v63
    v_dot2c_f32_bf16 v233, v63, v63
    s_branch L_5
L_4:
    ds_read_b128 v[64:67], v248 offset:2048
    ds_read_b128 v[68:71], v249 offset:2048
    ds_read_b128 v[72:75], v250 offset:2048
    ds_read_b128 v[76:79], v251 offset:2048
    ds_read_b128 v[80:83], v248 offset:3072
    ds_read_b128 v[84:87], v249 offset:3072
    ds_read_b128 v[88:91], v250 offset:3072
    ds_read_b128 v[92:95], v251 offset:3072
    ds_read_b128 v[32:35], v248 offset:0
    ds_read_b128 v[36:39], v249 offset:0
    ds_read_b128 v[40:43], v250 offset:0
    ds_read_b128 v[44:47], v251 offset:0
    s_add_u32 m0, s88, 73728
    s_add_u32 s75, s86, 131072
    buffer_load_dwordx4 v2, s[36:39], s75 offen lds
    s_add_u32 m0, s88, 106496
    s_add_u32 s75, s86, 131136
    buffer_load_dwordx4 v2, s[36:39], s75 offen lds
    s_add_u32 m0, s88, 90112
    s_add_u32 s75, s86, 393216
    buffer_load_dwordx4 v2, s[36:39], s75 offen lds
    s_add_u32 m0, s88, 122880
    s_add_u32 s75, s86, 393280
    buffer_load_dwordx4 v2, s[36:39], s75 offen lds
    s_add_u32 m0, s88, 77824
    s_add_u32 s75, s86, 196608
    buffer_load_dwordx4 v2, s[36:39], s75 offen lds
    s_add_u32 m0, s88, 110592
    s_add_u32 s75, s86, 196672
    buffer_load_dwordx4 v2, s[36:39], s75 offen lds
    s_add_u32 m0, s88, 94208
    s_add_u32 s75, s86, 458752
    buffer_load_dwordx4 v2, s[36:39], s75 offen lds
    s_add_u32 m0, s88, 126976
    s_add_u32 s75, s86, 458816
    buffer_load_dwordx4 v2, s[36:39], s75 offen lds
    s_waitcnt lgkmcnt(11)
    ds_read_b128 v[48:51], v248 offset:1024
    v_dot2c_f32_bf16 v232, s82, v64
    v_dot2c_f32_bf16 v233, v64, v64
    v_dot2c_f32_bf16 v232, s82, v65
    v_dot2c_f32_bf16 v233, v65, v65
    v_dot2c_f32_bf16 v232, s82, v66
    v_dot2c_f32_bf16 v233, v66, v66
    v_dot2c_f32_bf16 v232, s82, v67
    v_dot2c_f32_bf16 v233, v67, v67
    s_waitcnt lgkmcnt(11)
    ds_read_b128 v[52:55], v249 offset:1024
    v_dot2c_f32_bf16 v232, s82, v68
    v_dot2c_f32_bf16 v233, v68, v68
    v_dot2c_f32_bf16 v232, s82, v69
    v_dot2c_f32_bf16 v233, v69, v69
    v_dot2c_f32_bf16 v232, s82, v70
    v_dot2c_f32_bf16 v233, v70, v70
    v_dot2c_f32_bf16 v232, s82, v71
    v_dot2c_f32_bf16 v233, v71, v71
    s_waitcnt lgkmcnt(11)
    ds_read_b128 v[56:59], v250 offset:1024
    v_dot2c_f32_bf16 v232, s82, v72
    v_dot2c_f32_bf16 v233, v72, v72
    v_dot2c_f32_bf16 v232, s82, v73
    v_dot2c_f32_bf16 v233, v73, v73
    v_dot2c_f32_bf16 v232, s82, v74
    v_dot2c_f32_bf16 v233, v74, v74
    v_dot2c_f32_bf16 v232, s82, v75
    v_dot2c_f32_bf16 v233, v75, v75
    s_waitcnt lgkmcnt(11)
    ds_read_b128 v[60:63], v251 offset:1024
    v_dot2c_f32_bf16 v232, s82, v76
    v_dot2c_f32_bf16 v233, v76, v76
    v_dot2c_f32_bf16 v232, s82, v77
    v_dot2c_f32_bf16 v233, v77, v77
    v_dot2c_f32_bf16 v232, s82, v78
    v_dot2c_f32_bf16 v233, v78, v78
    v_dot2c_f32_bf16 v232, s82, v79
    v_dot2c_f32_bf16 v233, v79, v79
    s_waitcnt lgkmcnt(11)
    v_dot2c_f32_bf16 v232, s82, v80
    v_dot2c_f32_bf16 v233, v80, v80
    v_dot2c_f32_bf16 v232, s82, v81
    v_dot2c_f32_bf16 v233, v81, v81
    v_dot2c_f32_bf16 v232, s82, v82
    v_dot2c_f32_bf16 v233, v82, v82
    v_dot2c_f32_bf16 v232, s82, v83
    v_dot2c_f32_bf16 v233, v83, v83
    s_waitcnt lgkmcnt(10)
    v_dot2c_f32_bf16 v232, s82, v84
    v_dot2c_f32_bf16 v233, v84, v84
    v_dot2c_f32_bf16 v232, s82, v85
    v_dot2c_f32_bf16 v233, v85, v85
    v_dot2c_f32_bf16 v232, s82, v86
    v_dot2c_f32_bf16 v233, v86, v86
    v_dot2c_f32_bf16 v232, s82, v87
    v_dot2c_f32_bf16 v233, v87, v87
    s_waitcnt lgkmcnt(9)
    v_dot2c_f32_bf16 v232, s82, v88
    v_dot2c_f32_bf16 v233, v88, v88
    v_dot2c_f32_bf16 v232, s82, v89
    v_dot2c_f32_bf16 v233, v89, v89
    v_dot2c_f32_bf16 v232, s82, v90
    v_dot2c_f32_bf16 v233, v90, v90
    v_dot2c_f32_bf16 v232, s82, v91
    v_dot2c_f32_bf16 v233, v91, v91
    s_waitcnt lgkmcnt(8)
    v_dot2c_f32_bf16 v232, s82, v92
    v_dot2c_f32_bf16 v233, v92, v92
    v_dot2c_f32_bf16 v232, s82, v93
    v_dot2c_f32_bf16 v233, v93, v93
    v_dot2c_f32_bf16 v232, s82, v94
    v_dot2c_f32_bf16 v233, v94, v94
    v_dot2c_f32_bf16 v232, s82, v95
    v_dot2c_f32_bf16 v233, v95, v95
L_5:
    s_nop 2
    v_mov_b32 v234, v232
    v_mov_b32 v235, v233
    s_nop 1
    v_permlane32_swap_b32 v232, v234
    v_permlane32_swap_b32 v233, v235
    v_pk_add_f32 v[232:233], v[232:233], v[234:235]
    ds_write_b64 v223, v[232:233]
    s_add_u32 s67, s67, 1
    s_cmp_lt_u32 s66, 4
    s_cbranch_scc1 L_6
    s_waitcnt vmcnt(8)
L_6:
    s_waitcnt lgkmcnt(0)
    s_barrier
    ds_read_b64_tr_b16 v[96:97], v252 offset:0
    ds_read_b64_tr_b16 v[98:99], v252 offset:256
    ds_read_b64_tr_b16 v[100:101], v252 offset:1024
    ds_read_b64_tr_b16 v[102:103], v252 offset:1280
    ds_read_b64 v[160:161], v222 offset:0
    ds_read_b64 v[162:163], v222 offset:256
    ds_read_b64 v[164:165], v222 offset:512
    ds_read_b64 v[166:167], v222 offset:768
    ds_read_b64_tr_b16 v[104:105], v252 offset:2048
    ds_read_b64_tr_b16 v[106:107], v252 offset:2304
    ds_read_b64_tr_b16 v[108:109], v252 offset:3072
    ds_read_b64_tr_b16 v[110:111], v252 offset:3328
    ds_read_b64_tr_b16 v[112:113], v252 offset:4096
    ds_read_b64_tr_b16 v[114:115], v252 offset:4352
    s_waitcnt lgkmcnt(12)
    v_mfma_f32_32x32x16_bf16 v[192:207], v[96:99], v[32:35], 0
    ds_read_b64_tr_b16 v[116:117], v252 offset:5120
    ds_read_b64_tr_b16 v[118:119], v252 offset:5376
    s_waitcnt lgkmcnt(12)
    v_mfma_f32_32x32x16_bf16 v[192:207], v[100:103], v[36:39], v[192:207]
    ds_read_b64_tr_b16 v[120:121], v252 offset:6144
    ds_read_b64_tr_b16 v[122:123], v252 offset:6400
    v_smfmac_f32_16x16x64_bf16 v[216:219], v[6:9], v[96:103], v11
    s_waitcnt lgkmcnt(8)
    v_mfma_f32_32x32x16_bf16 v[192:207], v[104:107], v[40:43], v[192:207]
    ds_read_b64_tr_b16 v[124:125], v252 offset:7168
    ds_read_b64_tr_b16 v[126:127], v252 offset:7424
    s_waitcnt lgkmcnt(8)
    v_mfma_f32_32x32x16_bf16 v[192:207], v[108:111], v[44:47], v[192:207]
    v_smfmac_f32_16x16x64_bf16 v[216:219], v[6:9], v[104:111], v11
    s_waitcnt lgkmcnt(6)
    v_mfma_f32_32x32x16_bf16 v[192:207], v[112:115], v[48:51], v[192:207]
    s_cmp_lt_u32 s66, 4
    s_cbranch_scc1 L_7
    s_waitcnt vmcnt(0)
L_7:
    s_barrier
    ds_read_b64_tr_b16 v[128:129], v252 offset:8192
    ds_read_b64_tr_b16 v[130:131], v252 offset:8448
    ds_read_b64_tr_b16 v[132:133], v252 offset:9216
    ds_read_b64_tr_b16 v[134:135], v252 offset:9472
    ds_read_b64_tr_b16 v[136:137], v252 offset:10240
    ds_read_b64_tr_b16 v[138:139], v252 offset:10496
    ds_read_b64_tr_b16 v[140:141], v252 offset:11264
    ds_read_b64_tr_b16 v[142:143], v252 offset:11520
    s_waitcnt lgkmcnt(12)
    v_mfma_f32_32x32x16_bf16 v[192:207], v[116:119], v[52:55], v[192:207]
    ds_read_b64_tr_b16 v[144:145], v252 offset:12288
    ds_read_b64_tr_b16 v[146:147], v252 offset:12544
    v_smfmac_f32_16x16x64_bf16 v[216:219], v[6:9], v[112:119], v11
    s_waitcnt lgkmcnt(12)
    v_mfma_f32_32x32x16_bf16 v[192:207], v[120:123], v[56:59], v[192:207]
    ds_read_b64_tr_b16 v[148:149], v252 offset:13312
    ds_read_b64_tr_b16 v[150:151], v252 offset:13568
    v_pk_add_f32 v[160:161], v[160:161], v[162:163]
    v_pk_add_f32 v[164:165], v[164:165], v[166:167]
    v_pk_add_f32 v[232:233], v[160:161], v[164:165]
    v_mul_f32 v235, 0xbb000000, v232
    v_mul_f32 v233, 0x3b000000, v233
    v_fma_f32 v233, -v235, v235, v233
    v_max_f32 v233, 0, v233
    v_add_f32 v233, 0x3727c5ac, v233
    v_rsq_f32 v234, v233
    s_nop 0
    s_cmp_lg_u32 s66, 2
    s_cbranch_scc1 L_nopoll_8
    v_lshlrev_b32 v27, 5, v1
    v_add_u32 v27, 4096, v27
    s_mov_b32 s90, 1048576
    buffer_load_dwordx4 v[168:171], v27, s[56:59], 0 offen sc1
    buffer_load_dwordx4 v[172:175], v27, s[56:59], 0 offen offset:16 sc1
    buffer_load_dwordx4 v[176:179], v27, s[56:59], 0 offen sc1
    buffer_load_dwordx4 v[180:183], v27, s[56:59], 0 offen offset:16 sc1
L_nopoll_8:
    s_waitcnt lgkmcnt(12)
    v_mfma_f32_32x32x16_bf16 v[192:207], v[124:127], v[60:63], v[192:207]
    ds_read_b64_tr_b16 v[152:153], v252 offset:14336
    ds_read_b64_tr_b16 v[154:155], v252 offset:14592
    v_smfmac_f32_16x16x64_bf16 v[216:219], v[6:9], v[120:127], v11
    s_waitcnt lgkmcnt(12)
    v_mfma_f32_32x32x16_bf16 v[192:207], v[128:131], v[64:67], v[192:207]
    ds_read_b64_tr_b16 v[156:157], v252 offset:15360
    ds_read_b64_tr_b16 v[158:159], v252 offset:15616
    s_lshl_b32 s72, s76, 1
    v_bfe_u32 v23, v1, 4, 1
    v_add_u32 v23, s72, v23
    v_cmp_eq_u32 vcc, s70, v23
    s_nop 1
    v_cndmask_b32_e64 v234, v234, 1.0, vcc
    v_cndmask_b32_e64 v235, v235, 0, vcc
    v_mul_f32 v234, 0x3eb8aa3b, v234
    s_waitcnt lgkmcnt(12)
    v_mfma_f32_32x32x16_bf16 v[192:207], v[132:135], v[68:71], v[192:207]
    v_smfmac_f32_16x16x64_bf16 v[216:219], v[6:9], v[128:135], v11
    s_waitcnt lgkmcnt(10)
    v_mfma_f32_32x32x16_bf16 v[192:207], v[136:139], v[72:75], v[192:207]
    s_lshl_b32 s86, s77, 17
    s_lshl_b32 s73, s65, 7
    s_add_u32 s86, s86, s73
    s_lshr_b32 s72, s77, 1
    s_lshl_b32 s72, s72, 6
    s_add_u32 s86, s86, s72
    s_xor_b32 s84, s86, 64
    s_lshr_b32 s72, s66, 1
    s_mul_i32 s88, s72, 360448
    s_lshl_b32 s72, s78, 6
    s_add_u32 s88, s88, s72
    s_add_u32 s88, s88, s73
    s_lshl_b32 s72, s89, 6
    s_mul_i32 s87, s66, 44032
    s_add_u32 s87, s87, s72
    s_lshl_b32 s94, s80, 6
    s_add_u32 s94, s94, s72
    s_mul_i32 s83, s66, 8192
    s_add_u32 s83, s83, 98304
    v_add_u32 v24, s83, v5
    s_and_b32 s72, s77, 1
    s_lshl_b32 s72, s72, 5
    v_xor_b32 v25, s72, v24
    s_waitcnt lgkmcnt(8)
    v_mfma_f32_32x32x16_bf16 v[192:207], v[140:143], v[76:79], v[192:207]
    v_smfmac_f32_16x16x64_bf16 v[216:219], v[6:9], v[136:143], v11
    s_waitcnt lgkmcnt(6)
    v_mfma_f32_32x32x16_bf16 v[192:207], v[144:147], v[80:83], v[192:207]
    s_waitcnt lgkmcnt(4)
    v_mfma_f32_32x32x16_bf16 v[192:207], v[148:151], v[84:87], v[192:207]
    v_smfmac_f32_16x16x64_bf16 v[216:219], v[6:9], v[144:151], v11
    s_waitcnt lgkmcnt(2)
    v_mfma_f32_32x32x16_bf16 v[192:207], v[152:155], v[88:91], v[192:207]
    s_waitcnt lgkmcnt(0)
    v_mfma_f32_32x32x16_bf16 v[192:207], v[156:159], v[92:95], v[192:207]
    v_smfmac_f32_16x16x64_bf16 v[216:219], v[6:9], v[152:159], v11
    s_lshl_b32 s72, s66, 12
    s_add_u32 s72, s72, 32768
    v_add_u32 v22, s72, v4
    v_xor_b32 v23, 4096, v22
    s_nop 5
    v_add_f32 v216, v216, v217
    ds_write_b32 v220, v216
    ds_read_b128 v[96:99], v221 offset:0
    ds_read_b128 v[100:103], v221 offset:32
    ds_read_b128 v[104:107], v221 offset:64
    ds_read_b128 v[108:111], v221 offset:96
    s_waitcnt lgkmcnt(0)
    v_pk_fma_f32 v[192:193], v[96:97], v[234:235], v[192:193] op_sel:[0,1,0] op_sel_hi:[1,1,1]
    v_pk_fma_f32 v[194:195], v[98:99], v[234:235], v[194:195] op_sel:[0,1,0] op_sel_hi:[1,1,1]
    v_pk_fma_f32 v[196:197], v[100:101], v[234:235], v[196:197] op_sel:[0,1,0] op_sel_hi:[1,1,1]
    v_pk_fma_f32 v[198:199], v[102:103], v[234:235], v[198:199] op_sel:[0,1,0] op_sel_hi:[1,1,1]
    v_pk_fma_f32 v[200:201], v[104:105], v[234:235], v[200:201] op_sel:[0,1,0] op_sel_hi:[1,1,1]
    v_pk_fma_f32 v[202:203], v[106:107], v[234:235], v[202:203] op_sel:[0,1,0] op_sel_hi:[1,1,1]
    v_pk_fma_f32 v[204:205], v[108:109], v[234:235], v[204:205] op_sel:[0,1,0] op_sel_hi:[1,1,1]
    v_pk_fma_f32 v[206:207], v[110:111], v[234:235], v[206:207] op_sel:[0,1,0] op_sel_hi:[1,1,1]
    ds_write_b128 v22, v[192:195] offset:0
    ds_write_b128 v22, v[196:199] offset:1024
    ds_write_b128 v22, v[200:203] offset:2048
    ds_write_b128 v22, v[204:207] offset:3072
    v_mov_b32 v12, 0
    v_mov_b32 v13, 0
    v_mov_b32 v14, 0
    v_mov_b32 v15, 0
    v_mov_b32 v16, 0
    v_mov_b32 v17, 0
    v_mov_b32 v18, 0
    v_mov_b32 v19, 0
    s_nop 1
    v_mfma_f32_32x32x16_bf16 v[92:107], v[12:15], v[12:15], 0
    v_mfma_f32_32x32x16_bf16 v[108:123], v[12:15], v[12:15], 0
    s_mul_i32 s72, s78, 16384
    v_add_u32 v124, s72, v4
    v_add_u32 v125, 65536, v124
    s_cmp_lg_u32 s66, 2
    s_cbranch_scc1 L_nopoll_9
L_kvpoll:
    s_waitcnt vmcnt(2)
    v_xor_b32 v168, s67, v168
    v_xor_b32 v170, s67, v170
    v_xor_b32 v172, s67, v172
    v_xor_b32 v174, s67, v174
    v_or3_b32 v168, v168, v170, v172
    v_or_b32 v168, v168, v174
    v_max3_u32 v184, v169, v171, v173
    v_max_u32 v184, v184, v175
    v_xor_b32 v169, s95, v169
    v_xor_b32 v171, s95, v171
    v_xor_b32 v173, s95, v173
    v_xor_b32 v175, s95, v175
    v_or3_b32 v186, v169, v171, v173
    v_or_b32 v186, v186, v175
    v_cmp_ne_u32 vcc, 0, v168
    s_cbranch_vccz L_kvpoll_x
    buffer_load_dwordx4 v[168:171], v27, s[56:59], 0 offen sc1
    buffer_load_dwordx4 v[172:175], v27, s[56:59], 0 offen offset:16 sc1
    s_waitcnt vmcnt(2)
    v_xor_b32 v176, s67, v176
    v_xor_b32 v178, s67, v178
    v_xor_b32 v180, s67, v180
    v_xor_b32 v182, s67, v182
    v_or3_b32 v176, v176, v178, v180
    v_or_b32 v176, v176, v182
    v_max3_u32 v184, v177, v179, v181
    v_max_u32 v184, v184, v183
    v_xor_b32 v177, s95, v177
    v_xor_b32 v179, s95, v179
    v_xor_b32 v181, s95, v181
    v_xor_b32 v183, s95, v183
    v_or3_b32 v186, v177, v179, v181
    v_or_b32 v186, v186, v183
    v_cmp_ne_u32 vcc, 0, v176
    s_cbranch_vccz L_kvpoll_x
    buffer_load_dwordx4 v[176:179], v27, s[56:59], 0 offen sc1
    buffer_load_dwordx4 v[180:183], v27, s[56:59], 0 offen offset:16 sc1
    s_sub_u32 s90, s90, 1
    s_cbranch_scc0 L_kvpoll
L_kvpoll_x:
    s_nop 1
    v_max_u32_dpp v184, v184, v184 row_ror:8 row_mask:0xf bank_mask:0xf
    s_nop 1
    v_max_u32_dpp v184, v184, v184 row_ror:4 row_mask:0xf bank_mask:0xf
    s_nop 1
    v_max_u32_dpp v184, v184, v184 row_ror:2 row_mask:0xf bank_mask:0xf
    s_nop 1
    v_max_u32_dpp v184, v184, v184 row_ror:1 row_mask:0xf bank_mask:0xf
    v_mov_b32 v185, v184
    s_nop 1
    v_permlane16_swap_b32 v184, v185
    v_max_u32 v184, v184, v185
    v_mov_b32 v185, v184
    s_nop 1
    v_permlane32_swap_b32 v184, v185
    v_max_u32 v184, v184, v185
    s_lshl_b32 s72, s64, 1
    s_add_u32 s73, s72, 1
    v_readlane_b32 s72, v186, s72
    v_readlane_b32 s73, v186, s73
    v_mov_b32 v27, 151552
    s_or_b32 s72, s72, s73
    s_and_b32 s72, s72, 15
    v_mov_b32 v185, s72
    s_waitcnt vmcnt(0)
    ds_write_b64 v27, v[184:185]
    s_waitcnt lgkmcnt(0)
    s_or_b32 s72, s64, s65
    s_cmp_lg_u32 s72, 0
    s_cbranch_scc1 L_10
    v_mov_b32 v168, s67
    v_mov_b32 v28, 0
    s_mov_b64 exec, 1
    buffer_store_dword v168, v28, s[56:59], 0 offen sc1
    s_mov_b64 exec, -1
L_10:
L_nopoll_9:
    s_waitcnt lgkmcnt(0)
    s_barrier
    s_add_u32 m0, s69, 0
    s_add_u32 s75, s69, 65536
    buffer_load_dwordx4 v4, s[56:59], s75 offen sc1 lds
    s_add_u32 m0, s69, 8192
    s_add_u32 s75, s69, 73728
    buffer_load_dwordx4 v4, s[56:59], s75 offen sc1 lds
    s_add_u32 m0, s69, 16384
    s_add_u32 s75, s69, 81920
    buffer_load_dwordx4 v4, s[56:59], s75 offen sc1 lds
    s_add_u32 m0, s69, 24576
    s_add_u32 s75, s69, 90112
    buffer_load_dwordx4 v4, s[56:59], s75 offen sc1 lds
    ds_read_b128 v[32:35], v23 offset:0
    ds_read_b128 v[36:39], v23 offset:1024
    ds_read_b128 v[40:43], v23 offset:2048
    ds_read_b128 v[44:47], v23 offset:3072
    v_mov_b32 v22, 151552
    ds_read_b64 v[28:29], v22
    s_waitcnt lgkmcnt(1)
    v_pk_add_f32 v[192:193], v[192:193], v[32:33]
    v_pk_add_f32 v[194:195], v[194:195], v[34:35]
    v_pk_add_f32 v[196:197], v[196:197], v[36:37]
    v_pk_add_f32 v[198:199], v[198:199], v[38:39]
    v_pk_add_f32 v[200:201], v[200:201], v[40:41]
    v_pk_add_f32 v[202:203], v[202:203], v[42:43]
    v_pk_add_f32 v[204:205], v[204:205], v[44:45]
    v_pk_add_f32 v[206:207], v[206:207], v[46:47]
    v_pk_mul_f32 v[192:193], v[192:193], v[234:235] op_sel_hi:[1,0]
    v_pk_mul_f32 v[194:195], v[194:195], v[234:235] op_sel_hi:[1,0]
    v_pk_mul_f32 v[196:197], v[196:197], v[234:235] op_sel_hi:[1,0]
    v_pk_mul_f32 v[198:199], v[198:199], v[234:235] op_sel_hi:[1,0]
    v_pk_mul_f32 v[200:201], v[200:201], v[234:235] op_sel_hi:[1,0]
    v_pk_mul_f32 v[202:203], v[202:203], v[234:235] op_sel_hi:[1,0]
    v_pk_mul_f32 v[204:205], v[204:205], v[234:235] op_sel_hi:[1,0]
    v_pk_mul_f32 v[206:207], v[206:207], v[234:235] op_sel_hi:[1,0]
    v_cvt_pk_bf16_f32 v32, v192, v193
    v_cvt_pk_bf16_f32 v36, v200, v201
    v_cvt_pk_bf16_f32 v33, v194, v195
    v_cvt_pk_bf16_f32 v37, v202, v203
    v_cvt_pk_bf16_f32 v34, v196, v197
    v_cvt_pk_bf16_f32 v38, v204, v205
    v_cvt_pk_bf16_f32 v35, v198, v199
    v_cvt_pk_bf16_f32 v39, v206, v207
    v_mul_f32 v226, v192, v192
    v_mul_f32 v227, v200, v200
    v_fmac_f32 v226, v193, v193
    v_fmac_f32 v227, v201, v201
    v_fmac_f32 v226, v194, v194
    v_fmac_f32 v227, v202, v202
    v_fmac_f32 v226, v195, v195
    v_fmac_f32 v227, v203, v203
    v_fmac_f32 v226, v196, v196
    v_fmac_f32 v227, v204, v204
    v_fmac_f32 v226, v197, v197
    v_fmac_f32 v227, v205, v205
    v_fmac_f32 v226, v198, v198
    v_fmac_f32 v227, v206, v206
    v_fmac_f32 v226, v199, v199
    v_fmac_f32 v227, v207, v207
    v_mov_b32 v228, v226
    v_mov_b32 v229, v227
    s_nop 1
    v_permlane32_swap_b32 v226, v228
    v_permlane32_swap_b32 v227, v229
    v_add_f32 v226, v226, v228
    v_add_f32 v227, v227, v229
    v_max_u32 v226, v226, v227
    s_waitcnt lgkmcnt(0)
    v_mul_f32 v226, v226, v28
    v_readfirstlane_b32 s95, v29
    s_mov_b32 s72, 0x45610000
    v_cmp_nge_f32 vcc, s72, v226
    v_and_b32 v27, 31, v1
    v_lshrrev_b32 v28, 5, v1
    v_lshlrev_b32 v28, 3, v28
    v_lshl_add_u32 v27, v27, 10, v28
    s_lshl_b32 s72, s65, 7
    s_lshl_b32 s73, s77, 5
    s_add_u32 s72, s72, s73
    s_lshl_b32 s73, s91, 15
    s_lshl_b32 s74, s64, 16
    s_add_u32 s73, s73, s74
    s_add_u32 s68, s73, s72
    v_mul_u32_u24 v30, 64, v1
    s_mul_i32 s72, s66, 4096
    s_mul_i32 s73, s81, 44032
    s_add_u32 s73, s73, s72
    s_mul_i32 s74, s81, 22016
    s_add_u32 s74, s74, s72
    s_add_u32 s74, s74, 704512
    s_lshl_b32 s96, s64, 1
    s_add_u32 s96, s96, s76
    s_lshl_b32 s96, s96, 5
    s_lshl_b32 s97, s65, 2
    s_add_u32 s96, s96, s97
    s_lshl_b32 s97, s79, 1
    s_add_u32 s96, s96, s97
    s_add_u32 s96, s96, s78
    s_lshl_b32 s97, s96, 10
    s_add_u32 s97, s97, 262144
    s_lshl_b32 s96, s96, 2
    s_add_u32 s96, s96, 8192
    s_mov_b32 s98, 0x07060302
    s_cbranch_vccnz L_slow
    s_waitcnt vmcnt(0)
    s_barrier
    ds_read_b128 v[40:43], v124 offset:0
    s_setprio 3
    s_waitcnt lgkmcnt(0)
    v_mfma_f32_32x32x16_bf16 v[60:75], v[40:43], v[32:35], 0
    s_nop 11
    v_mfma_f32_32x32x16_bf16 v[76:91], v[40:43], v[36:39], 0
    ds_read_b128 v[40:43], v124 offset:2048
    v_exp_f32 v60, v60
    v_exp_f32 v61, v61
    v_exp_f32 v62, v62
    v_exp_f32 v63, v63
    ds_read_b128 v[44:47], v124 offset:1024
    v_exp_f32 v64, v64
    v_exp_f32 v65, v65
    v_exp_f32 v66, v66
    v_exp_f32 v67, v67
    s_add_u32 m0, s69, 32768
    s_add_u32 s75, s69, 98304
    buffer_load_dwordx4 v4, s[56:59], s75 offen sc1 lds
    v_exp_f32 v68, v68
    v_exp_f32 v69, v69
    v_perm_b32 v52, v61, v60, s98
    v_perm_b32 v53, v63, v62, s98
    v_perm_b32 v54, v65, v64, s98
    v_perm_b32 v55, v67, v66, s98
    v_exp_f32 v70, v70
    v_exp_f32 v71, v71
    v_perm_b32 v56, v69, v68, s98
    v_exp_f32 v72, v72
    v_exp_f32 v73, v73
    v_perm_b32 v57, v71, v70, s98
    v_exp_f32 v74, v74
    v_exp_f32 v75, v75
    v_perm_b32 v58, v73, v72, s98
    v_perm_b32 v59, v75, v74, s98
    s_waitcnt lgkmcnt(1)
    v_mfma_f32_32x32x16_bf16 v[60:75], v[40:43], v[32:35], 0
    v_exp_f32 v76, v76
    v_exp_f32 v77, v77
    v_exp_f32 v78, v78
    v_exp_f32 v79, v79
    s_waitcnt lgkmcnt(0)
    v_smfmac_f32_32x32x32_bf16 v[92:107], v[44:47], v[52:59], v10
    v_exp_f32 v80, v80
    v_exp_f32 v81, v81
    v_exp_f32 v82, v82
    v_exp_f32 v83, v83
    v_smfmac_f32_16x16x64_bf16 v[12:15], v[6:9], v[52:59], v11
    s_add_u32 m0, s69, 40960
    s_add_u32 s75, s69, 106496
    buffer_load_dwordx4 v4, s[56:59], s75 offen sc1 lds
    v_exp_f32 v84, v84
    v_exp_f32 v85, v85
    v_perm_b32 v52, v77, v76, s98
    v_perm_b32 v53, v79, v78, s98
    v_perm_b32 v54, v81, v80, s98
    v_perm_b32 v55, v83, v82, s98
    v_exp_f32 v86, v86
    v_exp_f32 v87, v87
    v_perm_b32 v56, v85, v84, s98
    v_exp_f32 v88, v88
    v_exp_f32 v89, v89
    v_perm_b32 v57, v87, v86, s98
    v_exp_f32 v90, v90
    v_exp_f32 v91, v91
    v_perm_b32 v58, v89, v88, s98
    v_perm_b32 v59, v91, v90, s98
    s_setprio 2
    v_mfma_f32_32x32x16_bf16 v[76:91], v[40:43], v[36:39], 0
    ds_read_b128 v[40:43], v124 offset:4096
    v_exp_f32 v60, v60
    v_exp_f32 v61, v61
    v_exp_f32 v62, v62
    v_exp_f32 v63, v63
    v_smfmac_f32_32x32x32_bf16 v[108:123], v[44:47], v[52:59], v10
    ds_read_b128 v[44:47], v124 offset:3072
    v_exp_f32 v64, v64
    v_exp_f32 v65, v65
    v_exp_f32 v66, v66
    v_exp_f32 v67, v67
    v_smfmac_f32_16x16x64_bf16 v[16:19], v[6:9], v[52:59], v11
    s_add_u32 m0, s69, 49152
    s_add_u32 s75, s69, 114688
    buffer_load_dwordx4 v4, s[56:59], s75 offen sc1 lds
    v_exp_f32 v68, v68
    v_exp_f32 v69, v69
    v_perm_b32 v52, v61, v60, s98
    v_perm_b32 v53, v63, v62, s98
    v_perm_b32 v54, v65, v64, s98
    v_perm_b32 v55, v67, v66, s98
    v_exp_f32 v70, v70
    v_exp_f32 v71, v71
    s_add_u32 m0, s83, 0
    s_add_u32 s75, s86, 0
    buffer_load_dwordx4 v2, s[44:47], s75 offen lds
    s_add_u32 m0, s83, 1024
    s_add_u32 s75, s84, 0
    buffer_load_dwordx4 v2, s[44:47], s75 offen lds
    v_perm_b32 v56, v69, v68, s98
    v_exp_f32 v72, v72
    v_exp_f32 v73, v73
    v_perm_b32 v57, v71, v70, s98
    v_exp_f32 v74, v74
    v_exp_f32 v75, v75
    v_perm_b32 v58, v73, v72, s98
    v_perm_b32 v59, v75, v74, s98
    s_waitcnt lgkmcnt(1)
    v_mfma_f32_32x32x16_bf16 v[60:75], v[40:43], v[32:35], 0
    v_exp_f32 v76, v76
    v_exp_f32 v77, v77
    v_exp_f32 v78, v78
    v_exp_f32 v79, v79
    s_waitcnt lgkmcnt(0)
    v_smfmac_f32_32x32x32_bf16 v[92:107], v[44:47], v[52:59], v10
    v_exp_f32 v80, v80
    v_exp_f32 v81, v81
    v_exp_f32 v82, v82
    v_exp_f32 v83, v83
    v_smfmac_f32_16x16x64_bf16 v[12:15], v[6:9], v[52:59], v11
    s_add_u32 m0, s69, 57344
    s_add_u32 s75, s69, 122880
    buffer_load_dwordx4 v4, s[56:59], s75 offen sc1 lds
    v_exp_f32 v84, v84
    v_exp_f32 v85, v85
    v_perm_b32 v52, v77, v76, s98
    v_perm_b32 v53, v79, v78, s98
    v_perm_b32 v54, v81, v80, s98
    v_perm_b32 v55, v83, v82, s98
    v_exp_f32 v86, v86
    v_exp_f32 v87, v87
    v_perm_b32 v56, v85, v84, s98
    v_exp_f32 v88, v88
    v_exp_f32 v89, v89
    v_perm_b32 v57, v87, v86, s98
    v_exp_f32 v90, v90
    v_exp_f32 v91, v91
    v_perm_b32 v58, v89, v88, s98
    v_perm_b32 v59, v91, v90, s98
    v_mfma_f32_32x32x16_bf16 v[76:91], v[40:43], v[36:39], 0
    ds_read_b128 v[40:43], v124 offset:6144
    v_exp_f32 v60, v60
    v_exp_f32 v61, v61
    v_exp_f32 v62, v62
    v_exp_f32 v63, v63
    v_smfmac_f32_32x32x32_bf16 v[108:123], v[44:47], v[52:59], v10
    ds_read_b128 v[44:47], v124 offset:5120
    v_exp_f32 v64, v64
    v_exp_f32 v65, v65
    v_exp_f32 v66, v66
    v_exp_f32 v67, v67
    v_smfmac_f32_16x16x64_bf16 v[16:19], v[6:9], v[52:59], v11
    s_add_u32 m0, s69, 65536
    s_add_u32 s75, s69, 131072
    buffer_load_dwordx4 v4, s[56:59], s75 offen sc1 lds
    v_exp_f32 v68, v68
    v_exp_f32 v69, v69
    v_perm_b32 v52, v61, v60, s98
    v_perm_b32 v53, v63, v62, s98
    v_perm_b32 v54, v65, v64, s98
    v_perm_b32 v55, v67, v66, s98
    v_exp_f32 v70, v70
    v_exp_f32 v71, v71
    s_add_u32 m0, s83, 2048
    s_add_u32 s75, s86, 16384
    buffer_load_dwordx4 v2, s[44:47], s75 offen lds
    s_add_u32 m0, s83, 3072
    s_add_u32 s75, s84, 16384
    buffer_load_dwordx4 v2, s[44:47], s75 offen lds
    v_perm_b32 v56, v69, v68, s98
    v_exp_f32 v72, v72
    v_exp_f32 v73, v73
    v_perm_b32 v57, v71, v70, s98
    v_exp_f32 v74, v74
    v_exp_f32 v75, v75
    v_perm_b32 v58, v73, v72, s98
    v_perm_b32 v59, v75, v74, s98
    s_waitcnt lgkmcnt(1)
    v_mfma_f32_32x32x16_bf16 v[60:75], v[40:43], v[32:35], 0
    v_exp_f32 v76, v76
    v_exp_f32 v77, v77
    v_exp_f32 v78, v78
    v_exp_f32 v79, v79
    s_waitcnt lgkmcnt(0)
    v_smfmac_f32_32x32x32_bf16 v[92:107], v[44:47], v[52:59], v10
    v_exp_f32 v80, v80
    v_exp_f32 v81, v81
    v_exp_f32 v82, v82
    v_exp_f32 v83, v83
    v_smfmac_f32_16x16x64_bf16 v[12:15], v[6:9], v[52:59], v11
    s_add_u32 m0, s69, 73728
    s_add_u32 s75, s69, 139264
    buffer_load_dwordx4 v4, s[56:59], s75 offen sc1 lds
    v_exp_f32 v84, v84
    v_exp_f32 v85, v85
    v_perm_b32 v52, v77, v76, s98
    v_perm_b32 v53, v79, v78, s98
    v_perm_b32 v54, v81, v80, s98
    v_perm_b32 v55, v83, v82, s98
    v_exp_f32 v86, v86
    v_exp_f32 v87, v87
    v_perm_b32 v56, v85, v84, s98
    v_exp_f32 v88, v88
    v_exp_f32 v89, v89
    v_perm_b32 v57, v87, v86, s98
    v_exp_f32 v90, v90
    v_exp_f32 v91, v91
    v_perm_b32 v58, v89, v88, s98
    v_perm_b32 v59, v91, v90, s98
    s_setprio 1
    v_mfma_f32_32x32x16_bf16 v[76:91], v[40:43], v[36:39], 0
    ds_read_b128 v[40:43], v124 offset:8192
    v_exp_f32 v60, v60
    v_exp_f32 v61, v61
    v_exp_f32 v62, v62
    v_exp_f32 v63, v63
    v_smfmac_f32_32x32x32_bf16 v[108:123], v[44:47], v[52:59], v10
    ds_read_b128 v[44:47], v124 offset:7168
    v_exp_f32 v64, v64
    v_exp_f32 v65, v65
    v_exp_f32 v66, v66
    v_exp_f32 v67, v67
    v_smfmac_f32_16x16x64_bf16 v[16:19], v[6:9], v[52:59], v11
    s_add_u32 m0, s69, 81920
    s_add_u32 s75, s69, 147456
    buffer_load_dwordx4 v4, s[56:59], s75 offen sc1 lds
    v_exp_f32 v68, v68
    v_exp_f32 v69, v69
    v_perm_b32 v52, v61, v60, s98
    v_perm_b32 v53, v63, v62, s98
    v_perm_b32 v54, v65, v64, s98
    v_perm_b32 v55, v67, v66, s98
    v_exp_f32 v70, v70
    v_exp_f32 v71, v71
    s_add_u32 m0, s83, 4096
    s_add_u32 s75, s86, 32768
    buffer_load_dwordx4 v2, s[44:47], s75 offen lds
    s_add_u32 m0, s83, 5120
    s_add_u32 s75, s84, 32768
    buffer_load_dwordx4 v2, s[44:47], s75 offen lds
    v_perm_b32 v56, v69, v68, s98
    v_exp_f32 v72, v72
    v_exp_f32 v73, v73
    v_perm_b32 v57, v71, v70, s98
    v_exp_f32 v74, v74
    v_exp_f32 v75, v75
    v_perm_b32 v58, v73, v72, s98
    v_perm_b32 v59, v75, v74, s98
    s_waitcnt lgkmcnt(1)
    v_mfma_f32_32x32x16_bf16 v[60:75], v[40:43], v[32:35], 0
    v_exp_f32 v76, v76
    v_exp_f32 v77, v77
    v_exp_f32 v78, v78
    v_exp_f32 v79, v79
    s_waitcnt lgkmcnt(0)
    v_smfmac_f32_32x32x32_bf16 v[92:107], v[44:47], v[52:59], v10
    v_exp_f32 v80, v80
    v_exp_f32 v81, v81
    v_exp_f32 v82, v82
    v_exp_f32 v83, v83
    v_smfmac_f32_16x16x64_bf16 v[12:15], v[6:9], v[52:59], v11
    s_add_u32 m0, s69, 90112
    s_add_u32 s75, s69, 155648
    buffer_load_dwordx4 v4, s[56:59], s75 offen sc1 lds
    v_exp_f32 v84, v84
    v_exp_f32 v85, v85
    v_perm_b32 v52, v77, v76, s98
    v_perm_b32 v53, v79, v78, s98
    v_perm_b32 v54, v81, v80, s98
    v_perm_b32 v55, v83, v82, s98
    v_exp_f32 v86, v86
    v_exp_f32 v87, v87
    s_waitcnt vmcnt(10)
    ds_read_b64_tr_b16 v[192:193], v25 offset:0
    ds_read_b64_tr_b16 v[194:195], v25 offset:512
    s_waitcnt vmcnt(9)
    ds_read_b64_tr_b16 v[196:197], v25 offset:1024
    ds_read_b64_tr_b16 v[198:199], v25 offset:1536
    v_perm_b32 v56, v85, v84, s98
    v_exp_f32 v88, v88
    v_exp_f32 v89, v89
    v_perm_b32 v57, v87, v86, s98
    v_exp_f32 v90, v90
    v_exp_f32 v91, v91
    v_perm_b32 v58, v89, v88, s98
    v_perm_b32 v59, v91, v90, s98
    v_mfma_f32_32x32x16_bf16 v[76:91], v[40:43], v[36:39], 0
    ds_read_b128 v[40:43], v124 offset:10240
    v_exp_f32 v60, v60
    v_exp_f32 v61, v61
    v_exp_f32 v62, v62
    v_exp_f32 v63, v63
    v_smfmac_f32_32x32x32_bf16 v[108:123], v[44:47], v[52:59], v10
    ds_read_b128 v[44:47], v124 offset:9216
    v_exp_f32 v64, v64
    v_exp_f32 v65, v65
    v_exp_f32 v66, v66
    v_exp_f32 v67, v67
    v_smfmac_f32_16x16x64_bf16 v[16:19], v[6:9], v[52:59], v11
    v_exp_f32 v68, v68
    v_exp_f32 v69, v69
    v_perm_b32 v52, v61, v60, s98
    v_perm_b32 v53, v63, v62, s98
    v_perm_b32 v54, v65, v64, s98
    v_perm_b32 v55, v67, v66, s98
    v_exp_f32 v70, v70
    v_exp_f32 v71, v71
    s_add_u32 m0, s83, 6144
    s_add_u32 s75, s86, 49152
    buffer_load_dwordx4 v2, s[44:47], s75 offen lds
    s_add_u32 m0, s83, 7168
    s_add_u32 s75, s84, 49152
    buffer_load_dwordx4 v2, s[44:47], s75 offen lds
    v_perm_b32 v56, v69, v68, s98
    v_exp_f32 v72, v72
    v_exp_f32 v73, v73
    v_perm_b32 v57, v71, v70, s98
    v_exp_f32 v74, v74
    v_exp_f32 v75, v75
    v_perm_b32 v58, v73, v72, s98
    v_perm_b32 v59, v75, v74, s98
    s_waitcnt lgkmcnt(1)
    v_mfma_f32_32x32x16_bf16 v[60:75], v[40:43], v[32:35], 0
    v_exp_f32 v76, v76
    v_exp_f32 v77, v77
    v_exp_f32 v78, v78
    v_exp_f32 v79, v79
    s_waitcnt lgkmcnt(0)
    v_smfmac_f32_32x32x32_bf16 v[92:107], v[44:47], v[52:59], v10
    v_exp_f32 v80, v80
    v_exp_f32 v81, v81
    v_exp_f32 v82, v82
    v_exp_f32 v83, v83
    v_smfmac_f32_16x16x64_bf16 v[12:15], v[6:9], v[52:59], v11
    v_exp_f32 v84, v84
    v_exp_f32 v85, v85
    v_perm_b32 v52, v77, v76, s98
    v_perm_b32 v53, v79, v78, s98
    v_perm_b32 v54, v81, v80, s98
    v_perm_b32 v55, v83, v82, s98
    v_exp_f32 v86, v86
    v_exp_f32 v87, v87
    s_waitcnt vmcnt(8)
    ds_read_b64_tr_b16 v[200:201], v25 offset:2048
    ds_read_b64_tr_b16 v[202:203], v25 offset:2560
    s_waitcnt vmcnt(7)
    ds_read_b64_tr_b16 v[204:205], v25 offset:3072
    ds_read_b64_tr_b16 v[206:207], v25 offset:3584
    v_perm_b32 v56, v85, v84, s98
    v_exp_f32 v88, v88
    v_exp_f32 v89, v89
    v_perm_b32 v57, v87, v86, s98
    v_exp_f32 v90, v90
    v_exp_f32 v91, v91
    v_perm_b32 v58, v89, v88, s98
    v_perm_b32 v59, v91, v90, s98
    s_setprio 0
    v_mfma_f32_32x32x16_bf16 v[76:91], v[40:43], v[36:39], 0
    ds_read_b128 v[40:43], v124 offset:12288
    v_exp_f32 v60, v60
    v_exp_f32 v61, v61
    v_exp_f32 v62, v62
    v_exp_f32 v63, v63
    v_smfmac_f32_32x32x32_bf16 v[108:123], v[44:47], v[52:59], v10
    ds_read_b128 v[44:47], v124 offset:11264
    v_exp_f32 v64, v64
    v_exp_f32 v65, v65
    v_exp_f32 v66, v66
    v_exp_f32 v67, v67
    v_smfmac_f32_16x16x64_bf16 v[16:19], v[6:9], v[52:59], v11
    v_exp_f32 v68, v68
    v_exp_f32 v69, v69
    v_perm_b32 v52, v61, v60, s98
    v_perm_b32 v53, v63, v62, s98
    v_perm_b32 v54, v65, v64, s98
    v_perm_b32 v55, v67, v66, s98
    v_exp_f32 v70, v70
    v_exp_f32 v71, v71
    s_add_u32 m0, s83, 0
    s_add_u32 s75, s86, 65536
    buffer_load_dwordx4 v2, s[44:47], s75 offen lds
    s_add_u32 m0, s83, 1024
    s_add_u32 s75, s84, 65536
    buffer_load_dwordx4 v2, s[44:47], s75 offen lds
    v_perm_b32 v56, v69, v68, s98
    v_exp_f32 v72, v72
    v_exp_f32 v73, v73
    v_perm_b32 v57, v71, v70, s98
    v_exp_f32 v74, v74
    v_exp_f32 v75, v75
    v_perm_b32 v58, v73, v72, s98
    v_perm_b32 v59, v75, v74, s98
    s_waitcnt lgkmcnt(1)
    v_mfma_f32_32x32x16_bf16 v[60:75], v[40:43], v[32:35], 0
    v_exp_f32 v76, v76
    v_exp_f32 v77, v77
    v_exp_f32 v78, v78
    v_exp_f32 v79, v79
    s_waitcnt lgkmcnt(0)
    v_smfmac_f32_32x32x32_bf16 v[92:107], v[44:47], v[52:59], v10
    v_exp_f32 v80, v80
    v_exp_f32 v81, v81
    v_exp_f32 v82, v82
    v_exp_f32 v83, v83
    v_smfmac_f32_16x16x64_bf16 v[12:15], v[6:9], v[52:59], v11
    v_exp_f32 v84, v84
    v_exp_f32 v85, v85
    v_perm_b32 v52, v77, v76, s98
    v_perm_b32 v53, v79, v78, s98
    v_perm_b32 v54, v81, v80, s98
    v_perm_b32 v55, v83, v82, s98
    v_exp_f32 v86, v86
    v_exp_f32 v87, v87
    s_waitcnt vmcnt(6)
    ds_read_b64_tr_b16 v[208:209], v25 offset:4096
    ds_read_b64_tr_b16 v[210:211], v25 offset:4608
    s_waitcnt vmcnt(5)
    ds_read_b64_tr_b16 v[212:213], v25 offset:5120
    ds_read_b64_tr_b16 v[214:215], v25 offset:5632
    v_perm_b32 v56, v85, v84, s98
    v_exp_f32 v88, v88
    v_exp_f32 v89, v89
    v_perm_b32 v57, v87, v86, s98
    v_exp_f32 v90, v90
    v_exp_f32 v91, v91
    v_perm_b32 v58, v89, v88, s98
    v_perm_b32 v59, v91, v90, s98
    v_mfma_f32_32x32x16_bf16 v[76:91], v[40:43], v[36:39], 0
    ds_read_b128 v[40:43], v124 offset:14336
    v_exp_f32 v60, v60
    v_exp_f32 v61, v61
    v_exp_f32 v62, v62
    v_exp_f32 v63, v63
    v_smfmac_f32_32x32x32_bf16 v[108:123], v[44:47], v[52:59], v10
    ds_read_b128 v[44:47], v124 offset:13312
    v_exp_f32 v64, v64
    v_exp_f32 v65, v65
    v_exp_f32 v66, v66
    v_exp_f32 v67, v67
    v_smfmac_f32_16x16x64_bf16 v[16:19], v[6:9], v[52:59], v11
    v_exp_f32 v68, v68
    v_exp_f32 v69, v69
    v_perm_b32 v52, v61, v60, s98
    v_perm_b32 v53, v63, v62, s98
    v_perm_b32 v54, v65, v64, s98
    v_perm_b32 v55, v67, v66, s98
    v_exp_f32 v70, v70
    v_exp_f32 v71, v71
    s_add_u32 m0, s83, 2048
    s_add_u32 s75, s86, 81920
    buffer_load_dwordx4 v2, s[44:47], s75 offen lds
    s_add_u32 m0, s83, 3072
    s_add_u32 s75, s84, 81920
    buffer_load_dwordx4 v2, s[44:47], s75 offen lds
    v_perm_b32 v56, v69, v68, s98
    v_exp_f32 v72, v72
    v_exp_f32 v73, v73
    v_perm_b32 v57, v71, v70, s98
    v_exp_f32 v74, v74
    v_exp_f32 v75, v75
    v_perm_b32 v58, v73, v72, s98
    v_perm_b32 v59, v75, v74, s98
    s_waitcnt lgkmcnt(1)
    v_mfma_f32_32x32x16_bf16 v[60:75], v[40:43], v[32:35], 0
    v_exp_f32 v76, v76
    v_exp_f32 v77, v77
    v_exp_f32 v78, v78
    v_exp_f32 v79, v79
    s_waitcnt lgkmcnt(0)
    v_smfmac_f32_32x32x32_bf16 v[92:107], v[44:47], v[52:59], v10
    v_exp_f32 v80, v80
    v_exp_f32 v81, v81
    v_exp_f32 v82, v82
    v_exp_f32 v83, v83
    v_smfmac_f32_16x16x64_bf16 v[12:15], v[6:9], v[52:59], v11
    v_exp_f32 v84, v84
    v_exp_f32 v85, v85
    v_perm_b32 v52, v77, v76, s98
    v_perm_b32 v53, v79, v78, s98
    v_perm_b32 v54, v81, v80, s98
    v_perm_b32 v55, v83, v82, s98
    v_exp_f32 v86, v86
    v_exp_f32 v87, v87
    s_waitcnt vmcnt(5)
    ds_read_b64_tr_b16 v[216:217], v25 offset:6144
    ds_read_b64_tr_b16 v[218:219], v25 offset:6656
    s_waitcnt vmcnt(4)
    ds_read_b64_tr_b16 v[220:221], v25 offset:7168
    ds_read_b64_tr_b16 v[222:223], v25 offset:7680
    v_perm_b32 v56, v85, v84, s98
    v_exp_f32 v88, v88
    v_exp_f32 v89, v89
    v_perm_b32 v57, v87, v86, s98
    v_exp_f32 v90, v90
    v_exp_f32 v91, v91
    v_perm_b32 v58, v89, v88, s98
    v_perm_b32 v59, v91, v90, s98
    s_barrier
    s_setprio 3
    v_mfma_f32_32x32x16_bf16 v[76:91], v[40:43], v[36:39], 0
    ds_read_b128 v[40:43], v124 offset:32768
    v_exp_f32 v60, v60
    v_exp_f32 v61, v61
    v_exp_f32 v62, v62
    v_exp_f32 v63, v63
    v_smfmac_f32_32x32x32_bf16 v[108:123], v[44:47], v[52:59], v10
    ds_read_b128 v[44:47], v124 offset:15360
    v_exp_f32 v64, v64
    v_exp_f32 v65, v65
    v_exp_f32 v66, v66
    v_exp_f32 v67, v67
    v_smfmac_f32_16x16x64_bf16 v[16:19], v[6:9], v[52:59], v11
    v_exp_f32 v68, v68
    v_exp_f32 v69, v69
    v_perm_b32 v52, v61, v60, s98
    v_perm_b32 v53, v63, v62, s98
    v_perm_b32 v54, v65, v64, s98
    v_perm_b32 v55, v67, v66, s98
    v_exp_f32 v70, v70
    v_exp_f32 v71, v71
    s_add_u32 m0, s83, 4096
    s_add_u32 s75, s86, 98304
    buffer_load_dwordx4 v2, s[44:47], s75 offen lds
    s_add_u32 m0, s83, 5120
    s_add_u32 s75, s84, 98304
    buffer_load_dwordx4 v2, s[44:47], s75 offen lds
    v_perm_b32 v56, v69, v68, s98
    v_exp_f32 v72, v72
    v_exp_f32 v73, v73
    v_perm_b32 v57, v71, v70, s98
    v_exp_f32 v74, v74
    v_exp_f32 v75, v75
    v_perm_b32 v58, v73, v72, s98
    v_perm_b32 v59, v75, v74, s98
    s_waitcnt lgkmcnt(1)
    v_mfma_f32_32x32x16_bf16 v[60:75], v[40:43], v[32:35], 0
    v_exp_f32 v76, v76
    v_exp_f32 v77, v77
    v_exp_f32 v78, v78
    v_exp_f32 v79, v79
    s_waitcnt lgkmcnt(0)
    v_smfmac_f32_32x32x32_bf16 v[92:107], v[44:47], v[52:59], v10
    v_exp_f32 v80, v80
    v_exp_f32 v81, v81
    v_exp_f32 v82, v82
    v_exp_f32 v83, v83
    v_smfmac_f32_16x16x64_bf16 v[12:15], v[6:9], v[52:59], v11
    v_exp_f32 v84, v84
    v_exp_f32 v85, v85
    v_perm_b32 v52, v77, v76, s98
    v_perm_b32 v53, v79, v78, s98
    v_perm_b32 v54, v81, v80, s98
    v_perm_b32 v55, v83, v82, s98
    v_exp_f32 v86, v86
    v_exp_f32 v87, v87
    s_waitcnt vmcnt(5)
    ds_read_b64_tr_b16 v[224:225], v25 offset:0
    ds_read_b64_tr_b16 v[226:227], v25 offset:512
    s_waitcnt vmcnt(4)
    ds_read_b64_tr_b16 v[228:229], v25 offset:1024
    ds_read_b64_tr_b16 v[230:231], v25 offset:1536
    v_perm_b32 v56, v85, v84, s98
    v_exp_f32 v88, v88
    v_exp_f32 v89, v89
    v_perm_b32 v57, v87, v86, s98
    v_exp_f32 v90, v90
    v_exp_f32 v91, v91
    v_perm_b32 v58, v89, v88, s98
    v_perm_b32 v59, v91, v90, s98
    v_mfma_f32_32x32x16_bf16 v[76:91], v[40:43], v[36:39], 0
    ds_read_b128 v[40:43], v124 offset:34816
    v_exp_f32 v60, v60
    v_exp_f32 v61, v61
    v_exp_f32 v62, v62
    v_exp_f32 v63, v63
    v_smfmac_f32_32x32x32_bf16 v[108:123], v[44:47], v[52:59], v10
    ds_read_b128 v[44:47], v124 offset:33792
    v_exp_f32 v64, v64
    v_exp_f32 v65, v65
    v_exp_f32 v66, v66
    v_exp_f32 v67, v67
    v_smfmac_f32_16x16x64_bf16 v[16:19], v[6:9], v[52:59], v11
    v_exp_f32 v68, v68
    v_exp_f32 v69, v69
    v_perm_b32 v52, v61, v60, s98
    v_perm_b32 v53, v63, v62, s98
    v_perm_b32 v54, v65, v64, s98
    v_perm_b32 v55, v67, v66, s98
    v_exp_f32 v70, v70
    v_exp_f32 v71, v71
    s_add_u32 m0, s83, 6144
    s_add_u32 s75, s86, 114688
    buffer_load_dwordx4 v2, s[44:47], s75 offen lds
    s_add_u32 m0, s83, 7168
    s_add_u32 s75, s84, 114688
    buffer_load_dwordx4 v2, s[44:47], s75 offen lds
    v_perm_b32 v56, v69, v68, s98
    v_exp_f32 v72, v72
    v_exp_f32 v73, v73
    v_perm_b32 v57, v71, v70, s98
    v_exp_f32 v74, v74
    v_exp_f32 v75, v75
    v_perm_b32 v58, v73, v72, s98
    v_perm_b32 v59, v75, v74, s98
    s_waitcnt lgkmcnt(1)
    v_mfma_f32_32x32x16_bf16 v[60:75], v[40:43], v[32:35], 0
    v_exp_f32 v76, v76
    v_exp_f32 v77, v77
    v_exp_f32 v78, v78
    v_exp_f32 v79, v79
    s_waitcnt lgkmcnt(0)
    v_smfmac_f32_32x32x32_bf16 v[92:107], v[44:47], v[52:59], v10
    v_exp_f32 v80, v80
    v_exp_f32 v81, v81
    v_exp_f32 v82, v82
    v_exp_f32 v83, v83
    v_smfmac_f32_16x16x64_bf16 v[12:15], v[6:9], v[52:59], v11
    v_exp_f32 v84, v84
    v_exp_f32 v85, v85
    v_perm_b32 v52, v77, v76, s98
    v_perm_b32 v53, v79, v78, s98
    v_perm_b32 v54, v81, v80, s98
    v_perm_b32 v55, v83, v82, s98
    v_exp_f32 v86, v86
    v_exp_f32 v87, v87
    s_waitcnt vmcnt(5)
    ds_read_b64_tr_b16 v[232:233], v25 offset:2048
    ds_read_b64_tr_b16 v[234:235], v25 offset:2560
    s_waitcnt vmcnt(4)
    ds_read_b64_tr_b16 v[236:237], v25 offset:3072
    ds_read_b64_tr_b16 v[238:239], v25 offset:3584
    v_perm_b32 v56, v85, v84, s98
    v_exp_f32 v88, v88
    v_exp_f32 v89, v89
    v_perm_b32 v57, v87, v86, s98
    v_exp_f32 v90, v90
    v_exp_f32 v91, v91
    v_perm_b32 v58, v89, v88, s98
    v_perm_b32 v59, v91, v90, s98
    s_setprio 2
    v_mfma_f32_32x32x16_bf16 v[76:91], v[40:43], v[36:39], 0
    ds_read_b128 v[40:43], v124 offset:36864
    v_exp_f32 v60, v60
    v_exp_f32 v61, v61
    v_exp_f32 v62, v62
    v_exp_f32 v63, v63
    v_smfmac_f32_32x32x32_bf16 v[108:123], v[44:47], v[52:59], v10
    ds_read_b128 v[44:47], v124 offset:35840
    v_exp_f32 v64, v64
    v_exp_f32 v65, v65
    v_exp_f32 v66, v66
    v_exp_f32 v67, v67
    v_smfmac_f32_16x16x64_bf16 v[16:19], v[6:9], v[52:59], v11
    v_exp_f32 v68, v68
    v_exp_f32 v69, v69
    v_perm_b32 v52, v61, v60, s98
    v_perm_b32 v53, v63, v62, s98
    v_perm_b32 v54, v65, v64, s98
    v_perm_b32 v55, v67, v66, s98
    v_exp_f32 v70, v70
    v_exp_f32 v71, v71
    s_add_u32 m0, s83, 0
    s_add_u32 s75, s94, 0
    buffer_load_dwordx4 v3, s[48:51], s75 offen lds
    s_add_u32 m0, s83, 1024
    s_add_u32 s75, s94, 44032
    buffer_load_dwordx4 v3, s[48:51], s75 offen lds
    v_perm_b32 v56, v69, v68, s98
    v_exp_f32 v72, v72
    v_exp_f32 v73, v73
    v_perm_b32 v57, v71, v70, s98
    v_exp_f32 v74, v74
    v_exp_f32 v75, v75
    v_perm_b32 v58, v73, v72, s98
    v_perm_b32 v59, v75, v74, s98
    s_waitcnt lgkmcnt(1)
    v_mfma_f32_32x32x16_bf16 v[60:75], v[40:43], v[32:35], 0
    v_exp_f32 v76, v76
    v_exp_f32 v77, v77
    v_exp_f32 v78, v78
    v_exp_f32 v79, v79
    s_waitcnt lgkmcnt(0)
    v_smfmac_f32_32x32x32_bf16 v[92:107], v[44:47], v[52:59], v10
    v_exp_f32 v80, v80
    v_exp_f32 v81, v81
    v_exp_f32 v82, v82
    v_exp_f32 v83, v83
    v_smfmac_f32_16x16x64_bf16 v[12:15], v[6:9], v[52:59], v11
    v_exp_f32 v84, v84
    v_exp_f32 v85, v85
    v_perm_b32 v52, v77, v76, s98
    v_perm_b32 v53, v79, v78, s98
    v_perm_b32 v54, v81, v80, s98
    v_perm_b32 v55, v83, v82, s98
    v_exp_f32 v86, v86
    v_exp_f32 v87, v87
    s_waitcnt vmcnt(5)
    ds_read_b64_tr_b16 v[240:241], v25 offset:4096
    ds_read_b64_tr_b16 v[242:243], v25 offset:4608
    s_waitcnt vmcnt(4)
    ds_read_b64_tr_b16 v[244:245], v25 offset:5120
    ds_read_b64_tr_b16 v[246:247], v25 offset:5632
    v_perm_b32 v56, v85, v84, s98
    v_exp_f32 v88, v88
    v_exp_f32 v89, v89
    v_perm_b32 v57, v87, v86, s98
    v_exp_f32 v90, v90
    v_exp_f32 v91, v91
    v_perm_b32 v58, v89, v88, s98
    v_perm_b32 v59, v91, v90, s98
    v_mfma_f32_32x32x16_bf16 v[76:91], v[40:43], v[36:39], 0
    ds_read_b128 v[40:43], v124 offset:38912
    v_exp_f32 v60, v60
    v_exp_f32 v61, v61
    v_exp_f32 v62, v62
    v_exp_f32 v63, v63
    v_smfmac_f32_32x32x32_bf16 v[108:123], v[44:47], v[52:59], v10
    ds_read_b128 v[44:47], v124 offset:37888
    v_exp_f32 v64, v64
    v_exp_f32 v65, v65
    v_exp_f32 v66, v66
    v_exp_f32 v67, v67
    v_smfmac_f32_16x16x64_bf16 v[16:19], v[6:9], v[52:59], v11
    v_exp_f32 v68, v68
    v_exp_f32 v69, v69
    v_perm_b32 v52, v61, v60, s98
    v_perm_b32 v53, v63, v62, s98
    v_perm_b32 v54, v65, v64, s98
    v_perm_b32 v55, v67, v66, s98
    v_exp_f32 v70, v70
    v_exp_f32 v71, v71
    s_add_u32 m0, s83, 2048
    s_add_u32 s75, s94, 88064
    buffer_load_dwordx4 v3, s[48:51], s75 offen lds
    s_add_u32 m0, s83, 3072
    s_add_u32 s75, s94, 132096
    buffer_load_dwordx4 v3, s[48:51], s75 offen lds
    v_perm_b32 v56, v69, v68, s98
    v_exp_f32 v72, v72
    v_exp_f32 v73, v73
    v_perm_b32 v57, v71, v70, s98
    v_exp_f32 v74, v74
    v_exp_f32 v75, v75
    v_perm_b32 v58, v73, v72, s98
    v_perm_b32 v59, v75, v74, s98
    s_waitcnt lgkmcnt(1)
    v_mfma_f32_32x32x16_bf16 v[60:75], v[40:43], v[32:35], 0
    v_exp_f32 v76, v76
    v_exp_f32 v77, v77
    v_exp_f32 v78, v78
    v_exp_f32 v79, v79
    s_waitcnt lgkmcnt(0)
    v_smfmac_f32_32x32x32_bf16 v[92:107], v[44:47], v[52:59], v10
    v_exp_f32 v80, v80
    v_exp_f32 v81, v81
    v_exp_f32 v82, v82
    v_exp_f32 v83, v83
    v_smfmac_f32_16x16x64_bf16 v[12:15], v[6:9], v[52:59], v11
    v_exp_f32 v84, v84
    v_exp_f32 v85, v85
    v_perm_b32 v52, v77, v76, s98
    v_perm_b32 v53, v79, v78, s98
    v_perm_b32 v54, v81, v80, s98
    v_perm_b32 v55, v83, v82, s98
    v_exp_f32 v86, v86
    v_exp_f32 v87, v87
    s_waitcnt vmcnt(5)
    ds_read_b64_tr_b16 v[248:249], v25 offset:6144
    ds_read_b64_tr_b16 v[250:251], v25 offset:6656
    s_waitcnt vmcnt(4)
    ds_read_b64_tr_b16 v[252:253], v25 offset:7168
    ds_read_b64_tr_b16 v[254:255], v25 offset:7680
    v_perm_b32 v56, v85, v84, s98
    v_exp_f32 v88, v88
    v_exp_f32 v89, v89
    v_perm_b32 v57, v87, v86, s98
    v_exp_f32 v90, v90
    v_exp_f32 v91, v91
    v_perm_b32 v58, v89, v88, s98
    v_perm_b32 v59, v91, v90, s98
    s_setprio 1
    v_mfma_f32_32x32x16_bf16 v[76:91], v[40:43], v[36:39], 0
    ds_read_b128 v[40:43], v124 offset:40960
    v_exp_f32 v60, v60
    v_exp_f32 v61, v61
    v_exp_f32 v62, v62
    v_exp_f32 v63, v63
    v_smfmac_f32_32x32x32_bf16 v[108:123], v[44:47], v[52:59], v10
    ds_read_b128 v[44:47], v124 offset:39936
    v_exp_f32 v64, v64
    v_exp_f32 v65, v65
    v_exp_f32 v66, v66
    v_exp_f32 v67, v67
    v_smfmac_f32_16x16x64_bf16 v[16:19], v[6:9], v[52:59], v11
    v_exp_f32 v68, v68
    v_exp_f32 v69, v69
    v_perm_b32 v52, v61, v60, s98
    v_perm_b32 v53, v63, v62, s98
    v_perm_b32 v54, v65, v64, s98
    v_perm_b32 v55, v67, v66, s98
    v_exp_f32 v70, v70
    v_exp_f32 v71, v71
    s_add_u32 m0, s83, 4096
    s_add_u32 s75, s94, 176128
    buffer_load_dwordx4 v3, s[48:51], s75 offen lds
    s_add_u32 m0, s83, 5120
    s_add_u32 s75, s94, 220160
    buffer_load_dwordx4 v3, s[48:51], s75 offen lds
    v_perm_b32 v56, v69, v68, s98
    v_exp_f32 v72, v72
    v_exp_f32 v73, v73
    v_perm_b32 v57, v71, v70, s98
    v_exp_f32 v74, v74
    v_exp_f32 v75, v75
    v_perm_b32 v58, v73, v72, s98
    v_perm_b32 v59, v75, v74, s98
    s_waitcnt lgkmcnt(1)
    v_mfma_f32_32x32x16_bf16 v[60:75], v[40:43], v[32:35], 0
    v_exp_f32 v76, v76
    v_exp_f32 v77, v77
    v_exp_f32 v78, v78
    v_exp_f32 v79, v79
    s_waitcnt lgkmcnt(0)
    v_smfmac_f32_32x32x32_bf16 v[92:107], v[44:47], v[52:59], v10
    v_exp_f32 v80, v80
    v_exp_f32 v81, v81
    v_exp_f32 v82, v82
    v_exp_f32 v83, v83
    v_smfmac_f32_16x16x64_bf16 v[12:15], v[6:9], v[52:59], v11
    v_exp_f32 v84, v84
    v_exp_f32 v85, v85
    v_perm_b32 v52, v77, v76, s98
    v_perm_b32 v53, v79, v78, s98
    v_perm_b32 v54, v81, v80, s98
    v_perm_b32 v55, v83, v82, s98
    v_exp_f32 v86, v86
    v_exp_f32 v87, v87
    s_waitcnt vmcnt(5)
    ds_read_b64_tr_b16 v[128:129], v24 offset:0
    ds_read_b64_tr_b16 v[130:131], v24 offset:512
    s_waitcnt vmcnt(4)
    ds_read_b64_tr_b16 v[132:133], v24 offset:1024
    ds_read_b64_tr_b16 v[134:135], v24 offset:1536
    v_perm_b32 v56, v85, v84, s98
    v_exp_f32 v88, v88
    v_exp_f32 v89, v89
    v_perm_b32 v57, v87, v86, s98
    v_exp_f32 v90, v90
    v_exp_f32 v91, v91
    v_perm_b32 v58, v89, v88, s98
    v_perm_b32 v59, v91, v90, s98
    v_mfma_f32_32x32x16_bf16 v[76:91], v[40:43], v[36:39], 0
    ds_read_b128 v[40:43], v124 offset:43008
    v_exp_f32 v60, v60
    v_exp_f32 v61, v61
    v_exp_f32 v62, v62
    v_exp_f32 v63, v63
    v_smfmac_f32_32x32x32_bf16 v[108:123], v[44:47], v[52:59], v10
    ds_read_b128 v[44:47], v124 offset:41984
    v_exp_f32 v64, v64
    v_exp_f32 v65, v65
    v_exp_f32 v66, v66
    v_exp_f32 v67, v67
    v_smfmac_f32_16x16x64_bf16 v[16:19], v[6:9], v[52:59], v11
    v_exp_f32 v68, v68
    v_exp_f32 v69, v69
    v_perm_b32 v52, v61, v60, s98
    v_perm_b32 v53, v63, v62, s98
    v_perm_b32 v54, v65, v64, s98
    v_perm_b32 v55, v67, v66, s98
    v_exp_f32 v70, v70
    v_exp_f32 v71, v71
    s_add_u32 m0, s83, 6144
    s_add_u32 s75, s94, 264192
    buffer_load_dwordx4 v3, s[48:51], s75 offen lds
    s_add_u32 m0, s83, 7168
    s_add_u32 s75, s94, 308224
    buffer_load_dwordx4 v3, s[48:51], s75 offen lds
    v_perm_b32 v56, v69, v68, s98
    v_exp_f32 v72, v72
    v_exp_f32 v73, v73
    v_perm_b32 v57, v71, v70, s98
    v_exp_f32 v74, v74
    v_exp_f32 v75, v75
    v_perm_b32 v58, v73, v72, s98
    v_perm_b32 v59, v75, v74, s98
    s_waitcnt lgkmcnt(1)
    v_mfma_f32_32x32x16_bf16 v[60:75], v[40:43], v[32:35], 0
    v_exp_f32 v76, v76
    v_exp_f32 v77, v77
    v_exp_f32 v78, v78
    v_exp_f32 v79, v79
    s_waitcnt lgkmcnt(0)
    v_smfmac_f32_32x32x32_bf16 v[92:107], v[44:47], v[52:59], v10
    v_exp_f32 v80, v80
    v_exp_f32 v81, v81
    v_exp_f32 v82, v82
    v_exp_f32 v83, v83
    v_smfmac_f32_16x16x64_bf16 v[12:15], v[6:9], v[52:59], v11
    v_exp_f32 v84, v84
    v_exp_f32 v85, v85
    v_perm_b32 v52, v77, v76, s98
    v_perm_b32 v53, v79, v78, s98
    v_perm_b32 v54, v81, v80, s98
    v_perm_b32 v55, v83, v82, s98
    v_exp_f32 v86, v86
    v_exp_f32 v87, v87
    s_waitcnt vmcnt(5)
    ds_read_b64_tr_b16 v[136:137], v24 offset:2048
    ds_read_b64_tr_b16 v[138:139], v24 offset:2560
    s_waitcnt vmcnt(4)
    ds_read_b64_tr_b16 v[140:141], v24 offset:3072
    ds_read_b64_tr_b16 v[142:143], v24 offset:3584
    v_perm_b32 v56, v85, v84, s98
    v_exp_f32 v88, v88
    v_exp_f32 v89, v89
    v_perm_b32 v57, v87, v86, s98
    v_exp_f32 v90, v90
    v_exp_f32 v91, v91
    v_perm_b32 v58, v89, v88, s98
    v_perm_b32 v59, v91, v90, s98
    s_setprio 0
    v_mfma_f32_32x32x16_bf16 v[76:91], v[40:43], v[36:39], 0
    ds_read_b128 v[40:43], v124 offset:45056
    v_exp_f32 v60, v60
    v_exp_f32 v61, v61
    v_exp_f32 v62, v62
    v_exp_f32 v63, v63
    v_smfmac_f32_32x32x32_bf16 v[108:123], v[44:47], v[52:59], v10
    ds_read_b128 v[44:47], v124 offset:44032
    v_exp_f32 v64, v64
    v_exp_f32 v65, v65
    v_exp_f32 v66, v66
    v_exp_f32 v67, v67
    v_smfmac_f32_16x16x64_bf16 v[16:19], v[6:9], v[52:59], v11
    v_exp_f32 v68, v68
    v_exp_f32 v69, v69
    v_perm_b32 v52, v61, v60, s98
    v_perm_b32 v53, v63, v62, s98
    v_perm_b32 v54, v65, v64, s98
    v_perm_b32 v55, v67, v66, s98
    v_exp_f32 v70, v70
    v_exp_f32 v71, v71
    s_add_u32 m0, s83, 0
    s_add_u32 s75, s94, 352256
    buffer_load_dwordx4 v3, s[48:51], s75 offen lds
    s_add_u32 m0, s83, 1024
    s_add_u32 s75, s94, 396288
    buffer_load_dwordx4 v3, s[48:51], s75 offen lds
    v_perm_b32 v56, v69, v68, s98
    v_exp_f32 v72, v72
    v_exp_f32 v73, v73
    v_perm_b32 v57, v71, v70, s98
    v_exp_f32 v74, v74
    v_exp_f32 v75, v75
    v_perm_b32 v58, v73, v72, s98
    v_perm_b32 v59, v75, v74, s98
    s_waitcnt lgkmcnt(1)
    v_mfma_f32_32x32x16_bf16 v[60:75], v[40:43], v[32:35], 0
    v_exp_f32 v76, v76
    v_exp_f32 v77, v77
    v_exp_f32 v78, v78
    v_exp_f32 v79, v79
    s_waitcnt lgkmcnt(0)
    v_smfmac_f32_32x32x32_bf16 v[92:107], v[44:47], v[52:59], v10
    v_exp_f32 v80, v80
    v_exp_f32 v81, v81
    v_exp_f32 v82, v82
    v_exp_f32 v83, v83
    v_smfmac_f32_16x16x64_bf16 v[12:15], v[6:9], v[52:59], v11
    v_exp_f32 v84, v84
    v_exp_f32 v85, v85
    v_perm_b32 v52, v77, v76, s98
    v_perm_b32 v53, v79, v78, s98
    v_perm_b32 v54, v81, v80, s98
    v_perm_b32 v55, v83, v82, s98
    v_exp_f32 v86, v86
    v_exp_f32 v87, v87
    s_waitcnt vmcnt(5)
    ds_read_b64_tr_b16 v[144:145], v24 offset:4096
    ds_read_b64_tr_b16 v[146:147], v24 offset:4608
    s_waitcnt vmcnt(4)
    ds_read_b64_tr_b16 v[148:149], v24 offset:5120
    ds_read_b64_tr_b16 v[150:151], v24 offset:5632
    v_perm_b32 v56, v85, v84, s98
    v_exp_f32 v88, v88
    v_exp_f32 v89, v89
    v_perm_b32 v57, v87, v86, s98
    v_exp_f32 v90, v90
    v_exp_f32 v91, v91
    v_perm_b32 v58, v89, v88, s98
    v_perm_b32 v59, v91, v90, s98
    v_mfma_f32_32x32x16_bf16 v[76:91], v[40:43], v[36:39], 0
    ds_read_b128 v[40:43], v124 offset:47104
    v_exp_f32 v60, v60
    v_exp_f32 v61, v61
    v_exp_f32 v62, v62
    v_exp_f32 v63, v63
    v_smfmac_f32_32x32x32_bf16 v[108:123], v[44:47], v[52:59], v10
    ds_read_b128 v[44:47], v124 offset:46080
    v_exp_f32 v64, v64
    v_exp_f32 v65, v65
    v_exp_f32 v66, v66
    v_exp_f32 v67, v67
    v_smfmac_f32_16x16x64_bf16 v[16:19], v[6:9], v[52:59], v11
    v_exp_f32 v68, v68
    v_exp_f32 v69, v69
    v_perm_b32 v52, v61, v60, s98
    v_perm_b32 v53, v63, v62, s98
    v_perm_b32 v54, v65, v64, s98
    v_perm_b32 v55, v67, v66, s98
    v_exp_f32 v70, v70
    v_exp_f32 v71, v71
    s_add_u32 m0, s83, 2048
    s_add_u32 s75, s94, 440320
    buffer_load_dwordx4 v3, s[48:51], s75 offen lds
    s_add_u32 m0, s83, 3072
    s_add_u32 s75, s94, 484352
    buffer_load_dwordx4 v3, s[48:51], s75 offen lds
    v_perm_b32 v56, v69, v68, s98
    v_exp_f32 v72, v72
    v_exp_f32 v73, v73
    v_perm_b32 v57, v71, v70, s98
    v_exp_f32 v74, v74
    v_exp_f32 v75, v75
    v_perm_b32 v58, v73, v72, s98
    v_perm_b32 v59, v75, v74, s98
    s_waitcnt lgkmcnt(1)
    v_mfma_f32_32x32x16_bf16 v[60:75], v[40:43], v[32:35], 0
    v_exp_f32 v76, v76
    v_exp_f32 v77, v77
    v_exp_f32 v78, v78
    v_exp_f32 v79, v79
    s_waitcnt lgkmcnt(0)
    v_smfmac_f32_32x32x32_bf16 v[92:107], v[44:47], v[52:59], v10
    v_exp_f32 v80, v80
    v_exp_f32 v81, v81
    v_exp_f32 v82, v82
    v_exp_f32 v83, v83
    v_smfmac_f32_16x16x64_bf16 v[12:15], v[6:9], v[52:59], v11
    v_exp_f32 v84, v84
    v_exp_f32 v85, v85
    v_perm_b32 v52, v77, v76, s98
    v_perm_b32 v53, v79, v78, s98
    v_perm_b32 v54, v81, v80, s98
    v_perm_b32 v55, v83, v82, s98
    v_exp_f32 v86, v86
    v_exp_f32 v87, v87
    s_waitcnt vmcnt(5)
    ds_read_b64_tr_b16 v[152:153], v24 offset:6144
    ds_read_b64_tr_b16 v[154:155], v24 offset:6656
    s_waitcnt vmcnt(4)
    ds_read_b64_tr_b16 v[156:157], v24 offset:7168
    ds_read_b64_tr_b16 v[158:159], v24 offset:7680
    v_perm_b32 v56, v85, v84, s98
    v_exp_f32 v88, v88
    v_exp_f32 v89, v89
    v_perm_b32 v57, v87, v86, s98
    v_exp_f32 v90, v90
    v_exp_f32 v91, v91
    v_perm_b32 v58, v89, v88, s98
    v_perm_b32 v59, v91, v90, s98
    s_barrier
    s_setprio 3
    v_mfma_f32_32x32x16_bf16 v[76:91], v[40:43], v[36:39], 0
    ds_read_b128 v[40:43], v125 offset:0
    v_exp_f32 v60, v60
    v_exp_f32 v61, v61
    v_exp_f32 v62, v62
    v_exp_f32 v63, v63
    v_smfmac_f32_32x32x32_bf16 v[108:123], v[44:47], v[52:59], v10
    ds_read_b128 v[44:47], v124 offset:48128
    v_exp_f32 v64, v64
    v_exp_f32 v65, v65
    v_exp_f32 v66, v66
    v_exp_f32 v67, v67
    v_smfmac_f32_16x16x64_bf16 v[16:19], v[6:9], v[52:59], v11
    s_add_u32 m0, s69, 0
    s_add_u32 s75, s69, 163840
    buffer_load_dwordx4 v4, s[56:59], s75 offen sc1 lds
    v_exp_f32 v68, v68
    v_exp_f32 v69, v69
    v_perm_b32 v52, v61, v60, s98
    v_perm_b32 v53, v63, v62, s98
    v_perm_b32 v54, v65, v64, s98
    v_perm_b32 v55, v67, v66, s98
    v_exp_f32 v70, v70
    v_exp_f32 v71, v71
    s_add_u32 m0, s83, 4096
    s_add_u32 s75, s94, 528384
    buffer_load_dwordx4 v3, s[48:51], s75 offen lds
    s_add_u32 m0, s83, 5120
    s_add_u32 s75, s94, 572416
    buffer_load_dwordx4 v3, s[48:51], s75 offen lds
    v_perm_b32 v56, v69, v68, s98
    v_exp_f32 v72, v72
    v_exp_f32 v73, v73
    v_perm_b32 v57, v71, v70, s98
    v_exp_f32 v74, v74
    v_exp_f32 v75, v75
    v_perm_b32 v58, v73, v72, s98
    v_perm_b32 v59, v75, v74, s98
    s_waitcnt lgkmcnt(1)
    v_mfma_f32_32x32x16_bf16 v[60:75], v[40:43], v[32:35], 0
    v_exp_f32 v76, v76
    v_exp_f32 v77, v77
    v_exp_f32 v78, v78
    v_exp_f32 v79, v79
    s_waitcnt lgkmcnt(0)
    v_smfmac_f32_32x32x32_bf16 v[92:107], v[44:47], v[52:59], v10
    v_exp_f32 v80, v80
    v_exp_f32 v81, v81
    v_exp_f32 v82, v82
    v_exp_f32 v83, v83
    v_smfmac_f32_16x16x64_bf16 v[12:15], v[6:9], v[52:59], v11
    s_add_u32 m0, s69, 8192
    s_add_u32 s75, s69, 172032
    buffer_load_dwordx4 v4, s[56:59], s75 offen sc1 lds
    v_exp_f32 v84, v84
    v_exp_f32 v85, v85
    v_perm_b32 v52, v77, v76, s98
    v_perm_b32 v53, v79, v78, s98
    v_perm_b32 v54, v81, v80, s98
    v_perm_b32 v55, v83, v82, s98
    v_exp_f32 v86, v86
    v_exp_f32 v87, v87
    s_waitcnt vmcnt(7)
    ds_read_b64_tr_b16 v[160:161], v24 offset:0
    ds_read_b64_tr_b16 v[162:163], v24 offset:512
    s_waitcnt vmcnt(6)
    ds_read_b64_tr_b16 v[164:165], v24 offset:1024
    ds_read_b64_tr_b16 v[166:167], v24 offset:1536
    v_perm_b32 v56, v85, v84, s98
    v_exp_f32 v88, v88
    v_exp_f32 v89, v89
    v_perm_b32 v57, v87, v86, s98
    v_exp_f32 v90, v90
    v_exp_f32 v91, v91
    v_perm_b32 v58, v89, v88, s98
    v_perm_b32 v59, v91, v90, s98
    v_mfma_f32_32x32x16_bf16 v[76:91], v[40:43], v[36:39], 0
    ds_read_b128 v[40:43], v125 offset:2048
    v_exp_f32 v60, v60
    v_exp_f32 v61, v61
    v_exp_f32 v62, v62
    v_exp_f32 v63, v63
    v_smfmac_f32_32x32x32_bf16 v[108:123], v[44:47], v[52:59], v10
    ds_read_b128 v[44:47], v125 offset:1024
    v_exp_f32 v64, v64
    v_exp_f32 v65, v65
    v_exp_f32 v66, v66
    v_exp_f32 v67, v67
    v_smfmac_f32_16x16x64_bf16 v[16:19], v[6:9], v[52:59], v11
    s_add_u32 m0, s69, 16384
    s_add_u32 s75, s69, 180224
    buffer_load_dwordx4 v4, s[56:59], s75 offen sc1 lds
    v_exp_f32 v68, v68
    v_exp_f32 v69, v69
    v_perm_b32 v52, v61, v60, s98
    v_perm_b32 v53, v63, v62, s98
    v_perm_b32 v54, v65, v64, s98
    v_perm_b32 v55, v67, v66, s98
    v_exp_f32 v70, v70
    v_exp_f32 v71, v71
    s_add_u32 m0, s83, 6144
    s_add_u32 s75, s94, 616448
    buffer_load_dwordx4 v3, s[48:51], s75 offen lds
    s_add_u32 m0, s83, 7168
    s_add_u32 s75, s94, 660480
    buffer_load_dwordx4 v3, s[48:51], s75 offen lds
    v_perm_b32 v56, v69, v68, s98
    v_exp_f32 v72, v72
    v_exp_f32 v73, v73
    v_perm_b32 v57, v71, v70, s98
    v_exp_f32 v74, v74
    v_exp_f32 v75, v75
    v_perm_b32 v58, v73, v72, s98
    v_perm_b32 v59, v75, v74, s98
    s_waitcnt lgkmcnt(1)
    v_mfma_f32_32x32x16_bf16 v[60:75], v[40:43], v[32:35], 0
    v_exp_f32 v76, v76
    v_exp_f32 v77, v77
    v_exp_f32 v78, v78
    v_exp_f32 v79, v79
    s_waitcnt lgkmcnt(0)
    v_smfmac_f32_32x32x32_bf16 v[92:107], v[44:47], v[52:59], v10
    v_exp_f32 v80, v80
    v_exp_f32 v81, v81
    v_exp_f32 v82, v82
    v_exp_f32 v83, v83
    v_smfmac_f32_16x16x64_bf16 v[12:15], v[6:9], v[52:59], v11
    s_add_u32 m0, s69, 24576
    s_add_u32 s75, s69, 188416
    buffer_load_dwordx4 v4, s[56:59], s75 offen sc1 lds
    v_exp_f32 v84, v84
    v_exp_f32 v85, v85
    v_perm_b32 v52, v77, v76, s98
    v_perm_b32 v53, v79, v78, s98
    v_perm_b32 v54, v81, v80, s98
    v_perm_b32 v55, v83, v82, s98
    v_exp_f32 v86, v86
    v_exp_f32 v87, v87
    s_waitcnt vmcnt(9)
    ds_read_b64_tr_b16 v[168:169], v24 offset:2048
    ds_read_b64_tr_b16 v[170:171], v24 offset:2560
    s_waitcnt vmcnt(8)
    ds_read_b64_tr_b16 v[172:173], v24 offset:3072
    ds_read_b64_tr_b16 v[174:175], v24 offset:3584
    v_perm_b32 v56, v85, v84, s98
    v_exp_f32 v88, v88
    v_exp_f32 v89, v89
    v_perm_b32 v57, v87, v86, s98
    v_exp_f32 v90, v90
    v_exp_f32 v91, v91
    v_perm_b32 v58, v89, v88, s98
    v_perm_b32 v59, v91, v90, s98
    s_setprio 2
    v_mfma_f32_32x32x16_bf16 v[76:91], v[40:43], v[36:39], 0
    ds_read_b128 v[40:43], v125 offset:4096
    v_exp_f32 v60, v60
    v_exp_f32 v61, v61
    v_exp_f32 v62, v62
    v_exp_f32 v63, v63
    v_smfmac_f32_32x32x32_bf16 v[108:123], v[44:47], v[52:59], v10
    ds_read_b128 v[44:47], v125 offset:3072
    v_exp_f32 v64, v64
    v_exp_f32 v65, v65
    v_exp_f32 v66, v66
    v_exp_f32 v67, v67
    v_smfmac_f32_16x16x64_bf16 v[16:19], v[6:9], v[52:59], v11
    v_exp_f32 v68, v68
    v_exp_f32 v69, v69
    v_perm_b32 v52, v61, v60, s98
    v_perm_b32 v53, v63, v62, s98
    v_perm_b32 v54, v65, v64, s98
    v_perm_b32 v55, v67, v66, s98
    v_exp_f32 v70, v70
    v_exp_f32 v71, v71
    v_perm_b32 v56, v69, v68, s98
    v_exp_f32 v72, v72
    v_exp_f32 v73, v73
    v_perm_b32 v57, v71, v70, s98
    v_exp_f32 v74, v74
    v_exp_f32 v75, v75
    v_perm_b32 v58, v73, v72, s98
    v_perm_b32 v59, v75, v74, s98
    s_waitcnt lgkmcnt(1)
    v_mfma_f32_32x32x16_bf16 v[60:75], v[40:43], v[32:35], 0
    v_exp_f32 v76, v76
    v_exp_f32 v77, v77
    v_exp_f32 v78, v78
    v_exp_f32 v79, v79
    s_waitcnt lgkmcnt(0)
    v_smfmac_f32_32x32x32_bf16 v[92:107], v[44:47], v[52:59], v10
    v_exp_f32 v80, v80
    v_exp_f32 v81, v81
    v_exp_f32 v82, v82
    v_exp_f32 v83, v83
    v_smfmac_f32_16x16x64_bf16 v[12:15], v[6:9], v[52:59], v11
    v_exp_f32 v84, v84
    v_exp_f32 v85, v85
    v_perm_b32 v52, v77, v76, s98
    v_perm_b32 v53, v79, v78, s98
    v_perm_b32 v54, v81, v80, s98
    v_perm_b32 v55, v83, v82, s98
    v_exp_f32 v86, v86
    v_exp_f32 v87, v87
    s_waitcnt vmcnt(6)
    ds_read_b64_tr_b16 v[176:177], v24 offset:4096
    ds_read_b64_tr_b16 v[178:179], v24 offset:4608
    s_waitcnt vmcnt(5)
    ds_read_b64_tr_b16 v[180:181], v24 offset:5120
    ds_read_b64_tr_b16 v[182:183], v24 offset:5632
    v_perm_b32 v56, v85, v84, s98
    v_exp_f32 v88, v88
    v_exp_f32 v89, v89
    v_perm_b32 v57, v87, v86, s98
    v_exp_f32 v90, v90
    v_exp_f32 v91, v91
    v_perm_b32 v58, v89, v88, s98
    v_perm_b32 v59, v91, v90, s98
    s_add_u32 s72, s89, s80
    s_lshl_b32 s72, s72, 6
    v_mov_b32 v28, s72
    s_lshl_b32 s72, s65, 7
    v_mov_b32 v29, s72
    global_load_dword v26, v28, s[18:19]
    global_load_dword v26, v29, s[22:23]
    v_mfma_f32_32x32x16_bf16 v[76:91], v[40:43], v[36:39], 0
    ds_read_b128 v[40:43], v125 offset:6144
    v_exp_f32 v60, v60
    v_exp_f32 v61, v61
    v_exp_f32 v62, v62
    v_exp_f32 v63, v63
    v_smfmac_f32_32x32x32_bf16 v[108:123], v[44:47], v[52:59], v10
    ds_read_b128 v[44:47], v125 offset:5120
    v_exp_f32 v64, v64
    v_exp_f32 v65, v65
    v_exp_f32 v66, v66
    v_exp_f32 v67, v67
    v_smfmac_f32_16x16x64_bf16 v[16:19], v[6:9], v[52:59], v11
    s_add_u32 s75, s74, 0
    buffer_load_dword v26, v30, s[48:51], s75 offen
    v_exp_f32 v68, v68
    v_exp_f32 v69, v69
    v_perm_b32 v52, v61, v60, s98
    v_perm_b32 v53, v63, v62, s98
    v_perm_b32 v54, v65, v64, s98
    v_perm_b32 v55, v67, v66, s98
    v_exp_f32 v70, v70
    v_exp_f32 v71, v71
    v_perm_b32 v56, v69, v68, s98
    v_exp_f32 v72, v72
    v_exp_f32 v73, v73
    v_perm_b32 v57, v71, v70, s98
    v_exp_f32 v74, v74
    v_exp_f32 v75, v75
    v_perm_b32 v58, v73, v72, s98
    v_perm_b32 v59, v75, v74, s98
    s_waitcnt lgkmcnt(1)
    v_mfma_f32_32x32x16_bf16 v[60:75], v[40:43], v[32:35], 0
    v_exp_f32 v76, v76
    v_exp_f32 v77, v77
    v_exp_f32 v78, v78
    v_exp_f32 v79, v79
    s_waitcnt lgkmcnt(0)
    v_smfmac_f32_32x32x32_bf16 v[92:107], v[44:47], v[52:59], v10
    v_exp_f32 v80, v80
    v_exp_f32 v81, v81
    v_exp_f32 v82, v82
    v_exp_f32 v83, v83
    v_smfmac_f32_16x16x64_bf16 v[12:15], v[6:9], v[52:59], v11
    buffer_load_dwordx2 v[48:49], v27, s[32:35], s68 offen
    v_exp_f32 v84, v84
    v_exp_f32 v85, v85
    v_perm_b32 v52, v77, v76, s98
    v_perm_b32 v53, v79, v78, s98
    v_perm_b32 v54, v81, v80, s98
    v_perm_b32 v55, v83, v82, s98
    v_exp_f32 v86, v86
    v_exp_f32 v87, v87
    s_waitcnt vmcnt(6)
    ds_read_b64_tr_b16 v[184:185], v24 offset:6144
    ds_read_b64_tr_b16 v[186:187], v24 offset:6656
    s_waitcnt vmcnt(5)
    ds_read_b64_tr_b16 v[188:189], v24 offset:7168
    ds_read_b64_tr_b16 v[190:191], v24 offset:7680
    v_perm_b32 v56, v85, v84, s98
    v_exp_f32 v88, v88
    v_exp_f32 v89, v89
    v_perm_b32 v57, v87, v86, s98
    v_exp_f32 v90, v90
    v_exp_f32 v91, v91
    v_perm_b32 v58, v89, v88, s98
    v_perm_b32 v59, v91, v90, s98
    s_setprio 1
    v_mfma_f32_32x32x16_bf16 v[76:91], v[40:43], v[36:39], 0
    ds_read_b128 v[40:43], v125 offset:8192
    v_exp_f32 v60, v60
    v_exp_f32 v61, v61
    v_exp_f32 v62, v62
    v_exp_f32 v63, v63
    v_smfmac_f32_32x32x32_bf16 v[108:123], v[44:47], v[52:59], v10
    ds_read_b128 v[44:47], v125 offset:7168
    v_exp_f32 v64, v64
    v_exp_f32 v65, v65
    v_exp_f32 v66, v66
    v_exp_f32 v67, v67
    v_smfmac_f32_16x16x64_bf16 v[16:19], v[6:9], v[52:59], v11
    buffer_load_dwordx2 v[50:51], v27, s[32:35], s68 offen offset:16
    v_exp_f32 v68, v68
    v_exp_f32 v69, v69
    v_perm_b32 v52, v61, v60, s98
    v_perm_b32 v53, v63, v62, s98
    v_perm_b32 v54, v65, v64, s98
    v_perm_b32 v55, v67, v66, s98
    v_exp_f32 v70, v70
    v_exp_f32 v71, v71
    v_perm_b32 v56, v69, v68, s98
    v_exp_f32 v72, v72
    v_exp_f32 v73, v73
    v_perm_b32 v57, v71, v70, s98
    v_exp_f32 v74, v74
    v_exp_f32 v75, v75
    v_perm_b32 v58, v73, v72, s98
    v_perm_b32 v59, v75, v74, s98
    s_waitcnt lgkmcnt(1)
    v_mfma_f32_32x32x16_bf16 v[60:75], v[40:43], v[32:35], 0
    v_exp_f32 v76, v76
    v_exp_f32 v77, v77
    v_exp_f32 v78, v78
    v_exp_f32 v79, v79
    s_waitcnt lgkmcnt(0)
    v_smfmac_f32_32x32x32_bf16 v[92:107], v[44:47], v[52:59], v10
    v_exp_f32 v80, v80
    v_exp_f32 v81, v81
    v_exp_f32 v82, v82
    v_exp_f32 v83, v83
    v_smfmac_f32_16x16x64_bf16 v[12:15], v[6:9], v[52:59], v11
    s_add_u32 s75, s73, 0
    buffer_load_dword v26, v30, s[52:55], s75 offen
    v_exp_f32 v84, v84
    v_exp_f32 v85, v85
    v_perm_b32 v52, v77, v76, s98
    v_perm_b32 v53, v79, v78, s98
    v_perm_b32 v54, v81, v80, s98
    v_perm_b32 v55, v83, v82, s98
    v_exp_f32 v86, v86
    v_exp_f32 v87, v87
    v_perm_b32 v56, v85, v84, s98
    v_exp_f32 v88, v88
    v_exp_f32 v89, v89
    v_perm_b32 v57, v87, v86, s98
    v_exp_f32 v90, v90
    v_exp_f32 v91, v91
    v_perm_b32 v58, v89, v88, s98
    v_perm_b32 v59, v91, v90, s98
    v_mfma_f32_32x32x16_bf16 v[76:91], v[40:43], v[36:39], 0
    ds_read_b128 v[40:43], v125 offset:10240
    v_exp_f32 v60, v60
    v_exp_f32 v61, v61
    v_exp_f32 v62, v62
    v_exp_f32 v63, v63
    v_smfmac_f32_32x32x32_bf16 v[108:123], v[44:47], v[52:59], v10
    ds_read_b128 v[44:47], v125 offset:9216
    v_exp_f32 v64, v64
    v_exp_f32 v65, v65
    v_exp_f32 v66, v66
    v_exp_f32 v67, v67
    v_smfmac_f32_16x16x64_bf16 v[16:19], v[6:9], v[52:59], v11
    s_add_u32 s75, s73, 32768
    buffer_load_dword v26, v30, s[52:55], s75 offen
    v_exp_f32 v68, v68
    v_exp_f32 v69, v69
    v_perm_b32 v52, v61, v60, s98
    v_perm_b32 v53, v63, v62, s98
    v_perm_b32 v54, v65, v64, s98
    v_perm_b32 v55, v67, v66, s98
    v_exp_f32 v70, v70
    v_exp_f32 v71, v71
    v_perm_b32 v56, v69, v68, s98
    v_exp_f32 v72, v72
    v_exp_f32 v73, v73
    v_perm_b32 v57, v71, v70, s98
    v_exp_f32 v74, v74
    v_exp_f32 v75, v75
    v_perm_b32 v58, v73, v72, s98
    v_perm_b32 v59, v75, v74, s98
    s_waitcnt lgkmcnt(1)
    v_mfma_f32_32x32x16_bf16 v[60:75], v[40:43], v[32:35], 0
    v_exp_f32 v76, v76
    v_exp_f32 v77, v77
    v_exp_f32 v78, v78
    v_exp_f32 v79, v79
    s_waitcnt lgkmcnt(0)
    v_smfmac_f32_32x32x32_bf16 v[92:107], v[44:47], v[52:59], v10
    v_exp_f32 v80, v80
    v_exp_f32 v81, v81
    v_exp_f32 v82, v82
    v_exp_f32 v83, v83
    v_smfmac_f32_16x16x64_bf16 v[12:15], v[6:9], v[52:59], v11
    v_exp_f32 v84, v84
    v_exp_f32 v85, v85
    v_perm_b32 v52, v77, v76, s98
    v_perm_b32 v53, v79, v78, s98
    v_perm_b32 v54, v81, v80, s98
    v_perm_b32 v55, v83, v82, s98
    v_exp_f32 v86, v86
    v_exp_f32 v87, v87
    v_perm_b32 v56, v85, v84, s98
    v_exp_f32 v88, v88
    v_exp_f32 v89, v89
    v_perm_b32 v57, v87, v86, s98
    v_exp_f32 v90, v90
    v_exp_f32 v91, v91
    v_perm_b32 v58, v89, v88, s98
    v_perm_b32 v59, v91, v90, s98
    s_setprio 0
    v_mfma_f32_32x32x16_bf16 v[76:91], v[40:43], v[36:39], 0
    ds_read_b128 v[40:43], v125 offset:12288
    v_exp_f32 v60, v60
    v_exp_f32 v61, v61
    v_exp_f32 v62, v62
    v_exp_f32 v63, v63
    v_smfmac_f32_32x32x32_bf16 v[108:123], v[44:47], v[52:59], v10
    ds_read_b128 v[44:47], v125 offset:11264
    v_exp_f32 v64, v64
    v_exp_f32 v65, v65
    v_exp_f32 v66, v66
    v_exp_f32 v67, v67
    v_smfmac_f32_16x16x64_bf16 v[16:19], v[6:9], v[52:59], v11
    v_exp_f32 v68, v68
    v_exp_f32 v69, v69
    v_perm_b32 v52, v61, v60, s98
    v_perm_b32 v53, v63, v62, s98
    v_perm_b32 v54, v65, v64, s98
    v_perm_b32 v55, v67, v66, s98
    v_exp_f32 v70, v70
    v_exp_f32 v71, v71
    v_perm_b32 v56, v69, v68, s98
    v_exp_f32 v72, v72
    v_exp_f32 v73, v73
    v_perm_b32 v57, v71, v70, s98
    v_exp_f32 v74, v74
    v_exp_f32 v75, v75
    v_perm_b32 v58, v73, v72, s98
    v_perm_b32 v59, v75, v74, s98
    s_waitcnt lgkmcnt(1)
    v_mfma_f32_32x32x16_bf16 v[60:75], v[40:43], v[32:35], 0
    v_exp_f32 v76, v76
    v_exp_f32 v77, v77
    v_exp_f32 v78, v78
    v_exp_f32 v79, v79
    s_waitcnt lgkmcnt(0)
    v_smfmac_f32_32x32x32_bf16 v[92:107], v[44:47], v[52:59], v10
    v_exp_f32 v80, v80
    v_exp_f32 v81, v81
    v_exp_f32 v82, v82
    v_exp_f32 v83, v83
    v_smfmac_f32_16x16x64_bf16 v[12:15], v[6:9], v[52:59], v11
    v_exp_f32 v84, v84
    v_exp_f32 v85, v85
    v_perm_b32 v52, v77, v76, s98
    v_perm_b32 v53, v79, v78, s98
    v_perm_b32 v54, v81, v80, s98
    v_perm_b32 v55, v83, v82, s98
    v_exp_f32 v86, v86
    v_exp_f32 v87, v87
    v_perm_b32 v56, v85, v84, s98
    v_exp_f32 v88, v88
    v_exp_f32 v89, v89
    v_perm_b32 v57, v87, v86, s98
    v_exp_f32 v90, v90
    v_exp_f32 v91, v91
    v_perm_b32 v58, v89, v88, s98
    v_perm_b32 v59, v91, v90, s98
    v_mfma_f32_32x32x16_bf16 v[76:91], v[40:43], v[36:39], 0
    ds_read_b128 v[40:43], v125 offset:14336
    v_exp_f32 v60, v60
    v_exp_f32 v61, v61
    v_exp_f32 v62, v62
    v_exp_f32 v63, v63
    v_smfmac_f32_32x32x32_bf16 v[108:123], v[44:47], v[52:59], v10
    ds_read_b128 v[44:47], v125 offset:13312
    v_exp_f32 v64, v64
    v_exp_f32 v65, v65
    v_exp_f32 v66, v66
    v_exp_f32 v67, v67
    v_smfmac_f32_16x16x64_bf16 v[16:19], v[6:9], v[52:59], v11
    v_exp_f32 v68, v68
    v_exp_f32 v69, v69
    v_perm_b32 v52, v61, v60, s98
    v_perm_b32 v53, v63, v62, s98
    v_perm_b32 v54, v65, v64, s98
    v_perm_b32 v55, v67, v66, s98
    v_exp_f32 v70, v70
    v_exp_f32 v71, v71
    v_perm_b32 v56, v69, v68, s98
    v_exp_f32 v72, v72
    v_exp_f32 v73, v73
    v_perm_b32 v57, v71, v70, s98
    v_exp_f32 v74, v74
    v_exp_f32 v75, v75
    v_perm_b32 v58, v73, v72, s98
    v_perm_b32 v59, v75, v74, s98
    s_waitcnt lgkmcnt(1)
    v_mfma_f32_32x32x16_bf16 v[60:75], v[40:43], v[32:35], 0
    v_exp_f32 v76, v76
    v_exp_f32 v77, v77
    v_exp_f32 v78, v78
    v_exp_f32 v79, v79
    s_waitcnt lgkmcnt(0)
    v_smfmac_f32_32x32x32_bf16 v[92:107], v[44:47], v[52:59], v10
    v_exp_f32 v80, v80
    v_exp_f32 v81, v81
    v_exp_f32 v82, v82
    v_exp_f32 v83, v83
    v_smfmac_f32_16x16x64_bf16 v[12:15], v[6:9], v[52:59], v11
    v_exp_f32 v84, v84
    v_exp_f32 v85, v85
    v_perm_b32 v52, v77, v76, s98
    v_perm_b32 v53, v79, v78, s98
    v_perm_b32 v54, v81, v80, s98
    v_perm_b32 v55, v83, v82, s98
    v_exp_f32 v86, v86
    v_exp_f32 v87, v87
    v_perm_b32 v56, v85, v84, s98
    v_exp_f32 v88, v88
    v_exp_f32 v89, v89
    v_perm_b32 v57, v87, v86, s98
    v_exp_f32 v90, v90
    v_exp_f32 v91, v91
    v_perm_b32 v58, v89, v88, s98
    v_perm_b32 v59, v91, v90, s98
    s_waitcnt vmcnt(7)
    s_waitcnt lgkmcnt(0)
    s_barrier
    s_setprio 3
    v_mfma_f32_32x32x16_bf16 v[76:91], v[40:43], v[36:39], 0
    ds_read_b128 v[40:43], v124 offset:0
    v_exp_f32 v60, v60
    v_exp_f32 v61, v61
    v_exp_f32 v62, v62
    v_exp_f32 v63, v63
    v_smfmac_f32_32x32x32_bf16 v[108:123], v[44:47], v[52:59], v10
    ds_read_b128 v[44:47], v125 offset:15360
    v_exp_f32 v64, v64
    v_exp_f32 v65, v65
    v_exp_f32 v66, v66
    v_exp_f32 v67, v67
    v_smfmac_f32_16x16x64_bf16 v[16:19], v[6:9], v[52:59], v11
    s_add_u32 m0, s69, 114688
    s_add_u32 s75, s87, 704512
    buffer_load_dwordx4 v3, s[48:51], s75 offen lds
    v_exp_f32 v68, v68
    v_exp_f32 v69, v69
    v_perm_b32 v52, v61, v60, s98
    v_perm_b32 v53, v63, v62, s98
    v_perm_b32 v54, v65, v64, s98
    v_perm_b32 v55, v67, v66, s98
    v_exp_f32 v70, v70
    v_exp_f32 v71, v71
    v_perm_b32 v56, v69, v68, s98
    v_exp_f32 v72, v72
    v_exp_f32 v73, v73
    v_perm_b32 v57, v71, v70, s98
    v_exp_f32 v74, v74
    v_exp_f32 v75, v75
    v_perm_b32 v58, v73, v72, s98
    v_perm_b32 v59, v75, v74, s98
    s_waitcnt lgkmcnt(1)
    v_mfma_f32_32x32x16_bf16 v[60:75], v[40:43], v[32:35], 0
    v_exp_f32 v76, v76
    v_exp_f32 v77, v77
    v_exp_f32 v78, v78
    v_exp_f32 v79, v79
    s_waitcnt lgkmcnt(0)
    v_smfmac_f32_32x32x32_bf16 v[92:107], v[44:47], v[52:59], v10
    v_exp_f32 v80, v80
    v_exp_f32 v81, v81
    v_exp_f32 v82, v82
    v_exp_f32 v83, v83
    v_smfmac_f32_16x16x64_bf16 v[12:15], v[6:9], v[52:59], v11
    s_add_u32 m0, s69, 122880
    s_add_u32 s75, s87, 704576
    buffer_load_dwordx4 v3, s[48:51], s75 offen lds
    v_exp_f32 v84, v84
    v_exp_f32 v85, v85
    v_perm_b32 v52, v77, v76, s98
    v_perm_b32 v53, v79, v78, s98
    v_perm_b32 v54, v81, v80, s98
    v_perm_b32 v55, v83, v82, s98
    v_exp_f32 v86, v86
    v_exp_f32 v87, v87
    v_perm_b32 v56, v85, v84, s98
    v_exp_f32 v88, v88
    v_exp_f32 v89, v89
    v_perm_b32 v57, v87, v86, s98
    v_exp_f32 v90, v90
    v_exp_f32 v91, v91
    v_perm_b32 v58, v89, v88, s98
    v_perm_b32 v59, v91, v90, s98
    v_mfma_f32_32x32x16_bf16 v[76:91], v[40:43], v[36:39], 0
    ds_read_b128 v[40:43], v124 offset:2048
    v_exp_f32 v60, v60
    v_exp_f32 v61, v61
    v_exp_f32 v62, v62
    v_exp_f32 v63, v63
    v_smfmac_f32_32x32x32_bf16 v[108:123], v[44:47], v[52:59], v10
    ds_read_b128 v[44:47], v124 offset:1024
    v_exp_f32 v64, v64
    v_exp_f32 v65, v65
    v_exp_f32 v66, v66
    v_exp_f32 v67, v67
    v_smfmac_f32_16x16x64_bf16 v[16:19], v[6:9], v[52:59], v11
    s_add_u32 m0, s69, 131072
    s_add_u32 s75, s87, 704640
    buffer_load_dwordx4 v3, s[48:51], s75 offen lds
    v_exp_f32 v68, v68
    v_exp_f32 v69, v69
    v_perm_b32 v52, v61, v60, s98
    v_perm_b32 v53, v63, v62, s98
    v_perm_b32 v54, v65, v64, s98
    v_perm_b32 v55, v67, v66, s98
    v_exp_f32 v70, v70
    v_exp_f32 v71, v71
    v_perm_b32 v56, v69, v68, s98
    v_exp_f32 v72, v72
    v_exp_f32 v73, v73
    v_perm_b32 v57, v71, v70, s98
    v_exp_f32 v74, v74
    v_exp_f32 v75, v75
    v_perm_b32 v58, v73, v72, s98
    v_perm_b32 v59, v75, v74, s98
    s_waitcnt lgkmcnt(1)
    v_mfma_f32_32x32x16_bf16 v[60:75], v[40:43], v[32:35], 0
    v_exp_f32 v76, v76
    v_exp_f32 v77, v77
    v_exp_f32 v78, v78
    v_exp_f32 v79, v79
    s_waitcnt lgkmcnt(0)
    v_smfmac_f32_32x32x32_bf16 v[92:107], v[44:47], v[52:59], v10
    v_exp_f32 v80, v80
    v_exp_f32 v81, v81
    v_exp_f32 v82, v82
    v_exp_f32 v83, v83
    v_smfmac_f32_16x16x64_bf16 v[12:15], v[6:9], v[52:59], v11
    s_add_u32 m0, s69, 139264
    s_add_u32 s75, s87, 704704
    buffer_load_dwordx4 v3, s[48:51], s75 offen lds
    v_exp_f32 v84, v84
    v_exp_f32 v85, v85
    v_perm_b32 v52, v77, v76, s98
    v_perm_b32 v53, v79, v78, s98
    v_perm_b32 v54, v81, v80, s98
    v_perm_b32 v55, v83, v82, s98
    v_exp_f32 v86, v86
    v_exp_f32 v87, v87
    v_perm_b32 v56, v85, v84, s98
    v_exp_f32 v88, v88
    v_exp_f32 v89, v89
    v_perm_b32 v57, v87, v86, s98
    v_exp_f32 v90, v90
    v_exp_f32 v91, v91
    v_perm_b32 v58, v89, v88, s98
    v_perm_b32 v59, v91, v90, s98
    s_setprio 2
    v_mfma_f32_32x32x16_bf16 v[76:91], v[40:43], v[36:39], 0
    ds_read_b128 v[40:43], v124 offset:4096
    v_exp_f32 v60, v60
    v_exp_f32 v61, v61
    v_exp_f32 v62, v62
    v_exp_f32 v63, v63
    v_smfmac_f32_32x32x32_bf16 v[108:123], v[44:47], v[52:59], v10
    ds_read_b128 v[44:47], v124 offset:3072
    v_exp_f32 v64, v64
    v_exp_f32 v65, v65
    v_exp_f32 v66, v66
    v_exp_f32 v67, v67
    v_smfmac_f32_16x16x64_bf16 v[16:19], v[6:9], v[52:59], v11
    s_add_u32 m0, s69, 147456
    s_add_u32 s75, s87, 704768
    buffer_load_dwordx4 v3, s[48:51], s75 offen lds
    v_exp_f32 v68, v68
    v_exp_f32 v69, v69
    v_perm_b32 v52, v61, v60, s98
    v_perm_b32 v53, v63, v62, s98
    v_perm_b32 v54, v65, v64, s98
    v_perm_b32 v55, v67, v66, s98
    v_exp_f32 v70, v70
    v_exp_f32 v71, v71
    v_perm_b32 v56, v69, v68, s98
    v_exp_f32 v72, v72
    v_exp_f32 v73, v73
    v_perm_b32 v57, v71, v70, s98
    v_exp_f32 v74, v74
    v_exp_f32 v75, v75
    v_perm_b32 v58, v73, v72, s98
    v_perm_b32 v59, v75, v74, s98
    s_waitcnt lgkmcnt(1)
    v_mfma_f32_32x32x16_bf16 v[60:75], v[40:43], v[32:35], 0
    v_exp_f32 v76, v76
    v_exp_f32 v77, v77
    v_exp_f32 v78, v78
    v_exp_f32 v79, v79
    s_waitcnt lgkmcnt(0)
    v_smfmac_f32_32x32x32_bf16 v[92:107], v[44:47], v[52:59], v10
    v_exp_f32 v80, v80
    v_exp_f32 v81, v81
    v_exp_f32 v82, v82
    v_exp_f32 v83, v83
    v_smfmac_f32_16x16x64_bf16 v[12:15], v[6:9], v[52:59], v11
    s_add_u32 m0, s69, 155648
    s_add_u32 s75, s87, 704832
    buffer_load_dwordx4 v3, s[48:51], s75 offen lds
    v_exp_f32 v84, v84
    v_exp_f32 v85, v85
    v_perm_b32 v52, v77, v76, s98
    v_perm_b32 v53, v79, v78, s98
    v_perm_b32 v54, v81, v80, s98
    v_perm_b32 v55, v83, v82, s98
    v_exp_f32 v86, v86
    v_exp_f32 v87, v87
    v_perm_b32 v56, v85, v84, s98
    v_exp_f32 v88, v88
    v_exp_f32 v89, v89
    v_perm_b32 v57, v87, v86, s98
    v_exp_f32 v90, v90
    v_exp_f32 v91, v91
    v_perm_b32 v58, v89, v88, s98
    v_perm_b32 v59, v91, v90, s98
    v_mfma_f32_32x32x16_bf16 v[76:91], v[40:43], v[36:39], 0
    ds_read_b128 v[40:43], v124 offset:6144
    v_exp_f32 v60, v60
    v_exp_f32 v61, v61
    v_exp_f32 v62, v62
    v_exp_f32 v63, v63
    v_smfmac_f32_32x32x32_bf16 v[108:123], v[44:47], v[52:59], v10
    ds_read_b128 v[44:47], v124 offset:5120
    v_exp_f32 v64, v64
    v_exp_f32 v65, v65
    v_exp_f32 v66, v66
    v_exp_f32 v67, v67
    v_smfmac_f32_16x16x64_bf16 v[16:19], v[6:9], v[52:59], v11
    s_add_u32 m0, s69, 49152
    s_add_u32 s75, s87, 1056768
    buffer_load_dwordx4 v3, s[48:51], s75 offen lds
    v_exp_f32 v68, v68
    v_exp_f32 v69, v69
    v_perm_b32 v52, v61, v60, s98
    v_perm_b32 v53, v63, v62, s98
    v_perm_b32 v54, v65, v64, s98
    v_perm_b32 v55, v67, v66, s98
    v_exp_f32 v70, v70
    v_exp_f32 v71, v71
    v_perm_b32 v56, v69, v68, s98
    v_exp_f32 v72, v72
    v_exp_f32 v73, v73
    v_perm_b32 v57, v71, v70, s98
    v_exp_f32 v74, v74
    v_exp_f32 v75, v75
    v_perm_b32 v58, v73, v72, s98
    v_perm_b32 v59, v75, v74, s98
    s_waitcnt lgkmcnt(1)
    v_mfma_f32_32x32x16_bf16 v[60:75], v[40:43], v[32:35], 0
    v_exp_f32 v76, v76
    v_exp_f32 v77, v77
    v_exp_f32 v78, v78
    v_exp_f32 v79, v79
    s_waitcnt lgkmcnt(0)
    v_smfmac_f32_32x32x32_bf16 v[92:107], v[44:47], v[52:59], v10
    v_exp_f32 v80, v80
    v_exp_f32 v81, v81
    v_exp_f32 v82, v82
    v_exp_f32 v83, v83
    v_smfmac_f32_16x16x64_bf16 v[12:15], v[6:9], v[52:59], v11
    s_add_u32 m0, s69, 57344
    s_add_u32 s75, s87, 1056832
    buffer_load_dwordx4 v3, s[48:51], s75 offen lds
    v_exp_f32 v84, v84
    v_exp_f32 v85, v85
    v_perm_b32 v52, v77, v76, s98
    v_perm_b32 v53, v79, v78, s98
    v_perm_b32 v54, v81, v80, s98
    v_perm_b32 v55, v83, v82, s98
    v_exp_f32 v86, v86
    v_exp_f32 v87, v87
    v_perm_b32 v56, v85, v84, s98
    v_exp_f32 v88, v88
    v_exp_f32 v89, v89
    v_perm_b32 v57, v87, v86, s98
    v_exp_f32 v90, v90
    v_exp_f32 v91, v91
    v_perm_b32 v58, v89, v88, s98
    v_perm_b32 v59, v91, v90, s98
    s_setprio 1
    v_mfma_f32_32x32x16_bf16 v[76:91], v[40:43], v[36:39], 0
    ds_read_b128 v[40:43], v124 offset:8192
    v_exp_f32 v60, v60
    v_exp_f32 v61, v61
    v_exp_f32 v62, v62
    v_exp_f32 v63, v63
    v_smfmac_f32_32x32x32_bf16 v[108:123], v[44:47], v[52:59], v10
    ds_read_b128 v[44:47], v124 offset:7168
    v_exp_f32 v64, v64
    v_exp_f32 v65, v65
    v_exp_f32 v66, v66
    v_exp_f32 v67, v67
    v_smfmac_f32_16x16x64_bf16 v[16:19], v[6:9], v[52:59], v11
    v_exp_f32 v68, v68
    v_exp_f32 v69, v69
    v_perm_b32 v52, v61, v60, s98
    v_perm_b32 v53, v63, v62, s98
    v_perm_b32 v54, v65, v64, s98
    v_perm_b32 v55, v67, v66, s98
    v_exp_f32 v70, v70
    v_exp_f32 v71, v71
    v_perm_b32 v56, v69, v68, s98
    v_exp_f32 v72, v72
    v_exp_f32 v73, v73
    v_perm_b32 v57, v71, v70, s98
    v_exp_f32 v74, v74
    v_exp_f32 v75, v75
    v_perm_b32 v58, v73, v72, s98
    v_perm_b32 v59, v75, v74, s98
    s_waitcnt lgkmcnt(1)
    v_mfma_f32_32x32x16_bf16 v[60:75], v[40:43], v[32:35], 0
    v_exp_f32 v76, v76
    v_exp_f32 v77, v77
    v_exp_f32 v78, v78
    v_exp_f32 v79, v79
    s_waitcnt lgkmcnt(0)
    v_smfmac_f32_32x32x32_bf16 v[92:107], v[44:47], v[52:59], v10
    v_exp_f32 v80, v80
    v_exp_f32 v81, v81
    v_exp_f32 v82, v82
    v_exp_f32 v83, v83
    v_smfmac_f32_16x16x64_bf16 v[12:15], v[6:9], v[52:59], v11
    v_exp_f32 v84, v84
    v_exp_f32 v85, v85
    v_perm_b32 v52, v77, v76, s98
    v_perm_b32 v53, v79, v78, s98
    v_perm_b32 v54, v81, v80, s98
    v_perm_b32 v55, v83, v82, s98
    v_exp_f32 v86, v86
    v_exp_f32 v87, v87
    v_perm_b32 v56, v85, v84, s98
    v_exp_f32 v88, v88
    v_exp_f32 v89, v89
    v_perm_b32 v57, v87, v86, s98
    v_exp_f32 v90, v90
    v_exp_f32 v91, v91
    v_perm_b32 v58, v89, v88, s98
    v_perm_b32 v59, v91, v90, s98
    v_mfma_f32_32x32x16_bf16 v[76:91], v[40:43], v[36:39], 0
    ds_read_b128 v[40:43], v124 offset:10240
    v_exp_f32 v60, v60
    v_exp_f32 v61, v61
    v_exp_f32 v62, v62
    v_exp_f32 v63, v63
    v_smfmac_f32_32x32x32_bf16 v[108:123], v[44:47], v[52:59], v10
    ds_read_b128 v[44:47], v124 offset:9216
    v_exp_f32 v64, v64
    v_exp_f32 v65, v65
    v_exp_f32 v66, v66
    v_exp_f32 v67, v67
    v_smfmac_f32_16x16x64_bf16 v[16:19], v[6:9], v[52:59], v11
    v_exp_f32 v68, v68
    v_exp_f32 v69, v69
    v_perm_b32 v52, v61, v60, s98
    v_perm_b32 v53, v63, v62, s98
    v_perm_b32 v54, v65, v64, s98
    v_perm_b32 v55, v67, v66, s98
    v_exp_f32 v70, v70
    v_exp_f32 v71, v71
    v_perm_b32 v56, v69, v68, s98
    v_exp_f32 v72, v72
    v_exp_f32 v73, v73
    v_perm_b32 v57, v71, v70, s98
    v_exp_f32 v74, v74
    v_exp_f32 v75, v75
    v_perm_b32 v58, v73, v72, s98
    v_perm_b32 v59, v75, v74, s98
    s_waitcnt lgkmcnt(1)
    v_mfma_f32_32x32x16_bf16 v[60:75], v[40:43], v[32:35], 0
    v_exp_f32 v76, v76
    v_exp_f32 v77, v77
    v_exp_f32 v78, v78
    v_exp_f32 v79, v79
    s_waitcnt lgkmcnt(0)
    v_smfmac_f32_32x32x32_bf16 v[92:107], v[44:47], v[52:59], v10
    v_exp_f32 v80, v80
    v_exp_f32 v81, v81
    v_exp_f32 v82, v82
    v_exp_f32 v83, v83
    v_smfmac_f32_16x16x64_bf16 v[12:15], v[6:9], v[52:59], v11
    v_exp_f32 v84, v84
    v_exp_f32 v85, v85
    v_perm_b32 v52, v77, v76, s98
    v_perm_b32 v53, v79, v78, s98
    v_perm_b32 v54, v81, v80, s98
    v_perm_b32 v55, v83, v82, s98
    v_exp_f32 v86, v86
    v_exp_f32 v87, v87
    v_perm_b32 v56, v85, v84, s98
    v_exp_f32 v88, v88
    v_exp_f32 v89, v89
    v_perm_b32 v57, v87, v86, s98
    v_exp_f32 v90, v90
    v_exp_f32 v91, v91
    v_perm_b32 v58, v89, v88, s98
    v_perm_b32 v59, v91, v90, s98
    s_setprio 0
    v_mfma_f32_32x32x16_bf16 v[76:91], v[40:43], v[36:39], 0
    ds_read_b128 v[40:43], v124 offset:12288
    v_exp_f32 v60, v60
    v_exp_f32 v61, v61
    v_exp_f32 v62, v62
    v_exp_f32 v63, v63
    v_smfmac_f32_32x32x32_bf16 v[108:123], v[44:47], v[52:59], v10
    ds_read_b128 v[44:47], v124 offset:11264
    v_exp_f32 v64, v64
    v_exp_f32 v65, v65
    v_exp_f32 v66, v66
    v_exp_f32 v67, v67
    v_smfmac_f32_16x16x64_bf16 v[16:19], v[6:9], v[52:59], v11
    v_exp_f32 v68, v68
    v_exp_f32 v69, v69
    v_perm_b32 v52, v61, v60, s98
    v_perm_b32 v53, v63, v62, s98
    v_perm_b32 v54, v65, v64, s98
    v_perm_b32 v55, v67, v66, s98
    v_exp_f32 v70, v70
    v_exp_f32 v71, v71
    v_perm_b32 v56, v69, v68, s98
    v_exp_f32 v72, v72
    v_exp_f32 v73, v73
    v_perm_b32 v57, v71, v70, s98
    v_exp_f32 v74, v74
    v_exp_f32 v75, v75
    v_perm_b32 v58, v73, v72, s98
    v_perm_b32 v59, v75, v74, s98
    s_waitcnt lgkmcnt(1)
    v_mfma_f32_32x32x16_bf16 v[60:75], v[40:43], v[32:35], 0
    v_exp_f32 v76, v76
    v_exp_f32 v77, v77
    v_exp_f32 v78, v78
    v_exp_f32 v79, v79
    s_waitcnt lgkmcnt(0)
    v_smfmac_f32_32x32x32_bf16 v[92:107], v[44:47], v[52:59], v10
    v_exp_f32 v80, v80
    v_exp_f32 v81, v81
    v_exp_f32 v82, v82
    v_exp_f32 v83, v83
    v_smfmac_f32_16x16x64_bf16 v[12:15], v[6:9], v[52:59], v11
    v_exp_f32 v84, v84
    v_exp_f32 v85, v85
    v_perm_b32 v52, v77, v76, s98
    v_perm_b32 v53, v79, v78, s98
    v_perm_b32 v54, v81, v80, s98
    v_perm_b32 v55, v83, v82, s98
    v_exp_f32 v86, v86
    v_exp_f32 v87, v87
    v_perm_b32 v56, v85, v84, s98
    v_exp_f32 v88, v88
    v_exp_f32 v89, v89
    v_perm_b32 v57, v87, v86, s98
    v_exp_f32 v90, v90
    v_exp_f32 v91, v91
    v_perm_b32 v58, v89, v88, s98
    v_perm_b32 v59, v91, v90, s98
    v_mfma_f32_32x32x16_bf16 v[76:91], v[40:43], v[36:39], 0
    ds_read_b128 v[40:43], v124 offset:14336
    v_exp_f32 v60, v60
    v_exp_f32 v61, v61
    v_exp_f32 v62, v62
    v_exp_f32 v63, v63
    v_smfmac_f32_32x32x32_bf16 v[108:123], v[44:47], v[52:59], v10
    ds_read_b128 v[44:47], v124 offset:13312
    v_exp_f32 v64, v64
    v_exp_f32 v65, v65
    v_exp_f32 v66, v66
    v_exp_f32 v67, v67
    v_smfmac_f32_16x16x64_bf16 v[16:19], v[6:9], v[52:59], v11
    v_exp_f32 v68, v68
    v_exp_f32 v69, v69
    v_perm_b32 v52, v61, v60, s98
    v_perm_b32 v53, v63, v62, s98
    v_perm_b32 v54, v65, v64, s98
    v_perm_b32 v55, v67, v66, s98
    v_exp_f32 v70, v70
    v_exp_f32 v71, v71
    v_perm_b32 v56, v69, v68, s98
    v_exp_f32 v72, v72
    v_exp_f32 v73, v73
    v_perm_b32 v57, v71, v70, s98
    v_exp_f32 v74, v74
    v_exp_f32 v75, v75
    v_perm_b32 v58, v73, v72, s98
    v_perm_b32 v59, v75, v74, s98
    s_waitcnt lgkmcnt(1)
    v_mfma_f32_32x32x16_bf16 v[60:75], v[40:43], v[32:35], 0
    v_exp_f32 v76, v76
    v_exp_f32 v77, v77
    v_exp_f32 v78, v78
    v_exp_f32 v79, v79
    s_waitcnt lgkmcnt(0)
    v_smfmac_f32_32x32x32_bf16 v[92:107], v[44:47], v[52:59], v10
    v_exp_f32 v80, v80
    v_exp_f32 v81, v81
    v_exp_f32 v82, v82
    v_exp_f32 v83, v83
    v_smfmac_f32_16x16x64_bf16 v[12:15], v[6:9], v[52:59], v11
    v_exp_f32 v84, v84
    v_exp_f32 v85, v85
    v_perm_b32 v52, v77, v76, s98
    v_perm_b32 v53, v79, v78, s98
    v_perm_b32 v54, v81, v80, s98
    v_perm_b32 v55, v83, v82, s98
    v_exp_f32 v86, v86
    v_exp_f32 v87, v87
    v_perm_b32 v56, v85, v84, s98
    v_exp_f32 v88, v88
    v_exp_f32 v89, v89
    v_perm_b32 v57, v87, v86, s98
    v_exp_f32 v90, v90
    v_exp_f32 v91, v91
    v_perm_b32 v58, v89, v88, s98
    v_perm_b32 v59, v91, v90, s98
    v_mfma_f32_32x32x16_bf16 v[76:91], v[40:43], v[36:39], 0
    v_exp_f32 v60, v60
    v_exp_f32 v61, v61
    v_exp_f32 v62, v62
    v_exp_f32 v63, v63
    v_smfmac_f32_32x32x32_bf16 v[108:123], v[44:47], v[52:59], v10
    ds_read_b128 v[44:47], v124 offset:15360
    v_exp_f32 v64, v64
    v_exp_f32 v65, v65
    v_exp_f32 v66, v66
    v_exp_f32 v67, v67
    v_smfmac_f32_16x16x64_bf16 v[16:19], v[6:9], v[52:59], v11
    v_exp_f32 v68, v68
    v_exp_f32 v69, v69
    v_perm_b32 v52, v61, v60, s98
    v_perm_b32 v53, v63, v62, s98
    v_perm_b32 v54, v65, v64, s98
    v_perm_b32 v55, v67, v66, s98
    v_exp_f32 v70, v70
    v_exp_f32 v71, v71
    v_perm_b32 v56, v69, v68, s98
    v_exp_f32 v72, v72
    v_exp_f32 v73, v73
    v_perm_b32 v57, v71, v70, s98
    v_exp_f32 v74, v74
    v_exp_f32 v75, v75
    v_perm_b32 v58, v73, v72, s98
    v_perm_b32 v59, v75, v74, s98
    v_exp_f32 v76, v76
    v_exp_f32 v77, v77
    v_exp_f32 v78, v78
    v_exp_f32 v79, v79
    s_waitcnt lgkmcnt(0)
    v_smfmac_f32_32x32x32_bf16 v[92:107], v[44:47], v[52:59], v10
    v_exp_f32 v80, v80
    v_exp_f32 v81, v81
    v_exp_f32 v82, v82
    v_exp_f32 v83, v83
    v_smfmac_f32_16x16x64_bf16 v[12:15], v[6:9], v[52:59], v11
    v_exp_f32 v84, v84
    v_exp_f32 v85, v85
    v_perm_b32 v52, v77, v76, s98
    v_perm_b32 v53, v79, v78, s98
    v_perm_b32 v54, v81, v80, s98
    v_perm_b32 v55, v83, v82, s98
    v_exp_f32 v86, v86
    v_exp_f32 v87, v87
    v_perm_b32 v56, v85, v84, s98
    v_exp_f32 v88, v88
    v_exp_f32 v89, v89
    v_perm_b32 v57, v87, v86, s98
    v_exp_f32 v90, v90
    v_exp_f32 v91, v91
    v_perm_b32 v58, v89, v88, s98
    v_perm_b32 v59, v91, v90, s98
    s_setprio 0
    s_nop 1
    v_smfmac_f32_32x32x32_bf16 v[108:123], v[44:47], v[52:59], v10
    v_smfmac_f32_16x16x64_bf16 v[16:19], v[6:9], v[52:59], v11
L_attdone:
    s_lshl_b32 s72, s66, 11
    s_add_u32 s72, s72, 98304
    v_add_u32 v22, s72, v4
    v_xor_b32 v23, 2048, v22
    s_lshl_b32 s72, s66, 8
    s_add_u32 s72, s72, 34816
    v_lshlrev_b32 v24, 2, v1
    v_add_u32 v24, s72, v24
    v_xor_b32 v25, 256, v24
    s_nop 3
    s_nop 0
    s_cmp_eq_u32 s78, 0
    s_cbranch_scc1 L_ex0
    v_pk_add_f32 v[92:93], v[92:93], v[100:101]
    v_pk_add_f32 v[94:95], v[94:95], v[102:103]
    v_pk_add_f32 v[96:97], v[96:97], v[104:105]
    v_pk_add_f32 v[98:99], v[98:99], v[106:107]
    v_add_f32 v12, v12, v13
    ds_write_b128 v22, v[92:95]
    ds_write_b128 v22, v[96:99] offset:1024
    ds_write_b32 v24, v12
    v_pk_add_f32 v[108:109], v[108:109], v[116:117]
    v_pk_add_f32 v[110:111], v[110:111], v[118:119]
    v_pk_add_f32 v[112:113], v[112:113], v[120:121]
    v_pk_add_f32 v[114:115], v[114:115], v[122:123]
    v_add_f32 v16, v16, v17
    s_waitcnt lgkmcnt(0)
    s_barrier
    ds_read_b32 v68, v25
    ds_read_b128 v[60:63], v23
    ds_read_b128 v[64:67], v23 offset:1024
    s_waitcnt lgkmcnt(2)
    v_add_f32 v68, v68, v16
    v_rcp_f32 v68, v68
    s_waitcnt lgkmcnt(0)
    v_pk_add_f32 v[60:61], v[60:61], v[108:109]
    v_pk_add_f32 v[62:63], v[62:63], v[110:111]
    v_pk_add_f32 v[64:65], v[64:65], v[112:113]
    v_pk_add_f32 v[66:67], v[66:67], v[114:115]
    v_pk_mul_f32 v[60:61], v[60:61], v[68:69] op_sel_hi:[1,0]
    v_pk_mul_f32 v[62:63], v[62:63], v[68:69] op_sel_hi:[1,0]
    v_pk_mul_f32 v[64:65], v[64:65], v[68:69] op_sel_hi:[1,0]
    v_pk_mul_f32 v[66:67], v[66:67], v[68:69] op_sel_hi:[1,0]
    s_branch L_exj
L_ex0:
    v_pk_add_f32 v[108:109], v[108:109], v[116:117]
    v_pk_add_f32 v[110:111], v[110:111], v[118:119]
    v_pk_add_f32 v[112:113], v[112:113], v[120:121]
    v_pk_add_f32 v[114:115], v[114:115], v[122:123]
    v_add_f32 v16, v16, v17
    ds_write_b128 v22, v[108:111]
    ds_write_b128 v22, v[112:115] offset:1024
    ds_write_b32 v24, v16
    v_pk_add_f32 v[92:93], v[92:93], v[100:101]
    v_pk_add_f32 v[94:95], v[94:95], v[102:103]
    v_pk_add_f32 v[96:97], v[96:97], v[104:105]
    v_pk_add_f32 v[98:99], v[98:99], v[106:107]
    v_add_f32 v12, v12, v13
    s_waitcnt lgkmcnt(0)
    s_barrier
    ds_read_b32 v68, v25
    ds_read_b128 v[60:63], v23
    ds_read_b128 v[64:67], v23 offset:1024
    s_waitcnt lgkmcnt(2)
    v_add_f32 v68, v68, v12
    v_rcp_f32 v68, v68
    s_waitcnt lgkmcnt(0)
    v_pk_add_f32 v[60:61], v[60:61], v[92:93]
    v_pk_add_f32 v[62:63], v[62:63], v[94:95]
    v_pk_add_f32 v[64:65], v[64:65], v[96:97]
    v_pk_add_f32 v[66:67], v[66:67], v[98:99]
    v_pk_mul_f32 v[60:61], v[60:61], v[68:69] op_sel_hi:[1,0]
    v_pk_mul_f32 v[62:63], v[62:63], v[68:69] op_sel_hi:[1,0]
    v_pk_mul_f32 v[64:65], v[64:65], v[68:69] op_sel_hi:[1,0]
    v_pk_mul_f32 v[66:67], v[66:67], v[68:69] op_sel_hi:[1,0]
L_exj:
    v_cvt_pk_bf16_f32 v70, v60, v61
    v_cvt_pk_bf16_f32 v71, v62, v63
    v_cvt_pk_bf16_f32 v72, v64, v65
    v_cvt_pk_bf16_f32 v73, v66, v67
    buffer_store_dwordx4 v[70:73], v4, s[56:59], s97 offen sc1
    v_mov_b32 v22, s96
    v_mov_b32 v30, s67
    s_lshl_b32 s68, s64, 1
    s_add_u32 s68, s68, s91
    s_lshl_b32 s68, s68, 5
    s_lshl_b32 s72, s77, 3
    s_add_u32 s70, s68, s72
    s_lshl_b32 s72, s64, 8
    v_lshlrev_b32 v24, 2, v1
    v_add_u32 v24, s72, v24
    v_add_u32 v25, 8192, v24
    s_lshl_b32 s70, s70, 10
    v_mov_b32 v112, v6
    v_mov_b32 v120, 0
    v_mov_b32 v113, v7
    v_mov_b32 v121, 0
    v_mov_b32 v114, v8
    v_mov_b32 v122, 0
    v_mov_b32 v115, v9
    v_mov_b32 v123, 0
    v_mov_b32 v119, v11
    s_nop 1
    v_smfmac_f32_16x16x64_bf16 v[120:123], v[112:115], v[128:135], v119
    v_smfmac_f32_16x16x64_bf16 v[120:123], v[112:115], v[136:143], v119
    v_smfmac_f32_16x16x64_bf16 v[120:123], v[112:115], v[144:151], v119
    v_smfmac_f32_16x16x64_bf16 v[120:123], v[112:115], v[152:159], v119
    v_smfmac_f32_16x16x64_bf16 v[120:123], v[112:115], v[160:167], v119
    v_smfmac_f32_16x16x64_bf16 v[120:123], v[112:115], v[168:175], v119
    v_smfmac_f32_16x16x64_bf16 v[120:123], v[112:115], v[176:183], v119
    v_smfmac_f32_16x16x64_bf16 v[120:123], v[112:115], v[184:191], v119
    s_waitcnt vmcnt(0)
    s_mov_b64 exec, 1
    s_cmp_eq_u32 s95, 0
    s_cbranch_scc1 L_11
    buffer_store_dword v30, v22, s[56:59], 0 offen sc1
    s_branch L_12
L_11:
    buffer_store_dword v30, v22, s[56:59], 0 offen
L_12:
    s_mov_b64 exec, -1
    s_add_u32 m0, s69, 65536
    s_add_u32 s75, s87, 1056896
    buffer_load_dwordx4 v3, s[48:51], s75 offen lds
    s_add_u32 m0, s69, 73728
    s_add_u32 s75, s87, 1056960
    buffer_load_dwordx4 v3, s[48:51], s75 offen lds
    s_add_u32 m0, s69, 81920
    s_add_u32 s75, s87, 1057024
    buffer_load_dwordx4 v3, s[48:51], s75 offen lds
    s_add_u32 m0, s69, 90112
    s_add_u32 s75, s87, 1057088
    buffer_load_dwordx4 v3, s[48:51], s75 offen lds
    v_mov_b32 v6, v48
    v_mov_b32 v7, v49
    v_mov_b32 v8, v50
    v_mov_b32 v9, v51
    s_add_u32 s72, s70, 262144
    s_add_u32 s73, s70, 266240
    s_cmp_lg_u32 s66, 0
    s_cbranch_scc1 L_opoll_x
    s_mov_b32 s90, 1048576
    buffer_load_dword v116, v25, s[56:59], 0 offen sc1
    buffer_load_dword v117, v25, s[56:59], 0 offen sc1
    buffer_load_dword v118, v25, s[56:59], 0 offen sc1
L_opoll:
    s_waitcnt vmcnt(2)
    v_cmp_ne_u32 vcc, s67, v116
    s_cbranch_vccz L_opoll_x
    buffer_load_dword v116, v25, s[56:59], 0 offen sc1
    s_waitcnt vmcnt(2)
    v_cmp_ne_u32 vcc, s67, v117
    s_cbranch_vccz L_opoll_x
    buffer_load_dword v117, v25, s[56:59], 0 offen sc1
    s_waitcnt vmcnt(2)
    v_cmp_ne_u32 vcc, s67, v118
    s_cbranch_vccz L_opoll_x
    buffer_load_dword v118, v25, s[56:59], 0 offen sc1
    s_sub_u32 s90, s90, 1
    s_cbranch_scc0 L_opoll
L_opoll_x:
    s_barrier
    buffer_load_dwordx4 v[32:35], v4, s[56:59], s72 offen offset:0 sc1
    buffer_load_dwordx4 v[36:39], v4, s[56:59], s72 offen offset:1024 sc1
    buffer_load_dwordx4 v[40:43], v4, s[56:59], s72 offen offset:2048 sc1
    buffer_load_dwordx4 v[44:47], v4, s[56:59], s72 offen offset:3072 sc1
    buffer_load_dwordx4 v[48:51], v4, s[56:59], s73 offen offset:0 sc1
    buffer_load_dwordx4 v[52:55], v4, s[56:59], s73 offen offset:1024 sc1
    buffer_load_dwordx4 v[56:59], v4, s[56:59], s73 offen offset:2048 sc1
    buffer_load_dwordx4 v[60:63], v4, s[56:59], s73 offen offset:3072 sc1
    s_xor_b32 s72, s66, 0
    s_mul_i32 s72, s72, 6144
    s_add_u32 s72, s72, 0
    v_add_u32 v29, s72, v4
    s_xor_b32 s72, s66, 1
    s_mul_i32 s72, s72, 6144
    s_add_u32 s72, s72, 0
    v_add_u32 v26, s72, v4
    s_xor_b32 s72, s66, 2
    s_mul_i32 s72, s72, 6144
    s_add_u32 s72, s72, 2048
    v_add_u32 v27, s72, v4
    s_xor_b32 s72, s66, 3
    s_mul_i32 s72, s72, 6144
    s_add_u32 s72, s72, 4096
    v_add_u32 v28, s72, v4
    s_waitcnt vmcnt(7)
    v_mfma_f32_32x32x16_bf16 v[64:79], v[192:195], v[32:35], 0
    v_mfma_f32_32x32x16_bf16 v[80:95], v[196:199], v[32:35], 0
    s_waitcnt vmcnt(6)
    v_mfma_f32_32x32x16_bf16 v[64:79], v[200:203], v[36:39], v[64:79]
    v_mfma_f32_32x32x16_bf16 v[80:95], v[204:207], v[36:39], v[80:95]
    s_waitcnt vmcnt(5)
    v_mfma_f32_32x32x16_bf16 v[64:79], v[208:211], v[40:43], v[64:79]
    v_mfma_f32_32x32x16_bf16 v[80:95], v[212:215], v[40:43], v[80:95]
    s_waitcnt vmcnt(4)
    v_mfma_f32_32x32x16_bf16 v[64:79], v[216:219], v[44:47], v[64:79]
    v_mfma_f32_32x32x16_bf16 v[80:95], v[220:223], v[44:47], v[80:95]
    s_waitcnt vmcnt(3)
    v_mfma_f32_32x32x16_bf16 v[64:79], v[224:227], v[48:51], v[64:79]
    v_mfma_f32_32x32x16_bf16 v[80:95], v[228:231], v[48:51], v[80:95]
    s_waitcnt vmcnt(2)
    v_mfma_f32_32x32x16_bf16 v[64:79], v[232:235], v[52:55], v[64:79]
    v_mfma_f32_32x32x16_bf16 v[80:95], v[236:239], v[52:55], v[80:95]
    s_waitcnt vmcnt(1)
    v_mfma_f32_32x32x16_bf16 v[64:79], v[240:243], v[56:59], v[64:79]
    v_mfma_f32_32x32x16_bf16 v[80:95], v[244:247], v[56:59], v[80:95]
    s_waitcnt vmcnt(0)
    v_mfma_f32_32x32x16_bf16 v[64:79], v[248:251], v[60:63], v[64:79]
    v_mfma_f32_32x32x16_bf16 v[80:95], v[252:255], v[60:63], v[80:95]
    s_nop 11
    ds_write_b128 v26, v[72:75]
    ds_write_b128 v26, v[76:79] offset:1024
    ds_write_b128 v27, v[80:83]
    ds_write_b128 v27, v[84:87] offset:1024
    ds_write_b128 v28, v[88:91]
    ds_write_b128 v28, v[92:95] offset:1024
    v_lshlrev_b32 v56, 16, v6
    v_and_b32 v57, 0xffff0000, v6
    v_lshlrev_b32 v58, 16, v7
    v_and_b32 v59, 0xffff0000, v7
    v_lshlrev_b32 v60, 16, v8
    v_and_b32 v61, 0xffff0000, v8
    v_lshlrev_b32 v62, 16, v9
    v_and_b32 v63, 0xffff0000, v9
    v_pk_add_f32 v[64:65], v[64:65], v[56:57]
    v_pk_add_f32 v[66:67], v[66:67], v[58:59]
    v_pk_add_f32 v[68:69], v[68:69], v[60:61]
    v_pk_add_f32 v[70:71], v[70:71], v[62:63]
    s_lshl_b32 s72, s65, 2
    s_add_u32 s72, s72, s77
    s_add_u32 s72, s72, s68
    s_lshl_b32 s73, s72, 10
    s_add_u32 s73, s73, 2359296
    s_lshl_b32 s74, s72, 8
    s_add_u32 s74, s74, 10485760
    s_lshl_b32 s72, s72, 2
    s_add_u32 s72, s72, 16384
    v_lshlrev_b32 v124, 3, v1
    s_waitcnt lgkmcnt(0)
    s_barrier
    ds_read_b128 v[32:35], v29 offset:0
    ds_read_b128 v[36:39], v29 offset:1024
    ds_read_b128 v[40:43], v29 offset:2048
    ds_read_b128 v[44:47], v29 offset:3072
    ds_read_b128 v[48:51], v29 offset:4096
    ds_read_b128 v[52:55], v29 offset:5120
    s_waitcnt lgkmcnt(4)
    v_pk_add_f32 v[64:65], v[64:65], v[32:33]
    v_pk_add_f32 v[66:67], v[66:67], v[34:35]
    v_pk_add_f32 v[68:69], v[68:69], v[36:37]
    v_pk_add_f32 v[70:71], v[70:71], v[38:39]
    s_waitcnt lgkmcnt(2)
    v_pk_add_f32 v[64:65], v[64:65], v[40:41]
    v_pk_add_f32 v[66:67], v[66:67], v[42:43]
    v_pk_add_f32 v[68:69], v[68:69], v[44:45]
    v_pk_add_f32 v[70:71], v[70:71], v[46:47]
    s_waitcnt lgkmcnt(0)
    v_pk_add_f32 v[64:65], v[64:65], v[48:49]
    v_pk_add_f32 v[66:67], v[66:67], v[50:51]
    v_pk_add_f32 v[68:69], v[68:69], v[52:53]
    v_pk_add_f32 v[70:71], v[70:71], v[54:55]
    v_cvt_pk_bf16_f32 v6, v64, v65
    v_cvt_pk_bf16_f32 v7, v66, v67
    v_cvt_pk_bf16_f32 v8, v68, v69
    v_cvt_pk_bf16_f32 v9, v70, v71
    buffer_store_dwordx4 v[6:9], v4, s[56:59], s73 offen sc1
    v_pk_add_f32 v[72:73], v[64:65], v[66:67]
    v_pk_mul_f32 v[74:75], v[64:65], v[64:65]
    v_pk_add_f32 v[72:73], v[72:73], v[68:69]
    v_pk_fma_f32 v[74:75], v[66:67], v[66:67], v[74:75]
    v_pk_add_f32 v[72:73], v[72:73], v[70:71]
    v_pk_fma_f32 v[74:75], v[68:69], v[68:69], v[74:75]
    v_add_f32 v72, v72, v73
    v_pk_fma_f32 v[74:75], v[70:71], v[70:71], v[74:75]
    v_add_f32 v73, v74, v75
    v_mov_b32 v74, v72
    v_mov_b32 v75, v73
    s_nop 1
    v_permlane32_swap_b32 v72, v74
    v_permlane32_swap_b32 v73, v75
    v_pk_add_f32 v[72:73], v[72:73], v[74:75]
    s_mov_b32 exec_hi, 0
    buffer_store_dwordx2 v[72:73], v124, s[56:59], s74 offen sc1
    s_mov_b64 exec, -1
    s_lshl_b32 s73, s80, 13
    v_add_u32 v22, s73, v5
    v_add_u32 v23, 114688, v22
    ds_read_b64_tr_b16 v[192:193], v23 offset:0
    ds_read_b64_tr_b16 v[194:195], v23 offset:512
    ds_read_b64_tr_b16 v[196:197], v23 offset:1024
    ds_read_b64_tr_b16 v[198:199], v23 offset:1536
    ds_read_b64_tr_b16 v[200:201], v23 offset:2048
    ds_read_b64_tr_b16 v[202:203], v23 offset:2560
    ds_read_b64_tr_b16 v[204:205], v23 offset:3072
    ds_read_b64_tr_b16 v[206:207], v23 offset:3584
    ds_read_b64_tr_b16 v[208:209], v23 offset:4096
    ds_read_b64_tr_b16 v[210:211], v23 offset:4608
    ds_read_b64_tr_b16 v[212:213], v23 offset:5120
    ds_read_b64_tr_b16 v[214:215], v23 offset:5632
    ds_read_b64_tr_b16 v[216:217], v23 offset:6144
    ds_read_b64_tr_b16 v[218:219], v23 offset:6656
    ds_read_b64_tr_b16 v[220:221], v23 offset:7168
    s_waitcnt lgkmcnt(10)
    ds_read_b64_tr_b16 v[222:223], v23 offset:7680
    ds_read_b64_tr_b16 v[224:225], v22 offset:49152
    ds_read_b64_tr_b16 v[226:227], v22 offset:49664
    ds_read_b64_tr_b16 v[228:229], v22 offset:50176
    ds_read_b64_tr_b16 v[230:231], v22 offset:50688
    s_waitcnt lgkmcnt(10)
    ds_read_b64_tr_b16 v[232:233], v22 offset:51200
    ds_read_b64_tr_b16 v[234:235], v22 offset:51712
    ds_read_b64_tr_b16 v[236:237], v22 offset:52224
    ds_read_b64_tr_b16 v[238:239], v22 offset:52736
    ds_read_b64_tr_b16 v[240:241], v22 offset:53248
    s_waitcnt lgkmcnt(10)
    ds_read_b64_tr_b16 v[242:243], v22 offset:53760
    ds_read_b64_tr_b16 v[244:245], v22 offset:54272
    ds_read_b64_tr_b16 v[246:247], v22 offset:54784
    ds_read_b64_tr_b16 v[248:249], v22 offset:55296
    ds_read_b64_tr_b16 v[250:251], v22 offset:55808
    s_waitcnt lgkmcnt(10)
    ds_read_b64_tr_b16 v[252:253], v22 offset:56320
    ds_read_b64_tr_b16 v[254:255], v22 offset:56832
    v_mov_b32 v26, s72
    s_waitcnt vmcnt(0)
    s_mov_b64 exec, 1
    s_cmp_eq_u32 s95, 0
    s_cbranch_scc1 L_13
    buffer_store_dword v30, v26, s[56:59], 0 offen sc1
    s_branch L_14
L_13:
    buffer_store_dword v30, v26, s[56:59], 0 offen
L_14:
    s_mov_b64 exec, -1
    s_waitcnt lgkmcnt(0)
    v_add_u32 v25, 16384, v24
    s_lshr_b32 s74, s70, 2
    s_add_u32 s74, s74, 10485760
    v_lshrrev_b32 v26, 5, v1
    v_mul_u32_u24 v26, 768, v26
    v_add_u32 v124, v124, v26
    s_lshl_b32 s71, s77, 12
    s_sub_u32 s70, s70, s71
    s_add_u32 s70, s70, 2359296
    s_lshl_b32 s72, s91, 15
    s_add_u32 s71, s71, s72
    s_cmp_lg_u32 s66, 0
    s_cbranch_scc1 L_hpoll_x
    s_mov_b32 s90, 1048576
    buffer_load_dword v116, v25, s[56:59], 0 offen sc1
    buffer_load_dword v117, v25, s[56:59], 0 offen sc1
    buffer_load_dword v118, v25, s[56:59], 0 offen sc1
L_hpoll:
    s_waitcnt vmcnt(2)
    v_cmp_ne_u32 vcc, s67, v116
    s_cbranch_vccz L_hpoll_x
    buffer_load_dword v116, v25, s[56:59], 0 offen sc1
    s_waitcnt vmcnt(2)
    v_cmp_ne_u32 vcc, s67, v117
    s_cbranch_vccz L_hpoll_x
    buffer_load_dword v117, v25, s[56:59], 0 offen sc1
    s_waitcnt vmcnt(2)
    v_cmp_ne_u32 vcc, s67, v118
    s_cbranch_vccz L_hpoll_x
    buffer_load_dword v118, v25, s[56:59], 0 offen sc1
    s_sub_u32 s90, s90, 1
    s_cbranch_scc0 L_hpoll
L_hpoll_x:
    s_barrier
    s_add_u32 m0, s71, 0
    s_add_u32 s75, s70, 0
    buffer_load_dwordx4 v4, s[56:59], s75 offen sc1 lds
    s_add_u32 m0, s71, 1024
    s_add_u32 s75, s70, 1024
    buffer_load_dwordx4 v4, s[56:59], s75 offen sc1 lds
    s_add_u32 m0, s71, 2048
    s_add_u32 s75, s70, 2048
    buffer_load_dwordx4 v4, s[56:59], s75 offen sc1 lds
    s_add_u32 m0, s71, 3072
    s_add_u32 s75, s70, 3072
    buffer_load_dwordx4 v4, s[56:59], s75 offen sc1 lds
    buffer_load_dwordx2 v[32:33], v124, s[56:59], s74 offen offset:0 sc1
    buffer_load_dwordx2 v[34:35], v124, s[56:59], s74 offen offset:256 sc1
    buffer_load_dwordx2 v[36:37], v124, s[56:59], s74 offen offset:512 sc1
    buffer_load_dwordx2 v[38:39], v124, s[56:59], s74 offen offset:768 sc1
    v_smfmac_f32_16x16x64_bf16 v[120:123], v[112:115], v[192:199], v119
    v_smfmac_f32_16x16x64_bf16 v[120:123], v[112:115], v[200:207], v119
    v_smfmac_f32_16x16x64_bf16 v[120:123], v[112:115], v[208:215], v119
    v_smfmac_f32_16x16x64_bf16 v[120:123], v[112:115], v[216:223], v119
    v_smfmac_f32_16x16x64_bf16 v[120:123], v[112:115], v[224:231], v119
    v_smfmac_f32_16x16x64_bf16 v[120:123], v[112:115], v[232:239], v119
    v_smfmac_f32_16x16x64_bf16 v[120:123], v[112:115], v[240:247], v119
    v_smfmac_f32_16x16x64_bf16 v[120:123], v[112:115], v[248:255], v119
    s_lshl_b32 s72, s66, 7
    s_add_u32 s72, s72, 68608
    v_and_b32 v40, 31, v1
    v_lshlrev_b32 v40, 2, v40
    v_add_u32 v40, s72, v40
    v_lshrrev_b32 v41, 5, v1
    v_lshlrev_b32 v41, 4, v41
    v_add_u32 v41, s72, v41
    v_and_b32 v25, 31, v1
    v_lshlrev_b32 v25, 3, v25
    v_add_u32 v25, 65536, v25
    s_lshl_b32 s72, s66, 8
    v_add_u32 v26, s72, v25
    s_waitcnt vmcnt(4)
    s_nop 0
    v_add_f32 v120, v120, v121
    ds_write_b32 v40, v120
    ds_read_b128 v[96:99], v41 offset:0
    ds_read_b128 v[100:103], v41 offset:32
    ds_read_b128 v[104:107], v41 offset:64
    ds_read_b128 v[108:111], v41 offset:96
    s_waitcnt vmcnt(0)
    v_pk_add_f32 v[32:33], v[32:33], v[36:37]
    v_pk_add_f32 v[34:35], v[34:35], v[38:39]
    v_pk_add_f32 v[32:33], v[32:33], v[34:35]
    v_mov_b32 v34, v32
    v_mov_b32 v35, v33
    s_nop 1
    v_permlane32_swap_b32 v32, v34
    v_permlane32_swap_b32 v33, v35
    v_pk_add_f32 v[32:33], v[32:33], v[34:35]
    ds_write_b64 v26, v[32:33]
    s_mov_b32 s96, s70
    s_mov_b32 s97, s71
    v_lshrrev_b32 v27, 5, v1
    v_lshlrev_b32 v27, 3, v27
    s_lshl_b32 s72, s65, 7
    s_lshl_b32 s73, s77, 5
    s_add_u32 s72, s72, s73
    v_add_u32 v28, s72, v27
    s_add_u32 s72, s89, s80
    s_lshl_b32 s72, s72, 6
    v_add_u32 v27, s72, v27
    s_waitcnt lgkmcnt(0)
    s_barrier
    s_add_u32 s70, s89, s80
    s_mul_i32 s72, s64, 176128
    s_lshl_b32 s73, s70, 11
    s_add_u32 s72, s72, s73
    s_add_u32 s72, s72, 4456448
    s_lshl_b32 s73, s64, 7
    s_add_u32 s73, s73, s70
    s_lshl_b32 s73, s73, 2
    s_add_u32 s73, s73, 24576
    s_cmp_ge_u32 s66, 4
    s_cbranch_scc1 L_small
    ds_read_b128 v[32:35], v4 offset:0
    ds_read_b128 v[36:39], v4 offset:32768
    ds_read_b128 v[40:43], v4 offset:1024
    ds_read_b128 v[44:47], v4 offset:33792
    ds_read_b128 v[48:51], v4 offset:2048
    ds_read_b128 v[52:55], v4 offset:34816
    ds_read_b64 v[56:57], v25 offset:0
    ds_read_b64 v[58:59], v25 offset:256
    ds_read_b64 v[60:61], v25 offset:512
    ds_read_b64 v[62:63], v25 offset:768
    s_waitcnt lgkmcnt(8)
    v_mfma_f32_32x32x16_bf16 v[64:79], v[128:131], v[32:35], 0
    v_mfma_f32_32x32x16_bf16 v[80:95], v[128:131], v[36:39], 0
    s_add_u32 m0, s97, 16384
    s_add_u32 s75, s96, 16384
    buffer_load_dwordx4 v4, s[56:59], s75 offen sc1 lds
    s_add_u32 m0, s97, 17408
    s_add_u32 s75, s96, 17408
    buffer_load_dwordx4 v4, s[56:59], s75 offen sc1 lds
    ds_read_b128 v[32:35], v4 offset:3072
    ds_read_b128 v[36:39], v4 offset:35840
    s_waitcnt lgkmcnt(8)
    v_mfma_f32_32x32x16_bf16 v[64:79], v[132:135], v[40:43], v[64:79]
    v_mfma_f32_32x32x16_bf16 v[80:95], v[132:135], v[44:47], v[80:95]
    s_add_u32 m0, s97, 18432
    s_add_u32 s75, s96, 18432
    buffer_load_dwordx4 v4, s[56:59], s75 offen sc1 lds
    s_add_u32 m0, s97, 19456
    s_add_u32 s75, s96, 19456
    buffer_load_dwordx4 v4, s[56:59], s75 offen sc1 lds
    ds_read_b128 v[40:43], v4 offset:4096
    ds_read_b128 v[44:47], v4 offset:36864
    s_waitcnt lgkmcnt(8)
    v_mfma_f32_32x32x16_bf16 v[64:79], v[136:139], v[48:51], v[64:79]
    v_mfma_f32_32x32x16_bf16 v[80:95], v[136:139], v[52:55], v[80:95]
    global_load_dwordx2 v[120:121], v27, s[18:19] offset:0
    ds_read_b128 v[48:51], v4 offset:5120
    ds_read_b128 v[52:55], v4 offset:37888
    s_waitcnt lgkmcnt(4)
    v_mfma_f32_32x32x16_bf16 v[64:79], v[140:143], v[32:35], v[64:79]
    v_mfma_f32_32x32x16_bf16 v[80:95], v[140:143], v[36:39], v[80:95]
    global_load_dwordx2 v[122:123], v27, s[18:19] offset:16
    ds_read_b128 v[32:35], v4 offset:6144
    ds_read_b128 v[36:39], v4 offset:38912
    v_pk_add_f32 v[56:57], v[56:57], v[58:59]
    v_pk_add_f32 v[60:61], v[60:61], v[62:63]
    v_pk_add_f32 v[14:15], v[56:57], v[60:61]
    v_mul_f32 v17, 0xbb000000, v14
    v_mul_f32 v15, 0x3b000000, v15
    v_fma_f32 v15, -v17, v17, v15
    v_max_f32 v15, 0, v15
    v_add_f32 v15, 0x3727c5ac, v15
    v_rsq_f32 v16, v15
    s_nop 0
    ds_read_b64 v[56:57], v25 offset:1024
    ds_read_b64 v[58:59], v25 offset:1280
    ds_read_b64 v[60:61], v25 offset:1536
    ds_read_b64 v[62:63], v25 offset:1792
    s_waitcnt lgkmcnt(8)
    v_mfma_f32_32x32x16_bf16 v[64:79], v[144:147], v[40:43], v[64:79]
    v_mfma_f32_32x32x16_bf16 v[80:95], v[144:147], v[44:47], v[80:95]
    global_load_dwordx2 v[124:125], v27, s[18:19] offset:32
    ds_read_b128 v[40:43], v4 offset:7168
    ds_read_b128 v[44:47], v4 offset:39936
    s_waitcnt lgkmcnt(8)
    v_mfma_f32_32x32x16_bf16 v[64:79], v[148:151], v[48:51], v[64:79]
    v_mfma_f32_32x32x16_bf16 v[80:95], v[148:151], v[52:55], v[80:95]
    global_load_dwordx2 v[126:127], v27, s[18:19] offset:48
    ds_read_b128 v[48:51], v4 offset:8192
    ds_read_b128 v[52:55], v4 offset:40960
    s_waitcnt lgkmcnt(8)
    v_mfma_f32_32x32x16_bf16 v[64:79], v[152:155], v[32:35], v[64:79]
    v_mfma_f32_32x32x16_bf16 v[80:95], v[152:155], v[36:39], v[80:95]
    global_load_dwordx2 v[10:11], v28, s[22:23] offset:0
    ds_read_b128 v[32:35], v4 offset:9216
    ds_read_b128 v[36:39], v4 offset:41984
    s_waitcnt lgkmcnt(4)
    v_mfma_f32_32x32x16_bf16 v[64:79], v[156:159], v[40:43], v[64:79]
    v_mfma_f32_32x32x16_bf16 v[80:95], v[156:159], v[44:47], v[80:95]
    global_load_dwordx2 v[12:13], v28, s[22:23] offset:16
    ds_read_b128 v[40:43], v4 offset:10240
    ds_read_b128 v[44:47], v4 offset:43008
    s_waitcnt lgkmcnt(4)
    v_mfma_f32_32x32x16_bf16 v[64:79], v[160:163], v[48:51], v[64:79]
    v_mfma_f32_32x32x16_bf16 v[80:95], v[160:163], v[52:55], v[80:95]
    ds_read_b128 v[48:51], v4 offset:11264
    ds_read_b128 v[52:55], v4 offset:44032
    v_pk_add_f32 v[56:57], v[56:57], v[58:59]
    v_pk_add_f32 v[60:61], v[60:61], v[62:63]
    v_pk_add_f32 v[18:19], v[56:57], v[60:61]
    v_mul_f32 v21, 0xbb000000, v18
    v_mul_f32 v19, 0x3b000000, v19
    v_fma_f32 v19, -v21, v21, v19
    v_max_f32 v19, 0, v19
    v_add_f32 v19, 0x3727c5ac, v19
    v_rsq_f32 v20, v19
    s_nop 0
    s_waitcnt lgkmcnt(4)
    v_mfma_f32_32x32x16_bf16 v[64:79], v[164:167], v[32:35], v[64:79]
    v_mfma_f32_32x32x16_bf16 v[80:95], v[164:167], v[36:39], v[80:95]
    ds_read_b128 v[32:35], v4 offset:12288
    ds_read_b128 v[36:39], v4 offset:45056
    s_waitcnt lgkmcnt(4)
    v_mfma_f32_32x32x16_bf16 v[64:79], v[168:171], v[40:43], v[64:79]
    v_mfma_f32_32x32x16_bf16 v[80:95], v[168:171], v[44:47], v[80:95]
    ds_read_b128 v[40:43], v4 offset:13312
    ds_read_b128 v[44:47], v4 offset:46080
    s_waitcnt lgkmcnt(4)
    v_mfma_f32_32x32x16_bf16 v[64:79], v[172:175], v[48:51], v[64:79]
    v_mfma_f32_32x32x16_bf16 v[80:95], v[172:175], v[52:55], v[80:95]
    ds_read_b128 v[48:51], v4 offset:14336
    ds_read_b128 v[52:55], v4 offset:47104
    s_waitcnt lgkmcnt(4)
    v_mfma_f32_32x32x16_bf16 v[64:79], v[176:179], v[32:35], v[64:79]
    v_mfma_f32_32x32x16_bf16 v[80:95], v[176:179], v[36:39], v[80:95]
    ds_read_b128 v[32:35], v4 offset:15360
    ds_read_b128 v[36:39], v4 offset:48128
    s_waitcnt lgkmcnt(4)
    v_mfma_f32_32x32x16_bf16 v[64:79], v[180:183], v[40:43], v[64:79]
    v_mfma_f32_32x32x16_bf16 v[80:95], v[180:183], v[44:47], v[80:95]
    s_waitcnt vmcnt(6)
    s_barrier
    ds_read_b128 v[40:43], v4 offset:16384
    ds_read_b128 v[44:47], v4 offset:49152
    s_waitcnt lgkmcnt(4)
    v_mfma_f32_32x32x16_bf16 v[64:79], v[184:187], v[48:51], v[64:79]
    v_mfma_f32_32x32x16_bf16 v[80:95], v[184:187], v[52:55], v[80:95]
    s_add_u32 m0, s69, 73728
    s_add_u32 s75, s88, 0
    buffer_load_dwordx4 v2, s[52:55], s75 offen lds
    ds_read_b128 v[48:51], v4 offset:17408
    ds_read_b128 v[52:55], v4 offset:50176
    s_waitcnt lgkmcnt(4)
    v_mfma_f32_32x32x16_bf16 v[64:79], v[188:191], v[32:35], v[64:79]
    v_mfma_f32_32x32x16_bf16 v[80:95], v[188:191], v[36:39], v[80:95]
    s_add_u32 m0, s69, 81920
    s_add_u32 s75, s88, 16384
    buffer_load_dwordx4 v2, s[52:55], s75 offen lds
    ds_read_b128 v[32:35], v4 offset:18432
    ds_read_b128 v[36:39], v4 offset:51200
    s_waitcnt lgkmcnt(4)
    v_mfma_f32_32x32x16_bf16 v[64:79], v[192:195], v[40:43], v[64:79]
    v_mfma_f32_32x32x16_bf16 v[80:95], v[192:195], v[44:47], v[80:95]
    s_add_u32 m0, s69, 90112
    s_add_u32 s75, s88, 32768
    buffer_load_dwordx4 v2, s[52:55], s75 offen lds
    ds_read_b128 v[40:43], v4 offset:19456
    ds_read_b128 v[44:47], v4 offset:52224
    s_waitcnt lgkmcnt(4)
    v_mfma_f32_32x32x16_bf16 v[64:79], v[196:199], v[48:51], v[64:79]
    v_mfma_f32_32x32x16_bf16 v[80:95], v[196:199], v[52:55], v[80:95]
    s_add_u32 m0, s69, 98304
    s_add_u32 s75, s88, 49152
    buffer_load_dwordx4 v2, s[52:55], s75 offen lds
    ds_read_b128 v[48:51], v4 offset:20480
    ds_read_b128 v[52:55], v4 offset:53248
    s_waitcnt lgkmcnt(4)
    v_mfma_f32_32x32x16_bf16 v[64:79], v[200:203], v[32:35], v[64:79]
    v_mfma_f32_32x32x16_bf16 v[80:95], v[200:203], v[36:39], v[80:95]
    s_add_u32 m0, s69, 106496
    s_add_u32 s75, s88, 65536
    buffer_load_dwordx4 v2, s[52:55], s75 offen lds
    ds_read_b128 v[32:35], v4 offset:21504
    ds_read_b128 v[36:39], v4 offset:54272
    s_waitcnt lgkmcnt(4)
    v_mfma_f32_32x32x16_bf16 v[64:79], v[204:207], v[40:43], v[64:79]
    v_mfma_f32_32x32x16_bf16 v[80:95], v[204:207], v[44:47], v[80:95]
    s_add_u32 m0, s69, 114688
    s_add_u32 s75, s88, 81920
    buffer_load_dwordx4 v2, s[52:55], s75 offen lds
    ds_read_b128 v[40:43], v4 offset:22528
    ds_read_b128 v[44:47], v4 offset:55296
    s_waitcnt lgkmcnt(4)
    v_mfma_f32_32x32x16_bf16 v[64:79], v[208:211], v[48:51], v[64:79]
    v_mfma_f32_32x32x16_bf16 v[80:95], v[208:211], v[52:55], v[80:95]
    s_add_u32 m0, s69, 122880
    s_add_u32 s75, s88, 98304
    buffer_load_dwordx4 v2, s[52:55], s75 offen lds
    ds_read_b128 v[48:51], v4 offset:23552
    ds_read_b128 v[52:55], v4 offset:56320
    s_waitcnt lgkmcnt(4)
    v_mfma_f32_32x32x16_bf16 v[64:79], v[212:215], v[32:35], v[64:79]
    v_mfma_f32_32x32x16_bf16 v[80:95], v[212:215], v[36:39], v[80:95]
    s_add_u32 m0, s69, 131072
    s_add_u32 s75, s88, 114688
    buffer_load_dwordx4 v2, s[52:55], s75 offen lds
    ds_read_b128 v[32:35], v4 offset:24576
    ds_read_b128 v[36:39], v4 offset:57344
    s_waitcnt lgkmcnt(4)
    v_mfma_f32_32x32x16_bf16 v[64:79], v[216:219], v[40:43], v[64:79]
    v_mfma_f32_32x32x16_bf16 v[80:95], v[216:219], v[44:47], v[80:95]
    s_add_u32 m0, s69, 139264
    s_add_u32 s75, s88, 131072
    buffer_load_dwordx4 v2, s[52:55], s75 offen lds
    ds_read_b128 v[40:43], v4 offset:25600
    ds_read_b128 v[44:47], v4 offset:58368
    s_waitcnt lgkmcnt(4)
    v_mfma_f32_32x32x16_bf16 v[64:79], v[220:223], v[48:51], v[64:79]
    v_mfma_f32_32x32x16_bf16 v[80:95], v[220:223], v[52:55], v[80:95]
    s_add_u32 m0, s69, 147456
    s_add_u32 s75, s88, 147456
    buffer_load_dwordx4 v2, s[52:55], s75 offen lds
    ds_read_b128 v[48:51], v4 offset:26624
    ds_read_b128 v[52:55], v4 offset:59392
    s_waitcnt lgkmcnt(4)
    v_mfma_f32_32x32x16_bf16 v[64:79], v[224:227], v[32:35], v[64:79]
    v_mfma_f32_32x32x16_bf16 v[80:95], v[224:227], v[36:39], v[80:95]
    s_add_u32 m0, s69, 155648
    s_add_u32 s75, s88, 163840
    buffer_load_dwordx4 v2, s[52:55], s75 offen lds
    ds_read_b128 v[32:35], v4 offset:27648
    ds_read_b128 v[36:39], v4 offset:60416
    s_waitcnt lgkmcnt(4)
    v_mfma_f32_32x32x16_bf16 v[64:79], v[228:231], v[40:43], v[64:79]
    v_mfma_f32_32x32x16_bf16 v[80:95], v[228:231], v[44:47], v[80:95]
    ds_read_b128 v[40:43], v4 offset:28672
    ds_read_b128 v[44:47], v4 offset:61440
    s_waitcnt lgkmcnt(4)
    v_mfma_f32_32x32x16_bf16 v[64:79], v[232:235], v[48:51], v[64:79]
    v_mfma_f32_32x32x16_bf16 v[80:95], v[232:235], v[52:55], v[80:95]
    s_waitcnt vmcnt(13)
    v_lshlrev_b32 v112, 16, v120
    v_and_b32 v113, 0xffff0000, v120
    v_lshlrev_b32 v114, 16, v121
    v_and_b32 v115, 0xffff0000, v121
    v_lshlrev_b32 v116, 16, v122
    v_and_b32 v117, 0xffff0000, v122
    v_lshlrev_b32 v118, 16, v123
    v_and_b32 v119, 0xffff0000, v123
    v_lshlrev_b32 v120, 16, v124
    v_and_b32 v121, 0xffff0000, v124
    v_lshlrev_b32 v122, 16, v125
    v_and_b32 v123, 0xffff0000, v125
    v_lshlrev_b32 v124, 16, v126
    v_and_b32 v125, 0xffff0000, v126
    v_lshlrev_b32 v126, 16, v127
    v_and_b32 v127, 0xffff0000, v127
    ds_read_b128 v[48:51], v4 offset:29696
    ds_read_b128 v[52:55], v4 offset:62464
    s_waitcnt lgkmcnt(4)
    v_mfma_f32_32x32x16_bf16 v[64:79], v[236:239], v[32:35], v[64:79]
    v_mfma_f32_32x32x16_bf16 v[80:95], v[236:239], v[36:39], v[80:95]
    ds_read_b128 v[32:35], v4 offset:30720
    ds_read_b128 v[36:39], v4 offset:63488
    s_waitcnt lgkmcnt(4)
    v_mfma_f32_32x32x16_bf16 v[64:79], v[240:243], v[40:43], v[64:79]
    v_mfma_f32_32x32x16_bf16 v[80:95], v[240:243], v[44:47], v[80:95]
    ds_read_b128 v[40:43], v4 offset:31744
    ds_read_b128 v[44:47], v4 offset:64512
    v_mul_f32 v17, v17, v16
    v_pk_fma_f32 v[128:129], v[96:97], v[16:17], v[112:113] op_sel:[0,1,0] op_sel_hi:[1,1,1]
    v_pk_fma_f32 v[130:131], v[98:99], v[16:17], v[114:115] op_sel:[0,1,0] op_sel_hi:[1,1,1]
    v_pk_fma_f32 v[132:133], v[100:101], v[16:17], v[116:117] op_sel:[0,1,0] op_sel_hi:[1,1,1]
    v_pk_fma_f32 v[134:135], v[102:103], v[16:17], v[118:119] op_sel:[0,1,0] op_sel_hi:[1,1,1]
    v_pk_fma_f32 v[136:137], v[104:105], v[16:17], v[120:121] op_sel:[0,1,0] op_sel_hi:[1,1,1]
    v_pk_fma_f32 v[138:139], v[106:107], v[16:17], v[122:123] op_sel:[0,1,0] op_sel_hi:[1,1,1]
    v_pk_fma_f32 v[140:141], v[108:109], v[16:17], v[124:125] op_sel:[0,1,0] op_sel_hi:[1,1,1]
    v_pk_fma_f32 v[142:143], v[110:111], v[16:17], v[126:127] op_sel:[0,1,0] op_sel_hi:[1,1,1]
    s_waitcnt lgkmcnt(4)
    v_mfma_f32_32x32x16_bf16 v[64:79], v[244:247], v[48:51], v[64:79]
    v_mfma_f32_32x32x16_bf16 v[80:95], v[244:247], v[52:55], v[80:95]
    v_mul_f32 v21, v21, v20
    v_pk_fma_f32 v[112:113], v[96:97], v[20:21], v[112:113] op_sel:[0,1,0] op_sel_hi:[1,1,1]
    v_pk_fma_f32 v[114:115], v[98:99], v[20:21], v[114:115] op_sel:[0,1,0] op_sel_hi:[1,1,1]
    v_pk_fma_f32 v[116:117], v[100:101], v[20:21], v[116:117] op_sel:[0,1,0] op_sel_hi:[1,1,1]
    v_pk_fma_f32 v[118:119], v[102:103], v[20:21], v[118:119] op_sel:[0,1,0] op_sel_hi:[1,1,1]
    v_pk_fma_f32 v[120:121], v[104:105], v[20:21], v[120:121] op_sel:[0,1,0] op_sel_hi:[1,1,1]
    v_pk_fma_f32 v[122:123], v[106:107], v[20:21], v[122:123] op_sel:[0,1,0] op_sel_hi:[1,1,1]
    v_pk_fma_f32 v[124:125], v[108:109], v[20:21], v[124:125] op_sel:[0,1,0] op_sel_hi:[1,1,1]
    v_pk_fma_f32 v[126:127], v[110:111], v[20:21], v[126:127] op_sel:[0,1,0] op_sel_hi:[1,1,1]
    s_waitcnt lgkmcnt(2)
    v_mfma_f32_32x32x16_bf16 v[64:79], v[248:251], v[32:35], v[64:79]
    v_mfma_f32_32x32x16_bf16 v[80:95], v[248:251], v[36:39], v[80:95]
    s_waitcnt lgkmcnt(0)
    v_mfma_f32_32x32x16_bf16 v[64:79], v[252:255], v[40:43], v[64:79]
    v_mfma_f32_32x32x16_bf16 v[80:95], v[252:255], v[44:47], v[80:95]
    s_waitcnt vmcnt(0)
    s_barrier
    s_setprio 3
    s_nop 9
    v_pk_fma_f32 v[64:65], v[64:65], v[16:17], v[128:129] op_sel:[0,0,0] op_sel_hi:[1,0,1]
    v_max_f32 v64, 0, v64
    v_max_f32 v65, 0, v65
    v_pk_mul_f32 v[64:65], v[64:65], v[64:65]
    v_cvt_pk_bf16_f32 v36, v64, v65
    v_pk_fma_f32 v[66:67], v[66:67], v[16:17], v[130:131] op_sel:[0,0,0] op_sel_hi:[1,0,1]
    v_max_f32 v66, 0, v66
    v_max_f32 v67, 0, v67
    v_pk_mul_f32 v[66:67], v[66:67], v[66:67]
    v_cvt_pk_bf16_f32 v37, v66, v67
    v_pk_fma_f32 v[68:69], v[68:69], v[16:17], v[132:133] op_sel:[0,0,0] op_sel_hi:[1,0,1]
    v_max_f32 v68, 0, v68
    v_max_f32 v69, 0, v69
    v_pk_mul_f32 v[68:69], v[68:69], v[68:69]
    v_cvt_pk_bf16_f32 v38, v68, v69
    v_pk_fma_f32 v[70:71], v[70:71], v[16:17], v[134:135] op_sel:[0,0,0] op_sel_hi:[1,0,1]
    v_max_f32 v70, 0, v70
    v_max_f32 v71, 0, v71
    v_pk_mul_f32 v[70:71], v[70:71], v[70:71]
    v_cvt_pk_bf16_f32 v39, v70, v71
    v_pk_fma_f32 v[72:73], v[72:73], v[16:17], v[136:137] op_sel:[0,0,0] op_sel_hi:[1,0,1]
    v_max_f32 v72, 0, v72
    v_max_f32 v73, 0, v73
    v_pk_mul_f32 v[72:73], v[72:73], v[72:73]
    v_cvt_pk_bf16_f32 v40, v72, v73
    v_pk_fma_f32 v[74:75], v[74:75], v[16:17], v[138:139] op_sel:[0,0,0] op_sel_hi:[1,0,1]
    v_max_f32 v74, 0, v74
    v_max_f32 v75, 0, v75
    v_pk_mul_f32 v[74:75], v[74:75], v[74:75]
    v_cvt_pk_bf16_f32 v41, v74, v75
    v_pk_fma_f32 v[76:77], v[76:77], v[16:17], v[140:141] op_sel:[0,0,0] op_sel_hi:[1,0,1]
    v_max_f32 v76, 0, v76
    v_max_f32 v77, 0, v77
    v_pk_mul_f32 v[76:77], v[76:77], v[76:77]
    v_cvt_pk_bf16_f32 v42, v76, v77
    v_pk_fma_f32 v[78:79], v[78:79], v[16:17], v[142:143] op_sel:[0,0,0] op_sel_hi:[1,0,1]
    v_max_f32 v78, 0, v78
    v_max_f32 v79, 0, v79
    v_pk_mul_f32 v[78:79], v[78:79], v[78:79]
    v_cvt_pk_bf16_f32 v43, v78, v79
    buffer_store_dwordx4 v[36:39], v4, s[56:59], s72 offen sc1
    buffer_store_dwordx4 v[40:43], v4, s[56:59], s72 offen offset:1024 sc1
    s_add_u32 s72, s72, 88064
    v_pk_fma_f32 v[80:81], v[80:81], v[20:21], v[112:113] op_sel:[0,0,0] op_sel_hi:[1,0,1]
    v_max_f32 v80, 0, v80
    v_max_f32 v81, 0, v81
    v_pk_mul_f32 v[80:81], v[80:81], v[80:81]
    v_cvt_pk_bf16_f32 v44, v80, v81
    v_pk_fma_f32 v[82:83], v[82:83], v[20:21], v[114:115] op_sel:[0,0,0] op_sel_hi:[1,0,1]
    v_max_f32 v82, 0, v82
    v_max_f32 v83, 0, v83
    v_pk_mul_f32 v[82:83], v[82:83], v[82:83]
    v_cvt_pk_bf16_f32 v45, v82, v83
    v_pk_fma_f32 v[84:85], v[84:85], v[20:21], v[116:117] op_sel:[0,0,0] op_sel_hi:[1,0,1]
    v_max_f32 v84, 0, v84
    v_max_f32 v85, 0, v85
    v_pk_mul_f32 v[84:85], v[84:85], v[84:85]
    v_cvt_pk_bf16_f32 v46, v84, v85
    v_pk_fma_f32 v[86:87], v[86:87], v[20:21], v[118:119] op_sel:[0,0,0] op_sel_hi:[1,0,1]
    v_max_f32 v86, 0, v86
    v_max_f32 v87, 0, v87
    v_pk_mul_f32 v[86:87], v[86:87], v[86:87]
    v_cvt_pk_bf16_f32 v47, v86, v87
    v_pk_fma_f32 v[88:89], v[88:89], v[20:21], v[120:121] op_sel:[0,0,0] op_sel_hi:[1,0,1]
    v_max_f32 v88, 0, v88
    v_max_f32 v89, 0, v89
    v_pk_mul_f32 v[88:89], v[88:89], v[88:89]
    v_cvt_pk_bf16_f32 v48, v88, v89
    v_pk_fma_f32 v[90:91], v[90:91], v[20:21], v[122:123] op_sel:[0,0,0] op_sel_hi:[1,0,1]
    v_max_f32 v90, 0, v90
    v_max_f32 v91, 0, v91
    v_pk_mul_f32 v[90:91], v[90:91], v[90:91]
    v_cvt_pk_bf16_f32 v49, v90, v91
    v_pk_fma_f32 v[92:93], v[92:93], v[20:21], v[124:125] op_sel:[0,0,0] op_sel_hi:[1,0,1]
    v_max_f32 v92, 0, v92
    v_max_f32 v93, 0, v93
    v_pk_mul_f32 v[92:93], v[92:93], v[92:93]
    v_cvt_pk_bf16_f32 v50, v92, v93
    v_pk_fma_f32 v[94:95], v[94:95], v[20:21], v[126:127] op_sel:[0,0,0] op_sel_hi:[1,0,1]
    v_max_f32 v94, 0, v94
    v_max_f32 v95, 0, v95
    v_pk_mul_f32 v[94:95], v[94:95], v[94:95]
    v_cvt_pk_bf16_f32 v51, v94, v95
    buffer_store_dwordx4 v[44:47], v4, s[56:59], s72 offen sc1
    buffer_store_dwordx4 v[48:51], v4, s[56:59], s72 offen offset:1024 sc1
    v_lshlrev_b32 v26, 8, v1
    v_add_u32 v26, s73, v26
    s_and_b32 s72, s77, 1
    s_lshl_b32 s72, s72, 5
    v_xor_b32 v22, s72, v5
    s_lshl_b32 s72, s77, 11
    s_lshr_b32 s73, s77, 1
    s_lshl_b32 s73, s73, 10
    s_add_u32 s72, s72, s73
    v_add_u32 v22, s72, v22
    v_xor_b32 v23, 1024, v22
    v_add_u32 v22, 73728, v22
    v_add_u32 v23, 73728, v23
    v_add_u32 v24, 49152, v22
    v_add_u32 v25, 49152, v23
    ds_read_b64_tr_b16 v[168:169], v22 offset:0
    ds_read_b64_tr_b16 v[170:171], v22 offset:512
    ds_read_b64_tr_b16 v[172:173], v23 offset:0
    ds_read_b64_tr_b16 v[174:175], v23 offset:512
    ds_read_b64_tr_b16 v[176:177], v22 offset:8192
    ds_read_b64_tr_b16 v[178:179], v22 offset:8704
    ds_read_b64_tr_b16 v[180:181], v23 offset:8192
    ds_read_b64_tr_b16 v[182:183], v23 offset:8704
    ds_read_b64_tr_b16 v[184:185], v22 offset:16384
    ds_read_b64_tr_b16 v[186:187], v22 offset:16896
    ds_read_b64_tr_b16 v[188:189], v23 offset:16384
    ds_read_b64_tr_b16 v[190:191], v23 offset:16896
    ds_read_b64_tr_b16 v[192:193], v22 offset:24576
    ds_read_b64_tr_b16 v[194:195], v22 offset:25088
    ds_read_b64_tr_b16 v[196:197], v23 offset:24576
    s_waitcnt lgkmcnt(10)
    ds_read_b64_tr_b16 v[198:199], v23 offset:25088
    ds_read_b64_tr_b16 v[200:201], v22 offset:32768
    ds_read_b64_tr_b16 v[202:203], v22 offset:33280
    ds_read_b64_tr_b16 v[204:205], v23 offset:32768
    ds_read_b64_tr_b16 v[206:207], v23 offset:33280
    s_waitcnt lgkmcnt(10)
    ds_read_b64_tr_b16 v[208:209], v22 offset:40960
    ds_read_b64_tr_b16 v[210:211], v22 offset:41472
    ds_read_b64_tr_b16 v[212:213], v23 offset:40960
    ds_read_b64_tr_b16 v[214:215], v23 offset:41472
    ds_read_b64_tr_b16 v[216:217], v24 offset:0
    s_waitcnt lgkmcnt(10)
    ds_read_b64_tr_b16 v[218:219], v24 offset:512
    ds_read_b64_tr_b16 v[220:221], v25 offset:0
    ds_read_b64_tr_b16 v[222:223], v25 offset:512
    ds_read_b64_tr_b16 v[224:225], v24 offset:8192
    ds_read_b64_tr_b16 v[226:227], v24 offset:8704
    s_waitcnt lgkmcnt(10)
    ds_read_b64_tr_b16 v[228:229], v25 offset:8192
    ds_read_b64_tr_b16 v[230:231], v25 offset:8704
    ds_read_b64_tr_b16 v[232:233], v24 offset:16384
    ds_read_b64_tr_b16 v[234:235], v24 offset:16896
    ds_read_b64_tr_b16 v[236:237], v25 offset:16384
    s_waitcnt lgkmcnt(10)
    ds_read_b64_tr_b16 v[238:239], v25 offset:16896
    ds_read_b64_tr_b16 v[240:241], v24 offset:24576
    ds_read_b64_tr_b16 v[242:243], v24 offset:25088
    ds_read_b64_tr_b16 v[244:245], v25 offset:24576
    ds_read_b64_tr_b16 v[246:247], v25 offset:25088
    s_waitcnt lgkmcnt(10)
    ds_read_b64_tr_b16 v[248:249], v24 offset:32768
    ds_read_b64_tr_b16 v[250:251], v24 offset:33280
    ds_read_b64_tr_b16 v[252:253], v25 offset:32768
    ds_read_b64_tr_b16 v[254:255], v25 offset:33280
    s_waitcnt lgkmcnt(0)
    s_barrier
    s_waitcnt vmcnt(0)
    s_mov_b64 exec, 3
    s_cmp_eq_u32 s95, 0
    s_cbranch_scc1 L_15
    buffer_store_dword v30, v26, s[56:59], 0 offen sc1
    s_branch L_16
L_15:
    buffer_store_dword v30, v26, s[56:59], 0 offen
L_16:
    s_mov_b64 exec, -1
    s_setprio 0
    s_branch L_f1join
L_small:
    s_setprio 2
    s_lshl_b32 s70, s78, 15
    v_add_u32 v26, s70, v4
    s_lshl_b32 s70, s78, 10
    v_add_u32 v25, s70, v25
    ds_read_b128 v[32:35], v26 offset:0
    ds_read_b128 v[36:39], v26 offset:1024
    ds_read_b128 v[40:43], v26 offset:2048
    ds_read_b128 v[44:47], v26 offset:3072
    ds_read_b128 v[48:51], v26 offset:4096
    ds_read_b128 v[52:55], v26 offset:5120
    ds_read_b64 v[56:57], v25 offset:0
    ds_read_b64 v[58:59], v25 offset:256
    ds_read_b64 v[60:61], v25 offset:512
    ds_read_b64 v[62:63], v25 offset:768
    s_waitcnt lgkmcnt(9)
    v_mfma_f32_32x32x16_bf16 v[64:79], v[128:131], v[32:35], 0
    s_add_u32 m0, s97, 16384
    s_add_u32 s75, s96, 16384
    buffer_load_dwordx4 v4, s[56:59], s75 offen sc1 lds
    s_add_u32 m0, s97, 17408
    s_add_u32 s75, s96, 17408
    buffer_load_dwordx4 v4, s[56:59], s75 offen sc1 lds
    ds_read_b128 v[32:35], v26 offset:6144
    s_waitcnt lgkmcnt(9)
    v_mfma_f32_32x32x16_bf16 v[64:79], v[132:135], v[36:39], v[64:79]
    s_add_u32 m0, s97, 18432
    s_add_u32 s75, s96, 18432
    buffer_load_dwordx4 v4, s[56:59], s75 offen sc1 lds
    s_add_u32 m0, s97, 19456
    s_add_u32 s75, s96, 19456
    buffer_load_dwordx4 v4, s[56:59], s75 offen sc1 lds
    ds_read_b128 v[36:39], v26 offset:7168
    s_waitcnt lgkmcnt(9)
    v_mfma_f32_32x32x16_bf16 v[64:79], v[136:139], v[40:43], v[64:79]
    global_load_dwordx2 v[120:121], v27, s[18:19] offset:0
    ds_read_b128 v[40:43], v26 offset:8192
    s_waitcnt lgkmcnt(9)
    v_mfma_f32_32x32x16_bf16 v[64:79], v[140:143], v[44:47], v[64:79]
    global_load_dwordx2 v[122:123], v27, s[18:19] offset:16
    ds_read_b128 v[44:47], v26 offset:9216
    s_waitcnt lgkmcnt(9)
    v_mfma_f32_32x32x16_bf16 v[64:79], v[144:147], v[48:51], v[64:79]
    global_load_dwordx2 v[124:125], v27, s[18:19] offset:32
    ds_read_b128 v[48:51], v26 offset:10240
    s_waitcnt lgkmcnt(9)
    v_mfma_f32_32x32x16_bf16 v[64:79], v[148:151], v[52:55], v[64:79]
    global_load_dwordx2 v[126:127], v27, s[18:19] offset:48
    ds_read_b128 v[52:55], v26 offset:11264
    s_waitcnt lgkmcnt(5)
    v_mfma_f32_32x32x16_bf16 v[64:79], v[152:155], v[32:35], v[64:79]
    global_load_dwordx2 v[10:11], v28, s[22:23] offset:0
    ds_read_b128 v[32:35], v26 offset:12288
    s_waitcnt lgkmcnt(5)
    v_mfma_f32_32x32x16_bf16 v[64:79], v[156:159], v[36:39], v[64:79]
    global_load_dwordx2 v[12:13], v28, s[22:23] offset:16
    ds_read_b128 v[36:39], v26 offset:13312
    v_pk_add_f32 v[56:57], v[56:57], v[58:59]
    v_pk_add_f32 v[60:61], v[60:61], v[62:63]
    v_pk_add_f32 v[14:15], v[56:57], v[60:61]
    v_mul_f32 v17, 0xbb000000, v14
    v_mul_f32 v15, 0x3b000000, v15
    v_fma_f32 v15, -v17, v17, v15
    v_max_f32 v15, 0, v15
    v_add_f32 v15, 0x3727c5ac, v15
    v_rsq_f32 v16, v15
    s_nop 0
    s_waitcnt lgkmcnt(5)
    v_mfma_f32_32x32x16_bf16 v[64:79], v[160:163], v[40:43], v[64:79]
    ds_read_b128 v[40:43], v26 offset:14336
    s_waitcnt lgkmcnt(5)
    v_mfma_f32_32x32x16_bf16 v[64:79], v[164:167], v[44:47], v[64:79]
    ds_read_b128 v[44:47], v26 offset:15360
    s_waitcnt lgkmcnt(5)
    v_mfma_f32_32x32x16_bf16 v[64:79], v[168:171], v[48:51], v[64:79]
    s_waitcnt vmcnt(6)
    s_barrier
    ds_read_b128 v[48:51], v26 offset:16384
    s_waitcnt lgkmcnt(5)
    v_mfma_f32_32x32x16_bf16 v[64:79], v[172:175], v[52:55], v[64:79]
    ds_read_b128 v[52:55], v26 offset:17408
    s_waitcnt lgkmcnt(5)
    v_mfma_f32_32x32x16_bf16 v[64:79], v[176:179], v[32:35], v[64:79]
    ds_read_b128 v[32:35], v26 offset:18432
    s_waitcnt lgkmcnt(5)
    v_mfma_f32_32x32x16_bf16 v[64:79], v[180:183], v[36:39], v[64:79]
    ds_read_b128 v[36:39], v26 offset:19456
    s_waitcnt lgkmcnt(5)
    v_mfma_f32_32x32x16_bf16 v[64:79], v[184:187], v[40:43], v[64:79]
    s_add_u32 m0, s69, 73728
    s_add_u32 s75, s88, 0
    buffer_load_dwordx4 v2, s[52:55], s75 offen lds
    ds_read_b128 v[40:43], v26 offset:20480
    s_waitcnt lgkmcnt(5)
    v_mfma_f32_32x32x16_bf16 v[64:79], v[188:191], v[44:47], v[64:79]
    s_add_u32 m0, s69, 81920
    s_add_u32 s75, s88, 16384
    buffer_load_dwordx4 v2, s[52:55], s75 offen lds
    ds_read_b128 v[44:47], v26 offset:21504
    s_waitcnt lgkmcnt(5)
    v_mfma_f32_32x32x16_bf16 v[64:79], v[192:195], v[48:51], v[64:79]
    s_add_u32 m0, s69, 90112
    s_add_u32 s75, s88, 32768
    buffer_load_dwordx4 v2, s[52:55], s75 offen lds
    ds_read_b128 v[48:51], v26 offset:22528
    s_waitcnt lgkmcnt(5)
    v_mfma_f32_32x32x16_bf16 v[64:79], v[196:199], v[52:55], v[64:79]
    s_add_u32 m0, s69, 98304
    s_add_u32 s75, s88, 49152
    buffer_load_dwordx4 v2, s[52:55], s75 offen lds
    ds_read_b128 v[52:55], v26 offset:23552
    s_waitcnt lgkmcnt(5)
    v_mfma_f32_32x32x16_bf16 v[64:79], v[200:203], v[32:35], v[64:79]
    s_add_u32 m0, s69, 106496
    s_add_u32 s75, s88, 65536
    buffer_load_dwordx4 v2, s[52:55], s75 offen lds
    ds_read_b128 v[32:35], v26 offset:24576
    s_waitcnt lgkmcnt(5)
    v_mfma_f32_32x32x16_bf16 v[64:79], v[204:207], v[36:39], v[64:79]
    s_add_u32 m0, s69, 114688
    s_add_u32 s75, s88, 81920
    buffer_load_dwordx4 v2, s[52:55], s75 offen lds
    ds_read_b128 v[36:39], v26 offset:25600
    s_waitcnt lgkmcnt(5)
    v_mfma_f32_32x32x16_bf16 v[64:79], v[208:211], v[40:43], v[64:79]
    s_add_u32 m0, s69, 122880
    s_add_u32 s75, s88, 98304
    buffer_load_dwordx4 v2, s[52:55], s75 offen lds
    ds_read_b128 v[40:43], v26 offset:26624
    s_waitcnt lgkmcnt(5)
    v_mfma_f32_32x32x16_bf16 v[64:79], v[212:215], v[44:47], v[64:79]
    s_add_u32 m0, s69, 131072
    s_add_u32 s75, s88, 114688
    buffer_load_dwordx4 v2, s[52:55], s75 offen lds
    ds_read_b128 v[44:47], v26 offset:27648
    s_waitcnt lgkmcnt(5)
    v_mfma_f32_32x32x16_bf16 v[64:79], v[216:219], v[48:51], v[64:79]
    s_add_u32 m0, s69, 139264
    s_add_u32 s75, s88, 131072
    buffer_load_dwordx4 v2, s[52:55], s75 offen lds
    ds_read_b128 v[48:51], v26 offset:28672
    s_waitcnt lgkmcnt(5)
    v_mfma_f32_32x32x16_bf16 v[64:79], v[220:223], v[52:55], v[64:79]
    s_add_u32 m0, s69, 147456
    s_add_u32 s75, s88, 147456
    buffer_load_dwordx4 v2, s[52:55], s75 offen lds
    ds_read_b128 v[52:55], v26 offset:29696
    s_waitcnt lgkmcnt(5)
    v_mfma_f32_32x32x16_bf16 v[64:79], v[224:227], v[32:35], v[64:79]
    s_add_u32 m0, s69, 155648
    s_add_u32 s75, s88, 163840
    buffer_load_dwordx4 v2, s[52:55], s75 offen lds
    ds_read_b128 v[32:35], v26 offset:30720
    s_waitcnt lgkmcnt(5)
    v_mfma_f32_32x32x16_bf16 v[64:79], v[228:231], v[36:39], v[64:79]
    ds_read_b128 v[36:39], v26 offset:31744
    s_waitcnt lgkmcnt(5)
    v_mfma_f32_32x32x16_bf16 v[64:79], v[232:235], v[40:43], v[64:79]
    s_waitcnt vmcnt(13)
    v_lshlrev_b32 v112, 16, v120
    v_and_b32 v113, 0xffff0000, v120
    v_lshlrev_b32 v114, 16, v121
    v_and_b32 v115, 0xffff0000, v121
    v_lshlrev_b32 v116, 16, v122
    v_and_b32 v117, 0xffff0000, v122
    v_lshlrev_b32 v118, 16, v123
    v_and_b32 v119, 0xffff0000, v123
    v_lshlrev_b32 v120, 16, v124
    v_and_b32 v121, 0xffff0000, v124
    v_lshlrev_b32 v122, 16, v125
    v_and_b32 v123, 0xffff0000, v125
    v_lshlrev_b32 v124, 16, v126
    v_and_b32 v125, 0xffff0000, v126
    v_lshlrev_b32 v126, 16, v127
    v_and_b32 v127, 0xffff0000, v127
    s_waitcnt lgkmcnt(4)
    v_mfma_f32_32x32x16_bf16 v[64:79], v[236:239], v[44:47], v[64:79]
    s_waitcnt lgkmcnt(3)
    v_mfma_f32_32x32x16_bf16 v[64:79], v[240:243], v[48:51], v[64:79]
    v_mul_f32 v17, v17, v16
    v_pk_fma_f32 v[112:113], v[96:97], v[16:17], v[112:113] op_sel:[0,1,0] op_sel_hi:[1,1,1]
    v_pk_fma_f32 v[114:115], v[98:99], v[16:17], v[114:115] op_sel:[0,1,0] op_sel_hi:[1,1,1]
    v_pk_fma_f32 v[116:117], v[100:101], v[16:17], v[116:117] op_sel:[0,1,0] op_sel_hi:[1,1,1]
    v_pk_fma_f32 v[118:119], v[102:103], v[16:17], v[118:119] op_sel:[0,1,0] op_sel_hi:[1,1,1]
    v_pk_fma_f32 v[120:121], v[104:105], v[16:17], v[120:121] op_sel:[0,1,0] op_sel_hi:[1,1,1]
    v_pk_fma_f32 v[122:123], v[106:107], v[16:17], v[122:123] op_sel:[0,1,0] op_sel_hi:[1,1,1]
    v_pk_fma_f32 v[124:125], v[108:109], v[16:17], v[124:125] op_sel:[0,1,0] op_sel_hi:[1,1,1]
    v_pk_fma_f32 v[126:127], v[110:111], v[16:17], v[126:127] op_sel:[0,1,0] op_sel_hi:[1,1,1]
    s_waitcnt lgkmcnt(2)
    v_mfma_f32_32x32x16_bf16 v[64:79], v[244:247], v[52:55], v[64:79]
    s_waitcnt lgkmcnt(1)
    v_mfma_f32_32x32x16_bf16 v[64:79], v[248:251], v[32:35], v[64:79]
    s_waitcnt lgkmcnt(0)
    v_mfma_f32_32x32x16_bf16 v[64:79], v[252:255], v[36:39], v[64:79]
    s_mul_i32 s70, s78, 88064
    s_add_u32 s72, s72, s70
    s_lshl_b32 s70, s78, 8
    s_add_u32 s73, s73, s70
    v_mov_b32 v26, s73
    s_nop 7
    v_pk_fma_f32 v[64:65], v[64:65], v[16:17], v[112:113] op_sel:[0,0,0] op_sel_hi:[1,0,1]
    v_max_f32 v64, 0, v64
    v_max_f32 v65, 0, v65
    v_pk_mul_f32 v[64:65], v[64:65], v[64:65]
    v_cvt_pk_bf16_f32 v36, v64, v65
    v_pk_fma_f32 v[66:67], v[66:67], v[16:17], v[114:115] op_sel:[0,0,0] op_sel_hi:[1,0,1]
    v_max_f32 v66, 0, v66
    v_max_f32 v67, 0, v67
    v_pk_mul_f32 v[66:67], v[66:67], v[66:67]
    v_cvt_pk_bf16_f32 v37, v66, v67
    v_pk_fma_f32 v[68:69], v[68:69], v[16:17], v[116:117] op_sel:[0,0,0] op_sel_hi:[1,0,1]
    v_max_f32 v68, 0, v68
    v_max_f32 v69, 0, v69
    v_pk_mul_f32 v[68:69], v[68:69], v[68:69]
    v_cvt_pk_bf16_f32 v38, v68, v69
    v_pk_fma_f32 v[70:71], v[70:71], v[16:17], v[118:119] op_sel:[0,0,0] op_sel_hi:[1,0,1]
    v_max_f32 v70, 0, v70
    v_max_f32 v71, 0, v71
    v_pk_mul_f32 v[70:71], v[70:71], v[70:71]
    v_cvt_pk_bf16_f32 v39, v70, v71
    v_pk_fma_f32 v[72:73], v[72:73], v[16:17], v[120:121] op_sel:[0,0,0] op_sel_hi:[1,0,1]
    v_max_f32 v72, 0, v72
    v_max_f32 v73, 0, v73
    v_pk_mul_f32 v[72:73], v[72:73], v[72:73]
    v_cvt_pk_bf16_f32 v40, v72, v73
    v_pk_fma_f32 v[74:75], v[74:75], v[16:17], v[122:123] op_sel:[0,0,0] op_sel_hi:[1,0,1]
    v_max_f32 v74, 0, v74
    v_max_f32 v75, 0, v75
    v_pk_mul_f32 v[74:75], v[74:75], v[74:75]
    v_cvt_pk_bf16_f32 v41, v74, v75
    v_pk_fma_f32 v[76:77], v[76:77], v[16:17], v[124:125] op_sel:[0,0,0] op_sel_hi:[1,0,1]
    v_max_f32 v76, 0, v76
    v_max_f32 v77, 0, v77
    v_pk_mul_f32 v[76:77], v[76:77], v[76:77]
    v_cvt_pk_bf16_f32 v42, v76, v77
    v_pk_fma_f32 v[78:79], v[78:79], v[16:17], v[126:127] op_sel:[0,0,0] op_sel_hi:[1,0,1]
    v_max_f32 v78, 0, v78
    v_max_f32 v79, 0, v79
    v_pk_mul_f32 v[78:79], v[78:79], v[78:79]
    v_cvt_pk_bf16_f32 v43, v78, v79
    buffer_store_dwordx4 v[36:39], v4, s[56:59], s72 offen sc1
    buffer_store_dwordx4 v[40:43], v4, s[56:59], s72 offen offset:1024 sc1
    s_setprio 0
    s_waitcnt vmcnt(2)
    s_barrier
    s_add_u32 m0, s69, 0
    s_add_u32 s75, s88, 180224
    buffer_load_dwordx4 v2, s[52:55], s75 offen lds
    s_add_u32 m0, s69, 8192
    s_add_u32 s75, s88, 196608
    buffer_load_dwordx4 v2, s[52:55], s75 offen lds
    s_add_u32 m0, s69, 16384
    s_add_u32 s75, s88, 212992
    buffer_load_dwordx4 v2, s[52:55], s75 offen lds
    s_add_u32 m0, s69, 24576
    s_add_u32 s75, s88, 229376
    buffer_load_dwordx4 v2, s[52:55], s75 offen lds
    s_add_u32 m0, s69, 32768
    s_add_u32 s75, s88, 245760
    buffer_load_dwordx4 v2, s[52:55], s75 offen lds
    s_add_u32 m0, s69, 40960
    s_add_u32 s75, s88, 262144
    buffer_load_dwordx4 v2, s[52:55], s75 offen lds
    s_add_u32 m0, s69, 49152
    s_add_u32 s75, s88, 278528
    buffer_load_dwordx4 v2, s[52:55], s75 offen lds
    s_add_u32 m0, s69, 57344
    s_add_u32 s75, s88, 294912
    buffer_load_dwordx4 v2, s[52:55], s75 offen lds
    s_and_b32 s72, s77, 1
    s_lshl_b32 s72, s72, 5
    v_xor_b32 v22, s72, v5
    s_lshl_b32 s72, s77, 11
    s_lshr_b32 s73, s77, 1
    s_lshl_b32 s73, s73, 10
    s_add_u32 s72, s72, s73
    v_add_u32 v22, s72, v22
    v_xor_b32 v23, 1024, v22
    v_add_u32 v22, 73728, v22
    v_add_u32 v23, 73728, v23
    v_add_u32 v24, 49152, v22
    v_add_u32 v25, 49152, v23
    ds_read_b64_tr_b16 v[168:169], v22 offset:0
    ds_read_b64_tr_b16 v[170:171], v22 offset:512
    ds_read_b64_tr_b16 v[172:173], v23 offset:0
    ds_read_b64_tr_b16 v[174:175], v23 offset:512
    ds_read_b64_tr_b16 v[176:177], v22 offset:8192
    ds_read_b64_tr_b16 v[178:179], v22 offset:8704
    ds_read_b64_tr_b16 v[180:181], v23 offset:8192
    ds_read_b64_tr_b16 v[182:183], v23 offset:8704
    ds_read_b64_tr_b16 v[184:185], v22 offset:16384
    ds_read_b64_tr_b16 v[186:187], v22 offset:16896
    ds_read_b64_tr_b16 v[188:189], v23 offset:16384
    ds_read_b64_tr_b16 v[190:191], v23 offset:16896
    ds_read_b64_tr_b16 v[192:193], v22 offset:24576
    ds_read_b64_tr_b16 v[194:195], v22 offset:25088
    ds_read_b64_tr_b16 v[196:197], v23 offset:24576
    s_waitcnt lgkmcnt(10)
    ds_read_b64_tr_b16 v[198:199], v23 offset:25088
    ds_read_b64_tr_b16 v[200:201], v22 offset:32768
    ds_read_b64_tr_b16 v[202:203], v22 offset:33280
    ds_read_b64_tr_b16 v[204:205], v23 offset:32768
    ds_read_b64_tr_b16 v[206:207], v23 offset:33280
    s_waitcnt lgkmcnt(10)
    ds_read_b64_tr_b16 v[208:209], v22 offset:40960
    ds_read_b64_tr_b16 v[210:211], v22 offset:41472
    ds_read_b64_tr_b16 v[212:213], v23 offset:40960
    ds_read_b64_tr_b16 v[214:215], v23 offset:41472
    ds_read_b64_tr_b16 v[216:217], v24 offset:0
    s_waitcnt lgkmcnt(10)
    ds_read_b64_tr_b16 v[218:219], v24 offset:512
    ds_read_b64_tr_b16 v[220:221], v25 offset:0
    ds_read_b64_tr_b16 v[222:223], v25 offset:512
    ds_read_b64_tr_b16 v[224:225], v24 offset:8192
    ds_read_b64_tr_b16 v[226:227], v24 offset:8704
    s_waitcnt lgkmcnt(10)
    ds_read_b64_tr_b16 v[228:229], v25 offset:8192
    ds_read_b64_tr_b16 v[230:231], v25 offset:8704
    ds_read_b64_tr_b16 v[232:233], v24 offset:16384
    ds_read_b64_tr_b16 v[234:235], v24 offset:16896
    ds_read_b64_tr_b16 v[236:237], v25 offset:16384
    s_waitcnt lgkmcnt(10)
    ds_read_b64_tr_b16 v[238:239], v25 offset:16896
    ds_read_b64_tr_b16 v[240:241], v24 offset:24576
    ds_read_b64_tr_b16 v[242:243], v24 offset:25088
    ds_read_b64_tr_b16 v[244:245], v25 offset:24576
    ds_read_b64_tr_b16 v[246:247], v25 offset:25088
    s_waitcnt lgkmcnt(10)
    ds_read_b64_tr_b16 v[248:249], v24 offset:32768
    ds_read_b64_tr_b16 v[250:251], v24 offset:33280
    ds_read_b64_tr_b16 v[252:253], v25 offset:32768
    ds_read_b64_tr_b16 v[254:255], v25 offset:33280
    s_waitcnt vmcnt(8)
    s_mov_b64 exec, 1
    s_cmp_eq_u32 s95, 0
    s_cbranch_scc1 L_17
    buffer_store_dword v30, v26, s[56:59], 0 offen sc1
    s_branch L_18
L_17:
    buffer_store_dword v30, v26, s[56:59], 0 offen
L_18:
    s_mov_b64 exec, -1
    s_sub_u32 s96, s88, 720896
    s_sub_u32 s97, s69, 4096
    s_add_u32 m0, s97, 0
    s_add_u32 s75, s96, 180224
    buffer_load_dwordx4 v2, s[52:55], s75 offen lds
    s_add_u32 m0, s97, 8192
    s_add_u32 s75, s96, 196608
    buffer_load_dwordx4 v2, s[52:55], s75 offen lds
    s_add_u32 m0, s97, 16384
    s_add_u32 s75, s96, 212992
    buffer_load_dwordx4 v2, s[52:55], s75 offen lds
    s_add_u32 m0, s97, 24576
    s_add_u32 s75, s96, 229376
    buffer_load_dwordx4 v2, s[52:55], s75 offen lds
    s_add_u32 m0, s97, 32768
    s_add_u32 s75, s96, 245760
    buffer_load_dwordx4 v2, s[52:55], s75 offen lds
    s_add_u32 m0, s97, 40960
    s_add_u32 s75, s96, 262144
    buffer_load_dwordx4 v2, s[52:55], s75 offen lds
    s_add_u32 m0, s97, 49152
    s_add_u32 s75, s96, 278528
    buffer_load_dwordx4 v2, s[52:55], s75 offen lds
    s_add_u32 m0, s97, 57344
    s_add_u32 s75, s96, 294912
    buffer_load_dwordx4 v2, s[52:55], s75 offen lds
    s_waitcnt lgkmcnt(0)
    s_barrier
    s_add_u32 m0, s69, 73728
    s_add_u32 s75, s88, 311296
    buffer_load_dwordx4 v2, s[52:55], s75 offen lds
    s_add_u32 m0, s97, 73728
    s_add_u32 s75, s96, 311296
    buffer_load_dwordx4 v2, s[52:55], s75 offen lds
    s_add_u32 m0, s69, 81920
    s_add_u32 s75, s88, 327680
    buffer_load_dwordx4 v2, s[52:55], s75 offen lds
    s_add_u32 m0, s97, 81920
    s_add_u32 s75, s96, 327680
    buffer_load_dwordx4 v2, s[52:55], s75 offen lds
    s_add_u32 m0, s69, 90112
    s_add_u32 s75, s88, 344064
    buffer_load_dwordx4 v2, s[52:55], s75 offen lds
    s_add_u32 m0, s97, 90112
    s_add_u32 s75, s96, 344064
    buffer_load_dwordx4 v2, s[52:55], s75 offen lds
L_f1join:
    s_waitcnt lgkmcnt(0)
    s_lshl_b32 s70, s64, 1
    s_add_u32 s70, s70, s91
    v_and_b32 v25, 31, v1
    v_lshlrev_b32 v25, 1, v25
    v_min_u32 v25, 41, v25
    v_lshrrev_b32 v26, 5, v1
    v_lshl_add_u32 v25, v26, 6, v25
    s_lshl_b32 s72, s64, 9
    s_add_u32 s72, s72, 24576
    v_lshlrev_b32 v25, 2, v25
    v_add_u32 v25, s72, v25
    s_mul_i32 s70, s70, 88064
    s_mul_i32 s73, s77, 22528
    s_add_u32 s70, s70, s73
    s_add_u32 s70, s70, 4456448
    v_add_u32 v22, 0xfffee000, v22
    v_add_u32 v23, 0xfffee000, v23
    s_waitcnt vmcnt(0)
    s_cmp_lg_u32 s66, 0
    s_cbranch_scc1 L_gpoll_x
    s_mov_b32 s90, 1048576
    buffer_load_dwordx2 v[152:153], v25, s[56:59], 0 offen sc1
    buffer_load_dwordx2 v[154:155], v25, s[56:59], 0 offen sc1
    buffer_load_dwordx2 v[156:157], v25, s[56:59], 0 offen sc1
L_gpoll:
    s_waitcnt vmcnt(2)
    v_xor_b32 v152, s67, v152
    v_xor_b32 v153, s67, v153
    v_or_b32 v152, v152, v153
    v_cmp_ne_u32 vcc, 0, v152
    s_cbranch_vccz L_gpoll_x
    buffer_load_dwordx2 v[152:153], v25, s[56:59], 0 offen sc1
    s_waitcnt vmcnt(2)
    v_xor_b32 v154, s67, v154
    v_xor_b32 v155, s67, v155
    v_or_b32 v154, v154, v155
    v_cmp_ne_u32 vcc, 0, v154
    s_cbranch_vccz L_gpoll_x
    buffer_load_dwordx2 v[154:155], v25, s[56:59], 0 offen sc1
    s_waitcnt vmcnt(2)
    v_xor_b32 v156, s67, v156
    v_xor_b32 v157, s67, v157
    v_or_b32 v156, v156, v157
    v_cmp_ne_u32 vcc, 0, v156
    s_cbranch_vccz L_gpoll_x
    buffer_load_dwordx2 v[156:157], v25, s[56:59], 0 offen sc1
    s_sub_u32 s90, s90, 1
    s_cbranch_scc0 L_gpoll
L_gpoll_x:
    s_barrier
    buffer_load_dwordx4 v[32:35], v4, s[56:59], s70 offen offset:0 sc1
    buffer_load_dwordx4 v[36:39], v4, s[56:59], s70 offen offset:1024 sc1
    buffer_load_dwordx4 v[40:43], v4, s[56:59], s70 offen offset:2048 sc1
    buffer_load_dwordx4 v[44:47], v4, s[56:59], s70 offen offset:3072 sc1
    s_add_u32 s70, s70, 4096
    buffer_load_dwordx4 v[48:51], v4, s[56:59], s70 offen offset:0 sc1
    buffer_load_dwordx4 v[52:55], v4, s[56:59], s70 offen offset:1024 sc1
    buffer_load_dwordx4 v[56:59], v4, s[56:59], s70 offen offset:2048 sc1
    buffer_load_dwordx4 v[60:63], v4, s[56:59], s70 offen offset:3072 sc1
    s_add_u32 s70, s70, 4096
    buffer_load_dwordx4 v[64:67], v4, s[56:59], s70 offen offset:0 sc1
    buffer_load_dwordx4 v[68:71], v4, s[56:59], s70 offen offset:1024 sc1
    buffer_load_dwordx4 v[72:75], v4, s[56:59], s70 offen offset:2048 sc1
    buffer_load_dwordx4 v[76:79], v4, s[56:59], s70 offen offset:3072 sc1
    v_add_u32 v24, 49152, v22
    v_add_u32 v25, 49152, v23
    s_xor_b32 s72, s66, 0
    s_mul_i32 s72, s72, 6144
    s_add_u32 s72, s72, 98304
    v_add_u32 v29, s72, v4
    s_xor_b32 s72, s66, 1
    s_mul_i32 s72, s72, 6144
    s_add_u32 s72, s72, 98304
    v_add_u32 v26, s72, v4
    s_xor_b32 s72, s66, 2
    s_mul_i32 s72, s72, 6144
    s_add_u32 s72, s72, 100352
    v_add_u32 v27, s72, v4
    s_xor_b32 s72, s66, 3
    s_mul_i32 s72, s72, 6144
    s_add_u32 s72, s72, 102400
    v_add_u32 v28, s72, v4
    s_waitcnt vmcnt(11)
    v_mfma_f32_32x32x16_bf16 v[120:135], v[168:171], v[32:35], 0
    v_mfma_f32_32x32x16_bf16 v[136:151], v[172:175], v[32:35], 0
    s_add_u32 s70, s70, 4096
    buffer_load_dwordx4 v[80:83], v4, s[56:59], s70 offen offset:0 sc1
    buffer_load_dwordx4 v[84:87], v4, s[56:59], s70 offen offset:1024 sc1
    s_waitcnt vmcnt(12)
    v_mfma_f32_32x32x16_bf16 v[120:135], v[176:179], v[36:39], v[120:135]
    v_mfma_f32_32x32x16_bf16 v[136:151], v[180:183], v[36:39], v[136:151]
    buffer_load_dwordx4 v[88:91], v4, s[56:59], s70 offen offset:2048 sc1
    buffer_load_dwordx4 v[92:95], v4, s[56:59], s70 offen offset:3072 sc1
    s_waitcnt vmcnt(13)
    v_mfma_f32_32x32x16_bf16 v[120:135], v[184:187], v[40:43], v[120:135]
    v_mfma_f32_32x32x16_bf16 v[136:151], v[188:191], v[40:43], v[136:151]
    s_add_u32 s70, s70, 4096
    buffer_load_dwordx4 v[96:99], v4, s[56:59], s70 offen offset:0 sc1
    buffer_load_dwordx4 v[100:103], v4, s[56:59], s70 offen offset:1024 sc1
    s_waitcnt vmcnt(14)
    v_mfma_f32_32x32x16_bf16 v[120:135], v[192:195], v[44:47], v[120:135]
    v_mfma_f32_32x32x16_bf16 v[136:151], v[196:199], v[44:47], v[136:151]
    buffer_load_dwordx4 v[104:107], v4, s[56:59], s70 offen offset:2048 sc1
    buffer_load_dwordx4 v[108:111], v4, s[56:59], s70 offen offset:3072 sc1
    s_waitcnt vmcnt(15)
    v_mfma_f32_32x32x16_bf16 v[120:135], v[200:203], v[48:51], v[120:135]
    v_mfma_f32_32x32x16_bf16 v[136:151], v[204:207], v[48:51], v[136:151]
    s_add_u32 s70, s70, 4096
    buffer_load_dwordx4 v[112:115], v4, s[56:59], s70 offen offset:0 sc1
    buffer_load_dwordx4 v[116:119], v4, s[56:59], s70 offen offset:1024 sc1
    s_waitcnt vmcnt(16)
    v_mfma_f32_32x32x16_bf16 v[120:135], v[208:211], v[52:55], v[120:135]
    v_mfma_f32_32x32x16_bf16 v[136:151], v[212:215], v[52:55], v[136:151]
    s_waitcnt vmcnt(15)
    v_mfma_f32_32x32x16_bf16 v[120:135], v[216:219], v[56:59], v[120:135]
    v_mfma_f32_32x32x16_bf16 v[136:151], v[220:223], v[56:59], v[136:151]
    s_waitcnt vmcnt(14)
    v_mfma_f32_32x32x16_bf16 v[120:135], v[224:227], v[60:63], v[120:135]
    v_mfma_f32_32x32x16_bf16 v[136:151], v[228:231], v[60:63], v[136:151]
    s_waitcnt vmcnt(13)
    v_mfma_f32_32x32x16_bf16 v[120:135], v[232:235], v[64:67], v[120:135]
    v_mfma_f32_32x32x16_bf16 v[136:151], v[236:239], v[64:67], v[136:151]
    s_waitcnt vmcnt(12)
    v_mfma_f32_32x32x16_bf16 v[120:135], v[240:243], v[68:71], v[120:135]
    v_mfma_f32_32x32x16_bf16 v[136:151], v[244:247], v[68:71], v[136:151]
    s_waitcnt vmcnt(11)
    v_mfma_f32_32x32x16_bf16 v[120:135], v[248:251], v[72:75], v[120:135]
    v_mfma_f32_32x32x16_bf16 v[136:151], v[252:255], v[72:75], v[136:151]
    ds_read_b64_tr_b16 v[168:169], v22 offset:0
    ds_read_b64_tr_b16 v[170:171], v22 offset:512
    ds_read_b64_tr_b16 v[172:173], v23 offset:0
    ds_read_b64_tr_b16 v[174:175], v23 offset:512
    ds_read_b64_tr_b16 v[176:177], v22 offset:8192
    ds_read_b64_tr_b16 v[178:179], v22 offset:8704
    ds_read_b64_tr_b16 v[180:181], v23 offset:8192
    ds_read_b64_tr_b16 v[182:183], v23 offset:8704
    ds_read_b64_tr_b16 v[184:185], v22 offset:16384
    ds_read_b64_tr_b16 v[186:187], v22 offset:16896
    ds_read_b64_tr_b16 v[188:189], v23 offset:16384
    ds_read_b64_tr_b16 v[190:191], v23 offset:16896
    ds_read_b64_tr_b16 v[192:193], v22 offset:24576
    ds_read_b64_tr_b16 v[194:195], v22 offset:25088
    ds_read_b64_tr_b16 v[196:197], v23 offset:24576
    s_waitcnt lgkmcnt(10)
    ds_read_b64_tr_b16 v[198:199], v23 offset:25088
    ds_read_b64_tr_b16 v[200:201], v22 offset:32768
    ds_read_b64_tr_b16 v[202:203], v22 offset:33280
    ds_read_b64_tr_b16 v[204:205], v23 offset:32768
    ds_read_b64_tr_b16 v[206:207], v23 offset:33280
    s_waitcnt lgkmcnt(10)
    ds_read_b64_tr_b16 v[208:209], v22 offset:40960
    ds_read_b64_tr_b16 v[210:211], v22 offset:41472
    ds_read_b64_tr_b16 v[212:213], v23 offset:40960
    ds_read_b64_tr_b16 v[214:215], v23 offset:41472
    ds_read_b64_tr_b16 v[216:217], v24 offset:0
    s_waitcnt lgkmcnt(10)
    ds_read_b64_tr_b16 v[218:219], v24 offset:512
    ds_read_b64_tr_b16 v[220:221], v25 offset:0
    ds_read_b64_tr_b16 v[222:223], v25 offset:512
    ds_read_b64_tr_b16 v[224:225], v24 offset:8192
    ds_read_b64_tr_b16 v[226:227], v24 offset:8704
    s_waitcnt lgkmcnt(10)
    ds_read_b64_tr_b16 v[228:229], v25 offset:8192
    ds_read_b64_tr_b16 v[230:231], v25 offset:8704
    ds_read_b64_tr_b16 v[232:233], v24 offset:24576
    ds_read_b64_tr_b16 v[234:235], v24 offset:25088
    ds_read_b64_tr_b16 v[236:237], v25 offset:24576
    s_waitcnt lgkmcnt(10)
    ds_read_b64_tr_b16 v[238:239], v25 offset:25088
    ds_read_b64_tr_b16 v[240:241], v24 offset:32768
    ds_read_b64_tr_b16 v[242:243], v24 offset:33280
    ds_read_b64_tr_b16 v[244:245], v25 offset:32768
    ds_read_b64_tr_b16 v[246:247], v25 offset:33280
    s_waitcnt lgkmcnt(10)
    ds_read_b64_tr_b16 v[248:249], v24 offset:40960
    ds_read_b64_tr_b16 v[250:251], v24 offset:41472
    ds_read_b64_tr_b16 v[252:253], v25 offset:40960
    ds_read_b64_tr_b16 v[254:255], v25 offset:41472
    s_waitcnt vmcnt(10)
    v_mfma_f32_32x32x16_bf16 v[120:135], v[168:171], v[76:79], v[120:135]
    v_mfma_f32_32x32x16_bf16 v[136:151], v[172:175], v[76:79], v[136:151]
    s_waitcnt vmcnt(9)
    v_mfma_f32_32x32x16_bf16 v[120:135], v[176:179], v[80:83], v[120:135]
    v_mfma_f32_32x32x16_bf16 v[136:151], v[180:183], v[80:83], v[136:151]
    s_waitcnt vmcnt(8)
    v_mfma_f32_32x32x16_bf16 v[120:135], v[184:187], v[84:87], v[120:135]
    v_mfma_f32_32x32x16_bf16 v[136:151], v[188:191], v[84:87], v[136:151]
    s_waitcnt vmcnt(7)
    v_mfma_f32_32x32x16_bf16 v[120:135], v[192:195], v[88:91], v[120:135]
    v_mfma_f32_32x32x16_bf16 v[136:151], v[196:199], v[88:91], v[136:151]
    s_waitcnt vmcnt(6)
    v_mfma_f32_32x32x16_bf16 v[120:135], v[200:203], v[92:95], v[120:135]
    v_mfma_f32_32x32x16_bf16 v[136:151], v[204:207], v[92:95], v[136:151]
    s_waitcnt vmcnt(5)
    v_mfma_f32_32x32x16_bf16 v[120:135], v[208:211], v[96:99], v[120:135]
    v_mfma_f32_32x32x16_bf16 v[136:151], v[212:215], v[96:99], v[136:151]
    s_waitcnt vmcnt(4)
    v_mfma_f32_32x32x16_bf16 v[120:135], v[216:219], v[100:103], v[120:135]
    v_mfma_f32_32x32x16_bf16 v[136:151], v[220:223], v[100:103], v[136:151]
    s_waitcnt vmcnt(3)
    s_waitcnt lgkmcnt(12)
    v_mfma_f32_32x32x16_bf16 v[120:135], v[224:227], v[104:107], v[120:135]
    v_mfma_f32_32x32x16_bf16 v[136:151], v[228:231], v[104:107], v[136:151]
    s_waitcnt vmcnt(2)
    s_waitcnt lgkmcnt(8)
    v_mfma_f32_32x32x16_bf16 v[120:135], v[232:235], v[108:111], v[120:135]
    v_mfma_f32_32x32x16_bf16 v[136:151], v[236:239], v[108:111], v[136:151]
    s_cmp_eq_u32 s77, 3
    s_cbranch_scc1 L_f2done
    s_waitcnt vmcnt(1)
    s_waitcnt lgkmcnt(4)
    v_mfma_f32_32x32x16_bf16 v[120:135], v[240:243], v[112:115], v[120:135]
    v_mfma_f32_32x32x16_bf16 v[136:151], v[244:247], v[112:115], v[136:151]
    s_waitcnt vmcnt(0)
    s_waitcnt lgkmcnt(0)
    v_mfma_f32_32x32x16_bf16 v[120:135], v[248:251], v[116:119], v[120:135]
    v_mfma_f32_32x32x16_bf16 v[136:151], v[252:255], v[116:119], v[136:151]
L_f2done:
    s_nop 11
    ds_write_b128 v26, v[128:131]
    ds_write_b128 v26, v[132:135] offset:1024
    ds_write_b128 v27, v[136:139]
    ds_write_b128 v27, v[140:143] offset:1024
    ds_write_b128 v28, v[144:147]
    ds_write_b128 v28, v[148:151] offset:1024
    s_waitcnt vmcnt(0)
    v_lshlrev_b32 v56, 16, v6
    v_and_b32 v57, 0xffff0000, v6
    v_lshlrev_b32 v58, 16, v7
    v_and_b32 v59, 0xffff0000, v7
    v_lshlrev_b32 v60, 16, v8
    v_and_b32 v61, 0xffff0000, v8
    v_lshlrev_b32 v62, 16, v9
    v_and_b32 v63, 0xffff0000, v9
    v_lshlrev_b32 v64, 16, v10
    v_and_b32 v65, 0xffff0000, v10
    v_lshlrev_b32 v66, 16, v11
    v_and_b32 v67, 0xffff0000, v11
    v_lshlrev_b32 v68, 16, v12
    v_and_b32 v69, 0xffff0000, v12
    v_lshlrev_b32 v70, 16, v13
    v_and_b32 v71, 0xffff0000, v13
    v_pk_add_f32 v[56:57], v[56:57], v[64:65]
    v_pk_add_f32 v[120:121], v[120:121], v[56:57]
    v_pk_add_f32 v[58:59], v[58:59], v[66:67]
    v_pk_add_f32 v[122:123], v[122:123], v[58:59]
    v_pk_add_f32 v[60:61], v[60:61], v[68:69]
    v_pk_add_f32 v[124:125], v[124:125], v[60:61]
    v_pk_add_f32 v[62:63], v[62:63], v[70:71]
    v_pk_add_f32 v[126:127], v[126:127], v[62:63]
    v_and_b32 v24, 31, v1
    v_lshrrev_b32 v25, 5, v1
    v_lshlrev_b32 v25, 4, v25
    v_lshl_add_u32 v24, v24, 10, v25
    s_lshl_b32 s72, s64, 16
    s_lshl_b32 s73, s91, 15
    s_add_u32 s72, s72, s73
    s_lshl_b32 s73, s65, 7
    s_add_u32 s72, s72, s73
    s_lshl_b32 s73, s77, 5
    s_add_u32 s72, s72, s73
    s_waitcnt lgkmcnt(0)
    s_barrier
    ds_read_b128 v[32:35], v29 offset:0
    ds_read_b128 v[36:39], v29 offset:1024
    ds_read_b128 v[40:43], v29 offset:2048
    ds_read_b128 v[44:47], v29 offset:3072
    ds_read_b128 v[48:51], v29 offset:4096
    ds_read_b128 v[52:55], v29 offset:5120
    s_waitcnt lgkmcnt(4)
    v_pk_add_f32 v[120:121], v[120:121], v[32:33]
    v_pk_add_f32 v[122:123], v[122:123], v[34:35]
    v_pk_add_f32 v[124:125], v[124:125], v[36:37]
    v_pk_add_f32 v[126:127], v[126:127], v[38:39]
    s_waitcnt lgkmcnt(2)
    v_pk_add_f32 v[120:121], v[120:121], v[40:41]
    v_pk_add_f32 v[122:123], v[122:123], v[42:43]
    v_pk_add_f32 v[124:125], v[124:125], v[44:45]
    v_pk_add_f32 v[126:127], v[126:127], v[46:47]
    s_waitcnt lgkmcnt(0)
    v_pk_add_f32 v[120:121], v[120:121], v[48:49]
    v_pk_add_f32 v[122:123], v[122:123], v[50:51]
    v_pk_add_f32 v[124:125], v[124:125], v[52:53]
    v_pk_add_f32 v[126:127], v[126:127], v[54:55]
    v_cvt_pk_bf16_f32 v72, v120, v121
    v_cvt_pk_bf16_f32 v73, v122, v123
    v_cvt_pk_bf16_f32 v74, v124, v125
    v_cvt_pk_bf16_f32 v75, v126, v127
    s_nop 1
    v_permlane32_swap_b32 v72, v74
    v_permlane32_swap_b32 v73, v75
    buffer_store_dwordx4 v[72:75], v24, s[60:63], s72 offen
L_fin:
L_end:
    s_endpgm
L_codeend:
L_slow:
    v_mov_b32 v20, 0xff800000
    v_mov_b32 v21, 0xff800000
    s_mov_b32 s72, 65536
L_maxloop:
    buffer_load_dwordx4 v[40:43], v4, s[56:59], s72 offen sc1
    s_add_u32 s72, s72, 2048
    s_waitcnt vmcnt(0)
    v_mfma_f32_32x32x16_bf16 v[60:75], v[40:43], v[32:35], 0
    v_mfma_f32_32x32x16_bf16 v[76:91], v[40:43], v[36:39], 0
    s_nop 15
    s_nop 15
    v_max3_f32 v20, v20, v60, v61
    v_max3_f32 v21, v21, v76, v77
    v_max3_f32 v20, v20, v62, v63
    v_max3_f32 v21, v21, v78, v79
    v_max3_f32 v20, v20, v64, v65
    v_max3_f32 v21, v21, v80, v81
    v_max3_f32 v20, v20, v66, v67
    v_max3_f32 v21, v21, v82, v83
    v_max3_f32 v20, v20, v68, v69
    v_max3_f32 v21, v21, v84, v85
    v_max3_f32 v20, v20, v70, v71
    v_max3_f32 v21, v21, v86, v87
    v_max3_f32 v20, v20, v72, v73
    v_max3_f32 v21, v21, v88, v89
    v_max3_f32 v20, v20, v74, v75
    v_max3_f32 v21, v21, v90, v91
    s_cmp_lt_u32 s72, 196608
    s_cbranch_scc1 L_maxloop
    v_mov_b32 v60, v20
    v_mov_b32 v61, v21
    s_nop 1
    v_permlane32_swap_b32 v20, v60
    v_permlane32_swap_b32 v21, v61
    v_max_f32 v20, v20, v60
    v_max_f32 v21, v21, v61
    s_waitcnt vmcnt(0)
    s_barrier
    ds_read_b128 v[40:43], v124 offset:0
    s_setprio 3
    s_waitcnt lgkmcnt(0)
    v_mfma_f32_32x32x16_bf16 v[60:75], v[40:43], v[32:35], 0
    s_nop 11
    v_mfma_f32_32x32x16_bf16 v[76:91], v[40:43], v[36:39], 0
    ds_read_b128 v[40:43], v124 offset:2048
    v_sub_f32 v60, v60, v20
    v_exp_f32 v60, v60
    v_sub_f32 v61, v61, v20
    v_exp_f32 v61, v61
    v_sub_f32 v62, v62, v20
    v_exp_f32 v62, v62
    v_sub_f32 v63, v63, v20
    v_exp_f32 v63, v63
    ds_read_b128 v[44:47], v124 offset:1024
    v_sub_f32 v64, v64, v20
    v_exp_f32 v64, v64
    v_sub_f32 v65, v65, v20
    v_exp_f32 v65, v65
    v_sub_f32 v66, v66, v20
    v_exp_f32 v66, v66
    v_sub_f32 v67, v67, v20
    v_exp_f32 v67, v67
    s_add_u32 m0, s69, 32768
    s_add_u32 s75, s69, 98304
    buffer_load_dwordx4 v4, s[56:59], s75 offen sc1 lds
    v_sub_f32 v68, v68, v20
    v_exp_f32 v68, v68
    v_sub_f32 v69, v69, v20
    v_exp_f32 v69, v69
    v_perm_b32 v52, v61, v60, s98
    v_perm_b32 v53, v63, v62, s98
    v_perm_b32 v54, v65, v64, s98
    v_perm_b32 v55, v67, v66, s98
    v_sub_f32 v70, v70, v20
    v_exp_f32 v70, v70
    v_sub_f32 v71, v71, v20
    v_exp_f32 v71, v71
    v_perm_b32 v56, v69, v68, s98
    v_sub_f32 v72, v72, v20
    v_exp_f32 v72, v72
    v_sub_f32 v73, v73, v20
    v_exp_f32 v73, v73
    v_perm_b32 v57, v71, v70, s98
    v_sub_f32 v74, v74, v20
    v_exp_f32 v74, v74
    v_sub_f32 v75, v75, v20
    v_exp_f32 v75, v75
    v_perm_b32 v58, v73, v72, s98
    v_perm_b32 v59, v75, v74, s98
    s_waitcnt lgkmcnt(1)
    v_mfma_f32_32x32x16_bf16 v[60:75], v[40:43], v[32:35], 0
    v_sub_f32 v76, v76, v21
    v_exp_f32 v76, v76
    v_sub_f32 v77, v77, v21
    v_exp_f32 v77, v77
    v_sub_f32 v78, v78, v21
    v_exp_f32 v78, v78
    v_sub_f32 v79, v79, v21
    v_exp_f32 v79, v79
    s_waitcnt lgkmcnt(0)
    v_smfmac_f32_32x32x32_bf16 v[92:107], v[44:47], v[52:59], v10
    v_sub_f32 v80, v80, v21
    v_exp_f32 v80, v80
    v_sub_f32 v81, v81, v21
    v_exp_f32 v81, v81
    v_sub_f32 v82, v82, v21
    v_exp_f32 v82, v82
    v_sub_f32 v83, v83, v21
    v_exp_f32 v83, v83
    v_smfmac_f32_16x16x64_bf16 v[12:15], v[6:9], v[52:59], v11
    s_add_u32 m0, s69, 40960
    s_add_u32 s75, s69, 106496
    buffer_load_dwordx4 v4, s[56:59], s75 offen sc1 lds
    v_sub_f32 v84, v84, v21
    v_exp_f32 v84, v84
    v_sub_f32 v85, v85, v21
    v_exp_f32 v85, v85
    v_perm_b32 v52, v77, v76, s98
    v_perm_b32 v53, v79, v78, s98
    v_perm_b32 v54, v81, v80, s98
    v_perm_b32 v55, v83, v82, s98
    v_sub_f32 v86, v86, v21
    v_exp_f32 v86, v86
    v_sub_f32 v87, v87, v21
    v_exp_f32 v87, v87
    v_perm_b32 v56, v85, v84, s98
    v_sub_f32 v88, v88, v21
    v_exp_f32 v88, v88
    v_sub_f32 v89, v89, v21
    v_exp_f32 v89, v89
    v_perm_b32 v57, v87, v86, s98
    v_sub_f32 v90, v90, v21
    v_exp_f32 v90, v90
    v_sub_f32 v91, v91, v21
    v_exp_f32 v91, v91
    v_perm_b32 v58, v89, v88, s98
    v_perm_b32 v59, v91, v90, s98
    s_setprio 2
    v_mfma_f32_32x32x16_bf16 v[76:91], v[40:43], v[36:39], 0
    ds_read_b128 v[40:43], v124 offset:4096
    v_sub_f32 v60, v60, v20
    v_exp_f32 v60, v60
    v_sub_f32 v61, v61, v20
    v_exp_f32 v61, v61
    v_sub_f32 v62, v62, v20
    v_exp_f32 v62, v62
    v_sub_f32 v63, v63, v20
    v_exp_f32 v63, v63
    v_smfmac_f32_32x32x32_bf16 v[108:123], v[44:47], v[52:59], v10
    ds_read_b128 v[44:47], v124 offset:3072
    v_sub_f32 v64, v64, v20
    v_exp_f32 v64, v64
    v_sub_f32 v65, v65, v20
    v_exp_f32 v65, v65
    v_sub_f32 v66, v66, v20
    v_exp_f32 v66, v66
    v_sub_f32 v67, v67, v20
    v_exp_f32 v67, v67
    v_smfmac_f32_16x16x64_bf16 v[16:19], v[6:9], v[52:59], v11
    s_add_u32 m0, s69, 49152
    s_add_u32 s75, s69, 114688
    buffer_load_dwordx4 v4, s[56:59], s75 offen sc1 lds
    v_sub_f32 v68, v68, v20
    v_exp_f32 v68, v68
    v_sub_f32 v69, v69, v20
    v_exp_f32 v69, v69
    v_perm_b32 v52, v61, v60, s98
    v_perm_b32 v53, v63, v62, s98
    v_perm_b32 v54, v65, v64, s98
    v_perm_b32 v55, v67, v66, s98
    v_sub_f32 v70, v70, v20
    v_exp_f32 v70, v70
    v_sub_f32 v71, v71, v20
    v_exp_f32 v71, v71
    s_add_u32 m0, s83, 0
    s_add_u32 s75, s86, 0
    buffer_load_dwordx4 v2, s[44:47], s75 offen lds
    s_add_u32 m0, s83, 1024
    s_add_u32 s75, s84, 0
    buffer_load_dwordx4 v2, s[44:47], s75 offen lds
    v_perm_b32 v56, v69, v68, s98
    v_sub_f32 v72, v72, v20
    v_exp_f32 v72, v72
    v_sub_f32 v73, v73, v20
    v_exp_f32 v73, v73
    v_perm_b32 v57, v71, v70, s98
    v_sub_f32 v74, v74, v20
    v_exp_f32 v74, v74
    v_sub_f32 v75, v75, v20
    v_exp_f32 v75, v75
    v_perm_b32 v58, v73, v72, s98
    v_perm_b32 v59, v75, v74, s98
    s_waitcnt lgkmcnt(1)
    v_mfma_f32_32x32x16_bf16 v[60:75], v[40:43], v[32:35], 0
    v_sub_f32 v76, v76, v21
    v_exp_f32 v76, v76
    v_sub_f32 v77, v77, v21
    v_exp_f32 v77, v77
    v_sub_f32 v78, v78, v21
    v_exp_f32 v78, v78
    v_sub_f32 v79, v79, v21
    v_exp_f32 v79, v79
    s_waitcnt lgkmcnt(0)
    v_smfmac_f32_32x32x32_bf16 v[92:107], v[44:47], v[52:59], v10
    v_sub_f32 v80, v80, v21
    v_exp_f32 v80, v80
    v_sub_f32 v81, v81, v21
    v_exp_f32 v81, v81
    v_sub_f32 v82, v82, v21
    v_exp_f32 v82, v82
    v_sub_f32 v83, v83, v21
    v_exp_f32 v83, v83
    v_smfmac_f32_16x16x64_bf16 v[12:15], v[6:9], v[52:59], v11
    s_add_u32 m0, s69, 57344
    s_add_u32 s75, s69, 122880
    buffer_load_dwordx4 v4, s[56:59], s75 offen sc1 lds
    v_sub_f32 v84, v84, v21
    v_exp_f32 v84, v84
    v_sub_f32 v85, v85, v21
    v_exp_f32 v85, v85
    v_perm_b32 v52, v77, v76, s98
    v_perm_b32 v53, v79, v78, s98
    v_perm_b32 v54, v81, v80, s98
    v_perm_b32 v55, v83, v82, s98
    v_sub_f32 v86, v86, v21
    v_exp_f32 v86, v86
    v_sub_f32 v87, v87, v21
    v_exp_f32 v87, v87
    v_perm_b32 v56, v85, v84, s98
    v_sub_f32 v88, v88, v21
    v_exp_f32 v88, v88
    v_sub_f32 v89, v89, v21
    v_exp_f32 v89, v89
    v_perm_b32 v57, v87, v86, s98
    v_sub_f32 v90, v90, v21
    v_exp_f32 v90, v90
    v_sub_f32 v91, v91, v21
    v_exp_f32 v91, v91
    v_perm_b32 v58, v89, v88, s98
    v_perm_b32 v59, v91, v90, s98
    v_mfma_f32_32x32x16_bf16 v[76:91], v[40:43], v[36:39], 0
    ds_read_b128 v[40:43], v124 offset:6144
    v_sub_f32 v60, v60, v20
    v_exp_f32 v60, v60
    v_sub_f32 v61, v61, v20
    v_exp_f32 v61, v61
    v_sub_f32 v62, v62, v20
    v_exp_f32 v62, v62
    v_sub_f32 v63, v63, v20
    v_exp_f32 v63, v63
    v_smfmac_f32_32x32x32_bf16 v[108:123], v[44:47], v[52:59], v10
    ds_read_b128 v[44:47], v124 offset:5120
    v_sub_f32 v64, v64, v20
    v_exp_f32 v64, v64
    v_sub_f32 v65, v65, v20
    v_exp_f32 v65, v65
    v_sub_f32 v66, v66, v20
    v_exp_f32 v66, v66
    v_sub_f32 v67, v67, v20
    v_exp_f32 v67, v67
    v_smfmac_f32_16x16x64_bf16 v[16:19], v[6:9], v[52:59], v11
    s_add_u32 m0, s69, 65536
    s_add_u32 s75, s69, 131072
    buffer_load_dwordx4 v4, s[56:59], s75 offen sc1 lds
    v_sub_f32 v68, v68, v20
    v_exp_f32 v68, v68
    v_sub_f32 v69, v69, v20
    v_exp_f32 v69, v69
    v_perm_b32 v52, v61, v60, s98
    v_perm_b32 v53, v63, v62, s98
    v_perm_b32 v54, v65, v64, s98
    v_perm_b32 v55, v67, v66, s98
    v_sub_f32 v70, v70, v20
    v_exp_f32 v70, v70
    v_sub_f32 v71, v71, v20
    v_exp_f32 v71, v71
    s_add_u32 m0, s83, 2048
    s_add_u32 s75, s86, 16384
    buffer_load_dwordx4 v2, s[44:47], s75 offen lds
    s_add_u32 m0, s83, 3072
    s_add_u32 s75, s84, 16384
    buffer_load_dwordx4 v2, s[44:47], s75 offen lds
    v_perm_b32 v56, v69, v68, s98
    v_sub_f32 v72, v72, v20
    v_exp_f32 v72, v72
    v_sub_f32 v73, v73, v20
    v_exp_f32 v73, v73
    v_perm_b32 v57, v71, v70, s98
    v_sub_f32 v74, v74, v20
    v_exp_f32 v74, v74
    v_sub_f32 v75, v75, v20
    v_exp_f32 v75, v75
    v_perm_b32 v58, v73, v72, s98
    v_perm_b32 v59, v75, v74, s98
    s_waitcnt lgkmcnt(1)
    v_mfma_f32_32x32x16_bf16 v[60:75], v[40:43], v[32:35], 0
    v_sub_f32 v76, v76, v21
    v_exp_f32 v76, v76
    v_sub_f32 v77, v77, v21
    v_exp_f32 v77, v77
    v_sub_f32 v78, v78, v21
    v_exp_f32 v78, v78
    v_sub_f32 v79, v79, v21
    v_exp_f32 v79, v79
    s_waitcnt lgkmcnt(0)
    v_smfmac_f32_32x32x32_bf16 v[92:107], v[44:47], v[52:59], v10
    v_sub_f32 v80, v80, v21
    v_exp_f32 v80, v80
    v_sub_f32 v81, v81, v21
    v_exp_f32 v81, v81
    v_sub_f32 v82, v82, v21
    v_exp_f32 v82, v82
    v_sub_f32 v83, v83, v21
    v_exp_f32 v83, v83
    v_smfmac_f32_16x16x64_bf16 v[12:15], v[6:9], v[52:59], v11
    s_add_u32 m0, s69, 73728
    s_add_u32 s75, s69, 139264
    buffer_load_dwordx4 v4, s[56:59], s75 offen sc1 lds
    v_sub_f32 v84, v84, v21
    v_exp_f32 v84, v84
    v_sub_f32 v85, v85, v21
    v_exp_f32 v85, v85
    v_perm_b32 v52, v77, v76, s98
    v_perm_b32 v53, v79, v78, s98
    v_perm_b32 v54, v81, v80, s98
    v_perm_b32 v55, v83, v82, s98
    v_sub_f32 v86, v86, v21
    v_exp_f32 v86, v86
    v_sub_f32 v87, v87, v21
    v_exp_f32 v87, v87
    v_perm_b32 v56, v85, v84, s98
    v_sub_f32 v88, v88, v21
    v_exp_f32 v88, v88
    v_sub_f32 v89, v89, v21
    v_exp_f32 v89, v89
    v_perm_b32 v57, v87, v86, s98
    v_sub_f32 v90, v90, v21
    v_exp_f32 v90, v90
    v_sub_f32 v91, v91, v21
    v_exp_f32 v91, v91
    v_perm_b32 v58, v89, v88, s98
    v_perm_b32 v59, v91, v90, s98
    s_setprio 1
    v_mfma_f32_32x32x16_bf16 v[76:91], v[40:43], v[36:39], 0
    ds_read_b128 v[40:43], v124 offset:8192
    v_sub_f32 v60, v60, v20
    v_exp_f32 v60, v60
    v_sub_f32 v61, v61, v20
    v_exp_f32 v61, v61
    v_sub_f32 v62, v62, v20
    v_exp_f32 v62, v62
    v_sub_f32 v63, v63, v20
    v_exp_f32 v63, v63
    v_smfmac_f32_32x32x32_bf16 v[108:123], v[44:47], v[52:59], v10
    ds_read_b128 v[44:47], v124 offset:7168
    v_sub_f32 v64, v64, v20
    v_exp_f32 v64, v64
    v_sub_f32 v65, v65, v20
    v_exp_f32 v65, v65
    v_sub_f32 v66, v66, v20
    v_exp_f32 v66, v66
    v_sub_f32 v67, v67, v20
    v_exp_f32 v67, v67
    v_smfmac_f32_16x16x64_bf16 v[16:19], v[6:9], v[52:59], v11
    s_add_u32 m0, s69, 81920
    s_add_u32 s75, s69, 147456
    buffer_load_dwordx4 v4, s[56:59], s75 offen sc1 lds
    v_sub_f32 v68, v68, v20
    v_exp_f32 v68, v68
    v_sub_f32 v69, v69, v20
    v_exp_f32 v69, v69
    v_perm_b32 v52, v61, v60, s98
    v_perm_b32 v53, v63, v62, s98
    v_perm_b32 v54, v65, v64, s98
    v_perm_b32 v55, v67, v66, s98
    v_sub_f32 v70, v70, v20
    v_exp_f32 v70, v70
    v_sub_f32 v71, v71, v20
    v_exp_f32 v71, v71
    s_add_u32 m0, s83, 4096
    s_add_u32 s75, s86, 32768
    buffer_load_dwordx4 v2, s[44:47], s75 offen lds
    s_add_u32 m0, s83, 5120
    s_add_u32 s75, s84, 32768
    buffer_load_dwordx4 v2, s[44:47], s75 offen lds
    v_perm_b32 v56, v69, v68, s98
    v_sub_f32 v72, v72, v20
    v_exp_f32 v72, v72
    v_sub_f32 v73, v73, v20
    v_exp_f32 v73, v73
    v_perm_b32 v57, v71, v70, s98
    v_sub_f32 v74, v74, v20
    v_exp_f32 v74, v74
    v_sub_f32 v75, v75, v20
    v_exp_f32 v75, v75
    v_perm_b32 v58, v73, v72, s98
    v_perm_b32 v59, v75, v74, s98
    s_waitcnt lgkmcnt(1)
    v_mfma_f32_32x32x16_bf16 v[60:75], v[40:43], v[32:35], 0
    v_sub_f32 v76, v76, v21
    v_exp_f32 v76, v76
    v_sub_f32 v77, v77, v21
    v_exp_f32 v77, v77
    v_sub_f32 v78, v78, v21
    v_exp_f32 v78, v78
    v_sub_f32 v79, v79, v21
    v_exp_f32 v79, v79
    s_waitcnt lgkmcnt(0)
    v_smfmac_f32_32x32x32_bf16 v[92:107], v[44:47], v[52:59], v10
    v_sub_f32 v80, v80, v21
    v_exp_f32 v80, v80
    v_sub_f32 v81, v81, v21
    v_exp_f32 v81, v81
    v_sub_f32 v82, v82, v21
    v_exp_f32 v82, v82
    v_sub_f32 v83, v83, v21
    v_exp_f32 v83, v83
    v_smfmac_f32_16x16x64_bf16 v[12:15], v[6:9], v[52:59], v11
    s_add_u32 m0, s69, 90112
    s_add_u32 s75, s69, 155648
    buffer_load_dwordx4 v4, s[56:59], s75 offen sc1 lds
    v_sub_f32 v84, v84, v21
    v_exp_f32 v84, v84
    v_sub_f32 v85, v85, v21
    v_exp_f32 v85, v85
    v_perm_b32 v52, v77, v76, s98
    v_perm_b32 v53, v79, v78, s98
    v_perm_b32 v54, v81, v80, s98
    v_perm_b32 v55, v83, v82, s98
    v_sub_f32 v86, v86, v21
    v_exp_f32 v86, v86
    v_sub_f32 v87, v87, v21
    v_exp_f32 v87, v87
    s_waitcnt vmcnt(10)
    ds_read_b64_tr_b16 v[192:193], v25 offset:0
    ds_read_b64_tr_b16 v[194:195], v25 offset:512
    s_waitcnt vmcnt(9)
    ds_read_b64_tr_b16 v[196:197], v25 offset:1024
    ds_read_b64_tr_b16 v[198:199], v25 offset:1536
    v_perm_b32 v56, v85, v84, s98
    v_sub_f32 v88, v88, v21
    v_exp_f32 v88, v88
    v_sub_f32 v89, v89, v21
    v_exp_f32 v89, v89
    v_perm_b32 v57, v87, v86, s98
    v_sub_f32 v90, v90, v21
    v_exp_f32 v90, v90
    v_sub_f32 v91, v91, v21
    v_exp_f32 v91, v91
    v_perm_b32 v58, v89, v88, s98
    v_perm_b32 v59, v91, v90, s98
    v_mfma_f32_32x32x16_bf16 v[76:91], v[40:43], v[36:39], 0
    ds_read_b128 v[40:43], v124 offset:10240
    v_sub_f32 v60, v60, v20
    v_exp_f32 v60, v60
    v_sub_f32 v61, v61, v20
    v_exp_f32 v61, v61
    v_sub_f32 v62, v62, v20
    v_exp_f32 v62, v62
    v_sub_f32 v63, v63, v20
    v_exp_f32 v63, v63
    v_smfmac_f32_32x32x32_bf16 v[108:123], v[44:47], v[52:59], v10
    ds_read_b128 v[44:47], v124 offset:9216
    v_sub_f32 v64, v64, v20
    v_exp_f32 v64, v64
    v_sub_f32 v65, v65, v20
    v_exp_f32 v65, v65
    v_sub_f32 v66, v66, v20
    v_exp_f32 v66, v66
    v_sub_f32 v67, v67, v20
    v_exp_f32 v67, v67
    v_smfmac_f32_16x16x64_bf16 v[16:19], v[6:9], v[52:59], v11
    v_sub_f32 v68, v68, v20
    v_exp_f32 v68, v68
    v_sub_f32 v69, v69, v20
    v_exp_f32 v69, v69
    v_perm_b32 v52, v61, v60, s98
    v_perm_b32 v53, v63, v62, s98
    v_perm_b32 v54, v65, v64, s98
    v_perm_b32 v55, v67, v66, s98
    v_sub_f32 v70, v70, v20
    v_exp_f32 v70, v70
    v_sub_f32 v71, v71, v20
    v_exp_f32 v71, v71
    s_add_u32 m0, s83, 6144
    s_add_u32 s75, s86, 49152
    buffer_load_dwordx4 v2, s[44:47], s75 offen lds
    s_add_u32 m0, s83, 7168
    s_add_u32 s75, s84, 49152
    buffer_load_dwordx4 v2, s[44:47], s75 offen lds
    v_perm_b32 v56, v69, v68, s98
    v_sub_f32 v72, v72, v20
    v_exp_f32 v72, v72
    v_sub_f32 v73, v73, v20
    v_exp_f32 v73, v73
    v_perm_b32 v57, v71, v70, s98
    v_sub_f32 v74, v74, v20
    v_exp_f32 v74, v74
    v_sub_f32 v75, v75, v20
    v_exp_f32 v75, v75
    v_perm_b32 v58, v73, v72, s98
    v_perm_b32 v59, v75, v74, s98
    s_waitcnt lgkmcnt(1)
    v_mfma_f32_32x32x16_bf16 v[60:75], v[40:43], v[32:35], 0
    v_sub_f32 v76, v76, v21
    v_exp_f32 v76, v76
    v_sub_f32 v77, v77, v21
    v_exp_f32 v77, v77
    v_sub_f32 v78, v78, v21
    v_exp_f32 v78, v78
    v_sub_f32 v79, v79, v21
    v_exp_f32 v79, v79
    s_waitcnt lgkmcnt(0)
    v_smfmac_f32_32x32x32_bf16 v[92:107], v[44:47], v[52:59], v10
    v_sub_f32 v80, v80, v21
    v_exp_f32 v80, v80
    v_sub_f32 v81, v81, v21
    v_exp_f32 v81, v81
    v_sub_f32 v82, v82, v21
    v_exp_f32 v82, v82
    v_sub_f32 v83, v83, v21
    v_exp_f32 v83, v83
    v_smfmac_f32_16x16x64_bf16 v[12:15], v[6:9], v[52:59], v11
    v_sub_f32 v84, v84, v21
    v_exp_f32 v84, v84
    v_sub_f32 v85, v85, v21
    v_exp_f32 v85, v85
    v_perm_b32 v52, v77, v76, s98
    v_perm_b32 v53, v79, v78, s98
    v_perm_b32 v54, v81, v80, s98
    v_perm_b32 v55, v83, v82, s98
    v_sub_f32 v86, v86, v21
    v_exp_f32 v86, v86
    v_sub_f32 v87, v87, v21
    v_exp_f32 v87, v87
    s_waitcnt vmcnt(8)
    ds_read_b64_tr_b16 v[200:201], v25 offset:2048
    ds_read_b64_tr_b16 v[202:203], v25 offset:2560
    s_waitcnt vmcnt(7)
    ds_read_b64_tr_b16 v[204:205], v25 offset:3072
    ds_read_b64_tr_b16 v[206:207], v25 offset:3584
    v_perm_b32 v56, v85, v84, s98
    v_sub_f32 v88, v88, v21
    v_exp_f32 v88, v88
    v_sub_f32 v89, v89, v21
    v_exp_f32 v89, v89
    v_perm_b32 v57, v87, v86, s98
    v_sub_f32 v90, v90, v21
    v_exp_f32 v90, v90
    v_sub_f32 v91, v91, v21
    v_exp_f32 v91, v91
    v_perm_b32 v58, v89, v88, s98
    v_perm_b32 v59, v91, v90, s98
    s_setprio 0
    v_mfma_f32_32x32x16_bf16 v[76:91], v[40:43], v[36:39], 0
    ds_read_b128 v[40:43], v124 offset:12288
    v_sub_f32 v60, v60, v20
    v_exp_f32 v60, v60
    v_sub_f32 v61, v61, v20
    v_exp_f32 v61, v61
    v_sub_f32 v62, v62, v20
    v_exp_f32 v62, v62
    v_sub_f32 v63, v63, v20
    v_exp_f32 v63, v63
    v_smfmac_f32_32x32x32_bf16 v[108:123], v[44:47], v[52:59], v10
    ds_read_b128 v[44:47], v124 offset:11264
    v_sub_f32 v64, v64, v20
    v_exp_f32 v64, v64
    v_sub_f32 v65, v65, v20
    v_exp_f32 v65, v65
    v_sub_f32 v66, v66, v20
    v_exp_f32 v66, v66
    v_sub_f32 v67, v67, v20
    v_exp_f32 v67, v67
    v_smfmac_f32_16x16x64_bf16 v[16:19], v[6:9], v[52:59], v11
    v_sub_f32 v68, v68, v20
    v_exp_f32 v68, v68
    v_sub_f32 v69, v69, v20
    v_exp_f32 v69, v69
    v_perm_b32 v52, v61, v60, s98
    v_perm_b32 v53, v63, v62, s98
    v_perm_b32 v54, v65, v64, s98
    v_perm_b32 v55, v67, v66, s98
    v_sub_f32 v70, v70, v20
    v_exp_f32 v70, v70
    v_sub_f32 v71, v71, v20
    v_exp_f32 v71, v71
    s_add_u32 m0, s83, 0
    s_add_u32 s75, s86, 65536
    buffer_load_dwordx4 v2, s[44:47], s75 offen lds
    s_add_u32 m0, s83, 1024
    s_add_u32 s75, s84, 65536
    buffer_load_dwordx4 v2, s[44:47], s75 offen lds
    v_perm_b32 v56, v69, v68, s98
    v_sub_f32 v72, v72, v20
    v_exp_f32 v72, v72
    v_sub_f32 v73, v73, v20
    v_exp_f32 v73, v73
    v_perm_b32 v57, v71, v70, s98
    v_sub_f32 v74, v74, v20
    v_exp_f32 v74, v74
    v_sub_f32 v75, v75, v20
    v_exp_f32 v75, v75
    v_perm_b32 v58, v73, v72, s98
    v_perm_b32 v59, v75, v74, s98
    s_waitcnt lgkmcnt(1)
    v_mfma_f32_32x32x16_bf16 v[60:75], v[40:43], v[32:35], 0
    v_sub_f32 v76, v76, v21
    v_exp_f32 v76, v76
    v_sub_f32 v77, v77, v21
    v_exp_f32 v77, v77
    v_sub_f32 v78, v78, v21
    v_exp_f32 v78, v78
    v_sub_f32 v79, v79, v21
    v_exp_f32 v79, v79
    s_waitcnt lgkmcnt(0)
    v_smfmac_f32_32x32x32_bf16 v[92:107], v[44:47], v[52:59], v10
    v_sub_f32 v80, v80, v21
    v_exp_f32 v80, v80
    v_sub_f32 v81, v81, v21
    v_exp_f32 v81, v81
    v_sub_f32 v82, v82, v21
    v_exp_f32 v82, v82
    v_sub_f32 v83, v83, v21
    v_exp_f32 v83, v83
    v_smfmac_f32_16x16x64_bf16 v[12:15], v[6:9], v[52:59], v11
    v_sub_f32 v84, v84, v21
    v_exp_f32 v84, v84
    v_sub_f32 v85, v85, v21
    v_exp_f32 v85, v85
    v_perm_b32 v52, v77, v76, s98
    v_perm_b32 v53, v79, v78, s98
    v_perm_b32 v54, v81, v80, s98
    v_perm_b32 v55, v83, v82, s98
    v_sub_f32 v86, v86, v21
    v_exp_f32 v86, v86
    v_sub_f32 v87, v87, v21
    v_exp_f32 v87, v87
    s_waitcnt vmcnt(6)
    ds_read_b64_tr_b16 v[208:209], v25 offset:4096
    ds_read_b64_tr_b16 v[210:211], v25 offset:4608
    s_waitcnt vmcnt(5)
    ds_read_b64_tr_b16 v[212:213], v25 offset:5120
    ds_read_b64_tr_b16 v[214:215], v25 offset:5632
    v_perm_b32 v56, v85, v84, s98
    v_sub_f32 v88, v88, v21
    v_exp_f32 v88, v88
    v_sub_f32 v89, v89, v21
    v_exp_f32 v89, v89
    v_perm_b32 v57, v87, v86, s98
    v_sub_f32 v90, v90, v21
    v_exp_f32 v90, v90
    v_sub_f32 v91, v91, v21
    v_exp_f32 v91, v91
    v_perm_b32 v58, v89, v88, s98
    v_perm_b32 v59, v91, v90, s98
    v_mfma_f32_32x32x16_bf16 v[76:91], v[40:43], v[36:39], 0
    ds_read_b128 v[40:43], v124 offset:14336
    v_sub_f32 v60, v60, v20
    v_exp_f32 v60, v60
    v_sub_f32 v61, v61, v20
    v_exp_f32 v61, v61
    v_sub_f32 v62, v62, v20
    v_exp_f32 v62, v62
    v_sub_f32 v63, v63, v20
    v_exp_f32 v63, v63
    v_smfmac_f32_32x32x32_bf16 v[108:123], v[44:47], v[52:59], v10
    ds_read_b128 v[44:47], v124 offset:13312
    v_sub_f32 v64, v64, v20
    v_exp_f32 v64, v64
    v_sub_f32 v65, v65, v20
    v_exp_f32 v65, v65
    v_sub_f32 v66, v66, v20
    v_exp_f32 v66, v66
    v_sub_f32 v67, v67, v20
    v_exp_f32 v67, v67
    v_smfmac_f32_16x16x64_bf16 v[16:19], v[6:9], v[52:59], v11
    v_sub_f32 v68, v68, v20
    v_exp_f32 v68, v68
    v_sub_f32 v69, v69, v20
    v_exp_f32 v69, v69
    v_perm_b32 v52, v61, v60, s98
    v_perm_b32 v53, v63, v62, s98
    v_perm_b32 v54, v65, v64, s98
    v_perm_b32 v55, v67, v66, s98
    v_sub_f32 v70, v70, v20
    v_exp_f32 v70, v70
    v_sub_f32 v71, v71, v20
    v_exp_f32 v71, v71
    s_add_u32 m0, s83, 2048
    s_add_u32 s75, s86, 81920
    buffer_load_dwordx4 v2, s[44:47], s75 offen lds
    s_add_u32 m0, s83, 3072
    s_add_u32 s75, s84, 81920
    buffer_load_dwordx4 v2, s[44:47], s75 offen lds
    v_perm_b32 v56, v69, v68, s98
    v_sub_f32 v72, v72, v20
    v_exp_f32 v72, v72
    v_sub_f32 v73, v73, v20
    v_exp_f32 v73, v73
    v_perm_b32 v57, v71, v70, s98
    v_sub_f32 v74, v74, v20
    v_exp_f32 v74, v74
    v_sub_f32 v75, v75, v20
    v_exp_f32 v75, v75
    v_perm_b32 v58, v73, v72, s98
    v_perm_b32 v59, v75, v74, s98
    s_waitcnt lgkmcnt(1)
    v_mfma_f32_32x32x16_bf16 v[60:75], v[40:43], v[32:35], 0
    v_sub_f32 v76, v76, v21
    v_exp_f32 v76, v76
    v_sub_f32 v77, v77, v21
    v_exp_f32 v77, v77
    v_sub_f32 v78, v78, v21
    v_exp_f32 v78, v78
    v_sub_f32 v79, v79, v21
    v_exp_f32 v79, v79
    s_waitcnt lgkmcnt(0)
    v_smfmac_f32_32x32x32_bf16 v[92:107], v[44:47], v[52:59], v10
    v_sub_f32 v80, v80, v21
    v_exp_f32 v80, v80
    v_sub_f32 v81, v81, v21
    v_exp_f32 v81, v81
    v_sub_f32 v82, v82, v21
    v_exp_f32 v82, v82
    v_sub_f32 v83, v83, v21
    v_exp_f32 v83, v83
    v_smfmac_f32_16x16x64_bf16 v[12:15], v[6:9], v[52:59], v11
    v_sub_f32 v84, v84, v21
    v_exp_f32 v84, v84
    v_sub_f32 v85, v85, v21
    v_exp_f32 v85, v85
    v_perm_b32 v52, v77, v76, s98
    v_perm_b32 v53, v79, v78, s98
    v_perm_b32 v54, v81, v80, s98
    v_perm_b32 v55, v83, v82, s98
    v_sub_f32 v86, v86, v21
    v_exp_f32 v86, v86
    v_sub_f32 v87, v87, v21
    v_exp_f32 v87, v87
    s_waitcnt vmcnt(5)
    ds_read_b64_tr_b16 v[216:217], v25 offset:6144
    ds_read_b64_tr_b16 v[218:219], v25 offset:6656
    s_waitcnt vmcnt(4)
    ds_read_b64_tr_b16 v[220:221], v25 offset:7168
    ds_read_b64_tr_b16 v[222:223], v25 offset:7680
    v_perm_b32 v56, v85, v84, s98
    v_sub_f32 v88, v88, v21
    v_exp_f32 v88, v88
    v_sub_f32 v89, v89, v21
    v_exp_f32 v89, v89
    v_perm_b32 v57, v87, v86, s98
    v_sub_f32 v90, v90, v21
    v_exp_f32 v90, v90
    v_sub_f32 v91, v91, v21
    v_exp_f32 v91, v91
    v_perm_b32 v58, v89, v88, s98
    v_perm_b32 v59, v91, v90, s98
    s_barrier
    s_setprio 3
    v_mfma_f32_32x32x16_bf16 v[76:91], v[40:43], v[36:39], 0
    ds_read_b128 v[40:43], v124 offset:32768
    v_sub_f32 v60, v60, v20
    v_exp_f32 v60, v60
    v_sub_f32 v61, v61, v20
    v_exp_f32 v61, v61
    v_sub_f32 v62, v62, v20
    v_exp_f32 v62, v62
    v_sub_f32 v63, v63, v20
    v_exp_f32 v63, v63
    v_smfmac_f32_32x32x32_bf16 v[108:123], v[44:47], v[52:59], v10
    ds_read_b128 v[44:47], v124 offset:15360
    v_sub_f32 v64, v64, v20
    v_exp_f32 v64, v64
    v_sub_f32 v65, v65, v20
    v_exp_f32 v65, v65
    v_sub_f32 v66, v66, v20
    v_exp_f32 v66, v66
    v_sub_f32 v67, v67, v20
    v_exp_f32 v67, v67
    v_smfmac_f32_16x16x64_bf16 v[16:19], v[6:9], v[52:59], v11
    v_sub_f32 v68, v68, v20
    v_exp_f32 v68, v68
    v_sub_f32 v69, v69, v20
    v_exp_f32 v69, v69
    v_perm_b32 v52, v61, v60, s98
    v_perm_b32 v53, v63, v62, s98
    v_perm_b32 v54, v65, v64, s98
    v_perm_b32 v55, v67, v66, s98
    v_sub_f32 v70, v70, v20
    v_exp_f32 v70, v70
    v_sub_f32 v71, v71, v20
    v_exp_f32 v71, v71
    s_add_u32 m0, s83, 4096
    s_add_u32 s75, s86, 98304
    buffer_load_dwordx4 v2, s[44:47], s75 offen lds
    s_add_u32 m0, s83, 5120
    s_add_u32 s75, s84, 98304
    buffer_load_dwordx4 v2, s[44:47], s75 offen lds
    v_perm_b32 v56, v69, v68, s98
    v_sub_f32 v72, v72, v20
    v_exp_f32 v72, v72
    v_sub_f32 v73, v73, v20
    v_exp_f32 v73, v73
    v_perm_b32 v57, v71, v70, s98
    v_sub_f32 v74, v74, v20
    v_exp_f32 v74, v74
    v_sub_f32 v75, v75, v20
    v_exp_f32 v75, v75
    v_perm_b32 v58, v73, v72, s98
    v_perm_b32 v59, v75, v74, s98
    s_waitcnt lgkmcnt(1)
    v_mfma_f32_32x32x16_bf16 v[60:75], v[40:43], v[32:35], 0
    v_sub_f32 v76, v76, v21
    v_exp_f32 v76, v76
    v_sub_f32 v77, v77, v21
    v_exp_f32 v77, v77
    v_sub_f32 v78, v78, v21
    v_exp_f32 v78, v78
    v_sub_f32 v79, v79, v21
    v_exp_f32 v79, v79
    s_waitcnt lgkmcnt(0)
    v_smfmac_f32_32x32x32_bf16 v[92:107], v[44:47], v[52:59], v10
    v_sub_f32 v80, v80, v21
    v_exp_f32 v80, v80
    v_sub_f32 v81, v81, v21
    v_exp_f32 v81, v81
    v_sub_f32 v82, v82, v21
    v_exp_f32 v82, v82
    v_sub_f32 v83, v83, v21
    v_exp_f32 v83, v83
    v_smfmac_f32_16x16x64_bf16 v[12:15], v[6:9], v[52:59], v11
    v_sub_f32 v84, v84, v21
    v_exp_f32 v84, v84
    v_sub_f32 v85, v85, v21
    v_exp_f32 v85, v85
    v_perm_b32 v52, v77, v76, s98
    v_perm_b32 v53, v79, v78, s98
    v_perm_b32 v54, v81, v80, s98
    v_perm_b32 v55, v83, v82, s98
    v_sub_f32 v86, v86, v21
    v_exp_f32 v86, v86
    v_sub_f32 v87, v87, v21
    v_exp_f32 v87, v87
    s_waitcnt vmcnt(5)
    ds_read_b64_tr_b16 v[224:225], v25 offset:0
    ds_read_b64_tr_b16 v[226:227], v25 offset:512
    s_waitcnt vmcnt(4)
    ds_read_b64_tr_b16 v[228:229], v25 offset:1024
    ds_read_b64_tr_b16 v[230:231], v25 offset:1536
    v_perm_b32 v56, v85, v84, s98
    v_sub_f32 v88, v88, v21
    v_exp_f32 v88, v88
    v_sub_f32 v89, v89, v21
    v_exp_f32 v89, v89
    v_perm_b32 v57, v87, v86, s98
    v_sub_f32 v90, v90, v21
    v_exp_f32 v90, v90
    v_sub_f32 v91, v91, v21
    v_exp_f32 v91, v91
    v_perm_b32 v58, v89, v88, s98
    v_perm_b32 v59, v91, v90, s98
    v_mfma_f32_32x32x16_bf16 v[76:91], v[40:43], v[36:39], 0
    ds_read_b128 v[40:43], v124 offset:34816
    v_sub_f32 v60, v60, v20
    v_exp_f32 v60, v60
    v_sub_f32 v61, v61, v20
    v_exp_f32 v61, v61
    v_sub_f32 v62, v62, v20
    v_exp_f32 v62, v62
    v_sub_f32 v63, v63, v20
    v_exp_f32 v63, v63
    v_smfmac_f32_32x32x32_bf16 v[108:123], v[44:47], v[52:59], v10
    ds_read_b128 v[44:47], v124 offset:33792
    v_sub_f32 v64, v64, v20
    v_exp_f32 v64, v64
    v_sub_f32 v65, v65, v20
    v_exp_f32 v65, v65
    v_sub_f32 v66, v66, v20
    v_exp_f32 v66, v66
    v_sub_f32 v67, v67, v20
    v_exp_f32 v67, v67
    v_smfmac_f32_16x16x64_bf16 v[16:19], v[6:9], v[52:59], v11
    v_sub_f32 v68, v68, v20
    v_exp_f32 v68, v68
    v_sub_f32 v69, v69, v20
    v_exp_f32 v69, v69
    v_perm_b32 v52, v61, v60, s98
    v_perm_b32 v53, v63, v62, s98
    v_perm_b32 v54, v65, v64, s98
    v_perm_b32 v55, v67, v66, s98
    v_sub_f32 v70, v70, v20
    v_exp_f32 v70, v70
    v_sub_f32 v71, v71, v20
    v_exp_f32 v71, v71
    s_add_u32 m0, s83, 6144
    s_add_u32 s75, s86, 114688
    buffer_load_dwordx4 v2, s[44:47], s75 offen lds
    s_add_u32 m0, s83, 7168
    s_add_u32 s75, s84, 114688
    buffer_load_dwordx4 v2, s[44:47], s75 offen lds
    v_perm_b32 v56, v69, v68, s98
    v_sub_f32 v72, v72, v20
    v_exp_f32 v72, v72
    v_sub_f32 v73, v73, v20
    v_exp_f32 v73, v73
    v_perm_b32 v57, v71, v70, s98
    v_sub_f32 v74, v74, v20
    v_exp_f32 v74, v74
    v_sub_f32 v75, v75, v20
    v_exp_f32 v75, v75
    v_perm_b32 v58, v73, v72, s98
    v_perm_b32 v59, v75, v74, s98
    s_waitcnt lgkmcnt(1)
    v_mfma_f32_32x32x16_bf16 v[60:75], v[40:43], v[32:35], 0
    v_sub_f32 v76, v76, v21
    v_exp_f32 v76, v76
    v_sub_f32 v77, v77, v21
    v_exp_f32 v77, v77
    v_sub_f32 v78, v78, v21
    v_exp_f32 v78, v78
    v_sub_f32 v79, v79, v21
    v_exp_f32 v79, v79
    s_waitcnt lgkmcnt(0)
    v_smfmac_f32_32x32x32_bf16 v[92:107], v[44:47], v[52:59], v10
    v_sub_f32 v80, v80, v21
    v_exp_f32 v80, v80
    v_sub_f32 v81, v81, v21
    v_exp_f32 v81, v81
    v_sub_f32 v82, v82, v21
    v_exp_f32 v82, v82
    v_sub_f32 v83, v83, v21
    v_exp_f32 v83, v83
    v_smfmac_f32_16x16x64_bf16 v[12:15], v[6:9], v[52:59], v11
    v_sub_f32 v84, v84, v21
    v_exp_f32 v84, v84
    v_sub_f32 v85, v85, v21
    v_exp_f32 v85, v85
    v_perm_b32 v52, v77, v76, s98
    v_perm_b32 v53, v79, v78, s98
    v_perm_b32 v54, v81, v80, s98
    v_perm_b32 v55, v83, v82, s98
    v_sub_f32 v86, v86, v21
    v_exp_f32 v86, v86
    v_sub_f32 v87, v87, v21
    v_exp_f32 v87, v87
    s_waitcnt vmcnt(5)
    ds_read_b64_tr_b16 v[232:233], v25 offset:2048
    ds_read_b64_tr_b16 v[234:235], v25 offset:2560
    s_waitcnt vmcnt(4)
    ds_read_b64_tr_b16 v[236:237], v25 offset:3072
    ds_read_b64_tr_b16 v[238:239], v25 offset:3584
    v_perm_b32 v56, v85, v84, s98
    v_sub_f32 v88, v88, v21
    v_exp_f32 v88, v88
    v_sub_f32 v89, v89, v21
    v_exp_f32 v89, v89
    v_perm_b32 v57, v87, v86, s98
    v_sub_f32 v90, v90, v21
    v_exp_f32 v90, v90
    v_sub_f32 v91, v91, v21
    v_exp_f32 v91, v91
    v_perm_b32 v58, v89, v88, s98
    v_perm_b32 v59, v91, v90, s98
    s_setprio 2
    v_mfma_f32_32x32x16_bf16 v[76:91], v[40:43], v[36:39], 0
    ds_read_b128 v[40:43], v124 offset:36864
    v_sub_f32 v60, v60, v20
    v_exp_f32 v60, v60
    v_sub_f32 v61, v61, v20
    v_exp_f32 v61, v61
    v_sub_f32 v62, v62, v20
    v_exp_f32 v62, v62
    v_sub_f32 v63, v63, v20
    v_exp_f32 v63, v63
    v_smfmac_f32_32x32x32_bf16 v[108:123], v[44:47], v[52:59], v10
    ds_read_b128 v[44:47], v124 offset:35840
    v_sub_f32 v64, v64, v20
    v_exp_f32 v64, v64
    v_sub_f32 v65, v65, v20
    v_exp_f32 v65, v65
    v_sub_f32 v66, v66, v20
    v_exp_f32 v66, v66
    v_sub_f32 v67, v67, v20
    v_exp_f32 v67, v67
    v_smfmac_f32_16x16x64_bf16 v[16:19], v[6:9], v[52:59], v11
    v_sub_f32 v68, v68, v20
    v_exp_f32 v68, v68
    v_sub_f32 v69, v69, v20
    v_exp_f32 v69, v69
    v_perm_b32 v52, v61, v60, s98
    v_perm_b32 v53, v63, v62, s98
    v_perm_b32 v54, v65, v64, s98
    v_perm_b32 v55, v67, v66, s98
    v_sub_f32 v70, v70, v20
    v_exp_f32 v70, v70
    v_sub_f32 v71, v71, v20
    v_exp_f32 v71, v71
    s_add_u32 m0, s83, 0
    s_add_u32 s75, s94, 0
    buffer_load_dwordx4 v3, s[48:51], s75 offen lds
    s_add_u32 m0, s83, 1024
    s_add_u32 s75, s94, 44032
    buffer_load_dwordx4 v3, s[48:51], s75 offen lds
    v_perm_b32 v56, v69, v68, s98
    v_sub_f32 v72, v72, v20
    v_exp_f32 v72, v72
    v_sub_f32 v73, v73, v20
    v_exp_f32 v73, v73
    v_perm_b32 v57, v71, v70, s98
    v_sub_f32 v74, v74, v20
    v_exp_f32 v74, v74
    v_sub_f32 v75, v75, v20
    v_exp_f32 v75, v75
    v_perm_b32 v58, v73, v72, s98
    v_perm_b32 v59, v75, v74, s98
    s_waitcnt lgkmcnt(1)
    v_mfma_f32_32x32x16_bf16 v[60:75], v[40:43], v[32:35], 0
    v_sub_f32 v76, v76, v21
    v_exp_f32 v76, v76
    v_sub_f32 v77, v77, v21
    v_exp_f32 v77, v77
    v_sub_f32 v78, v78, v21
    v_exp_f32 v78, v78
    v_sub_f32 v79, v79, v21
    v_exp_f32 v79, v79
    s_waitcnt lgkmcnt(0)
    v_smfmac_f32_32x32x32_bf16 v[92:107], v[44:47], v[52:59], v10
    v_sub_f32 v80, v80, v21
    v_exp_f32 v80, v80
    v_sub_f32 v81, v81, v21
    v_exp_f32 v81, v81
    v_sub_f32 v82, v82, v21
    v_exp_f32 v82, v82
    v_sub_f32 v83, v83, v21
    v_exp_f32 v83, v83
    v_smfmac_f32_16x16x64_bf16 v[12:15], v[6:9], v[52:59], v11
    v_sub_f32 v84, v84, v21
    v_exp_f32 v84, v84
    v_sub_f32 v85, v85, v21
    v_exp_f32 v85, v85
    v_perm_b32 v52, v77, v76, s98
    v_perm_b32 v53, v79, v78, s98
    v_perm_b32 v54, v81, v80, s98
    v_perm_b32 v55, v83, v82, s98
    v_sub_f32 v86, v86, v21
    v_exp_f32 v86, v86
    v_sub_f32 v87, v87, v21
    v_exp_f32 v87, v87
    s_waitcnt vmcnt(5)
    ds_read_b64_tr_b16 v[240:241], v25 offset:4096
    ds_read_b64_tr_b16 v[242:243], v25 offset:4608
    s_waitcnt vmcnt(4)
    ds_read_b64_tr_b16 v[244:245], v25 offset:5120
    ds_read_b64_tr_b16 v[246:247], v25 offset:5632
    v_perm_b32 v56, v85, v84, s98
    v_sub_f32 v88, v88, v21
    v_exp_f32 v88, v88
    v_sub_f32 v89, v89, v21
    v_exp_f32 v89, v89
    v_perm_b32 v57, v87, v86, s98
    v_sub_f32 v90, v90, v21
    v_exp_f32 v90, v90
    v_sub_f32 v91, v91, v21
    v_exp_f32 v91, v91
    v_perm_b32 v58, v89, v88, s98
    v_perm_b32 v59, v91, v90, s98
    v_mfma_f32_32x32x16_bf16 v[76:91], v[40:43], v[36:39], 0
    ds_read_b128 v[40:43], v124 offset:38912
    v_sub_f32 v60, v60, v20
    v_exp_f32 v60, v60
    v_sub_f32 v61, v61, v20
    v_exp_f32 v61, v61
    v_sub_f32 v62, v62, v20
    v_exp_f32 v62, v62
    v_sub_f32 v63, v63, v20
    v_exp_f32 v63, v63
    v_smfmac_f32_32x32x32_bf16 v[108:123], v[44:47], v[52:59], v10
    ds_read_b128 v[44:47], v124 offset:37888
    v_sub_f32 v64, v64, v20
    v_exp_f32 v64, v64
    v_sub_f32 v65, v65, v20
    v_exp_f32 v65, v65
    v_sub_f32 v66, v66, v20
    v_exp_f32 v66, v66
    v_sub_f32 v67, v67, v20
    v_exp_f32 v67, v67
    v_smfmac_f32_16x16x64_bf16 v[16:19], v[6:9], v[52:59], v11
    v_sub_f32 v68, v68, v20
    v_exp_f32 v68, v68
    v_sub_f32 v69, v69, v20
    v_exp_f32 v69, v69
    v_perm_b32 v52, v61, v60, s98
    v_perm_b32 v53, v63, v62, s98
    v_perm_b32 v54, v65, v64, s98
    v_perm_b32 v55, v67, v66, s98
    v_sub_f32 v70, v70, v20
    v_exp_f32 v70, v70
    v_sub_f32 v71, v71, v20
    v_exp_f32 v71, v71
    s_add_u32 m0, s83, 2048
    s_add_u32 s75, s94, 88064
    buffer_load_dwordx4 v3, s[48:51], s75 offen lds
    s_add_u32 m0, s83, 3072
    s_add_u32 s75, s94, 132096
    buffer_load_dwordx4 v3, s[48:51], s75 offen lds
    v_perm_b32 v56, v69, v68, s98
    v_sub_f32 v72, v72, v20
    v_exp_f32 v72, v72
    v_sub_f32 v73, v73, v20
    v_exp_f32 v73, v73
    v_perm_b32 v57, v71, v70, s98
    v_sub_f32 v74, v74, v20
    v_exp_f32 v74, v74
    v_sub_f32 v75, v75, v20
    v_exp_f32 v75, v75
    v_perm_b32 v58, v73, v72, s98
    v_perm_b32 v59, v75, v74, s98
    s_waitcnt lgkmcnt(1)
    v_mfma_f32_32x32x16_bf16 v[60:75], v[40:43], v[32:35], 0
    v_sub_f32 v76, v76, v21
    v_exp_f32 v76, v76
    v_sub_f32 v77, v77, v21
    v_exp_f32 v77, v77
    v_sub_f32 v78, v78, v21
    v_exp_f32 v78, v78
    v_sub_f32 v79, v79, v21
    v_exp_f32 v79, v79
    s_waitcnt lgkmcnt(0)
    v_smfmac_f32_32x32x32_bf16 v[92:107], v[44:47], v[52:59], v10
    v_sub_f32 v80, v80, v21
    v_exp_f32 v80, v80
    v_sub_f32 v81, v81, v21
    v_exp_f32 v81, v81
    v_sub_f32 v82, v82, v21
    v_exp_f32 v82, v82
    v_sub_f32 v83, v83, v21
    v_exp_f32 v83, v83
    v_smfmac_f32_16x16x64_bf16 v[12:15], v[6:9], v[52:59], v11
    v_sub_f32 v84, v84, v21
    v_exp_f32 v84, v84
    v_sub_f32 v85, v85, v21
    v_exp_f32 v85, v85
    v_perm_b32 v52, v77, v76, s98
    v_perm_b32 v53, v79, v78, s98
    v_perm_b32 v54, v81, v80, s98
    v_perm_b32 v55, v83, v82, s98
    v_sub_f32 v86, v86, v21
    v_exp_f32 v86, v86
    v_sub_f32 v87, v87, v21
    v_exp_f32 v87, v87
    s_waitcnt vmcnt(5)
    ds_read_b64_tr_b16 v[248:249], v25 offset:6144
    ds_read_b64_tr_b16 v[250:251], v25 offset:6656
    s_waitcnt vmcnt(4)
    ds_read_b64_tr_b16 v[252:253], v25 offset:7168
    ds_read_b64_tr_b16 v[254:255], v25 offset:7680
    v_perm_b32 v56, v85, v84, s98
    v_sub_f32 v88, v88, v21
    v_exp_f32 v88, v88
    v_sub_f32 v89, v89, v21
    v_exp_f32 v89, v89
    v_perm_b32 v57, v87, v86, s98
    v_sub_f32 v90, v90, v21
    v_exp_f32 v90, v90
    v_sub_f32 v91, v91, v21
    v_exp_f32 v91, v91
    v_perm_b32 v58, v89, v88, s98
    v_perm_b32 v59, v91, v90, s98
    s_setprio 1
    v_mfma_f32_32x32x16_bf16 v[76:91], v[40:43], v[36:39], 0
    ds_read_b128 v[40:43], v124 offset:40960
    v_sub_f32 v60, v60, v20
    v_exp_f32 v60, v60
    v_sub_f32 v61, v61, v20
    v_exp_f32 v61, v61
    v_sub_f32 v62, v62, v20
    v_exp_f32 v62, v62
    v_sub_f32 v63, v63, v20
    v_exp_f32 v63, v63
    v_smfmac_f32_32x32x32_bf16 v[108:123], v[44:47], v[52:59], v10
    ds_read_b128 v[44:47], v124 offset:39936
    v_sub_f32 v64, v64, v20
    v_exp_f32 v64, v64
    v_sub_f32 v65, v65, v20
    v_exp_f32 v65, v65
    v_sub_f32 v66, v66, v20
    v_exp_f32 v66, v66
    v_sub_f32 v67, v67, v20
    v_exp_f32 v67, v67
    v_smfmac_f32_16x16x64_bf16 v[16:19], v[6:9], v[52:59], v11
    v_sub_f32 v68, v68, v20
    v_exp_f32 v68, v68
    v_sub_f32 v69, v69, v20
    v_exp_f32 v69, v69
    v_perm_b32 v52, v61, v60, s98
    v_perm_b32 v53, v63, v62, s98
    v_perm_b32 v54, v65, v64, s98
    v_perm_b32 v55, v67, v66, s98
    v_sub_f32 v70, v70, v20
    v_exp_f32 v70, v70
    v_sub_f32 v71, v71, v20
    v_exp_f32 v71, v71
    s_add_u32 m0, s83, 4096
    s_add_u32 s75, s94, 176128
    buffer_load_dwordx4 v3, s[48:51], s75 offen lds
    s_add_u32 m0, s83, 5120
    s_add_u32 s75, s94, 220160
    buffer_load_dwordx4 v3, s[48:51], s75 offen lds
    v_perm_b32 v56, v69, v68, s98
    v_sub_f32 v72, v72, v20
    v_exp_f32 v72, v72
    v_sub_f32 v73, v73, v20
    v_exp_f32 v73, v73
    v_perm_b32 v57, v71, v70, s98
    v_sub_f32 v74, v74, v20
    v_exp_f32 v74, v74
    v_sub_f32 v75, v75, v20
    v_exp_f32 v75, v75
    v_perm_b32 v58, v73, v72, s98
    v_perm_b32 v59, v75, v74, s98
    s_waitcnt lgkmcnt(1)
    v_mfma_f32_32x32x16_bf16 v[60:75], v[40:43], v[32:35], 0
    v_sub_f32 v76, v76, v21
    v_exp_f32 v76, v76
    v_sub_f32 v77, v77, v21
    v_exp_f32 v77, v77
    v_sub_f32 v78, v78, v21
    v_exp_f32 v78, v78
    v_sub_f32 v79, v79, v21
    v_exp_f32 v79, v79
    s_waitcnt lgkmcnt(0)
    v_smfmac_f32_32x32x32_bf16 v[92:107], v[44:47], v[52:59], v10
    v_sub_f32 v80, v80, v21
    v_exp_f32 v80, v80
    v_sub_f32 v81, v81, v21
    v_exp_f32 v81, v81
    v_sub_f32 v82, v82, v21
    v_exp_f32 v82, v82
    v_sub_f32 v83, v83, v21
    v_exp_f32 v83, v83
    v_smfmac_f32_16x16x64_bf16 v[12:15], v[6:9], v[52:59], v11
    v_sub_f32 v84, v84, v21
    v_exp_f32 v84, v84
    v_sub_f32 v85, v85, v21
    v_exp_f32 v85, v85
    v_perm_b32 v52, v77, v76, s98
    v_perm_b32 v53, v79, v78, s98
    v_perm_b32 v54, v81, v80, s98
    v_perm_b32 v55, v83, v82, s98
    v_sub_f32 v86, v86, v21
    v_exp_f32 v86, v86
    v_sub_f32 v87, v87, v21
    v_exp_f32 v87, v87
    s_waitcnt vmcnt(5)
    ds_read_b64_tr_b16 v[128:129], v24 offset:0
    ds_read_b64_tr_b16 v[130:131], v24 offset:512
    s_waitcnt vmcnt(4)
    ds_read_b64_tr_b16 v[132:133], v24 offset:1024
    ds_read_b64_tr_b16 v[134:135], v24 offset:1536
    v_perm_b32 v56, v85, v84, s98
    v_sub_f32 v88, v88, v21
    v_exp_f32 v88, v88
    v_sub_f32 v89, v89, v21
    v_exp_f32 v89, v89
    v_perm_b32 v57, v87, v86, s98
    v_sub_f32 v90, v90, v21
    v_exp_f32 v90, v90
    v_sub_f32 v91, v91, v21
    v_exp_f32 v91, v91
    v_perm_b32 v58, v89, v88, s98
    v_perm_b32 v59, v91, v90, s98
    v_mfma_f32_32x32x16_bf16 v[76:91], v[40:43], v[36:39], 0
    ds_read_b128 v[40:43], v124 offset:43008
    v_sub_f32 v60, v60, v20
    v_exp_f32 v60, v60
    v_sub_f32 v61, v61, v20
    v_exp_f32 v61, v61
    v_sub_f32 v62, v62, v20
    v_exp_f32 v62, v62
    v_sub_f32 v63, v63, v20
    v_exp_f32 v63, v63
    v_smfmac_f32_32x32x32_bf16 v[108:123], v[44:47], v[52:59], v10
    ds_read_b128 v[44:47], v124 offset:41984
    v_sub_f32 v64, v64, v20
    v_exp_f32 v64, v64
    v_sub_f32 v65, v65, v20
    v_exp_f32 v65, v65
    v_sub_f32 v66, v66, v20
    v_exp_f32 v66, v66
    v_sub_f32 v67, v67, v20
    v_exp_f32 v67, v67
    v_smfmac_f32_16x16x64_bf16 v[16:19], v[6:9], v[52:59], v11
    v_sub_f32 v68, v68, v20
    v_exp_f32 v68, v68
    v_sub_f32 v69, v69, v20
    v_exp_f32 v69, v69
    v_perm_b32 v52, v61, v60, s98
    v_perm_b32 v53, v63, v62, s98
    v_perm_b32 v54, v65, v64, s98
    v_perm_b32 v55, v67, v66, s98
    v_sub_f32 v70, v70, v20
    v_exp_f32 v70, v70
    v_sub_f32 v71, v71, v20
    v_exp_f32 v71, v71
    s_add_u32 m0, s83, 6144
    s_add_u32 s75, s94, 264192
    buffer_load_dwordx4 v3, s[48:51], s75 offen lds
    s_add_u32 m0, s83, 7168
    s_add_u32 s75, s94, 308224
    buffer_load_dwordx4 v3, s[48:51], s75 offen lds
    v_perm_b32 v56, v69, v68, s98
    v_sub_f32 v72, v72, v20
    v_exp_f32 v72, v72
    v_sub_f32 v73, v73, v20
    v_exp_f32 v73, v73
    v_perm_b32 v57, v71, v70, s98
    v_sub_f32 v74, v74, v20
    v_exp_f32 v74, v74
    v_sub_f32 v75, v75, v20
    v_exp_f32 v75, v75
    v_perm_b32 v58, v73, v72, s98
    v_perm_b32 v59, v75, v74, s98
    s_waitcnt lgkmcnt(1)
    v_mfma_f32_32x32x16_bf16 v[60:75], v[40:43], v[32:35], 0
    v_sub_f32 v76, v76, v21
    v_exp_f32 v76, v76
    v_sub_f32 v77, v77, v21
    v_exp_f32 v77, v77
    v_sub_f32 v78, v78, v21
    v_exp_f32 v78, v78
    v_sub_f32 v79, v79, v21
    v_exp_f32 v79, v79
    s_waitcnt lgkmcnt(0)
    v_smfmac_f32_32x32x32_bf16 v[92:107], v[44:47], v[52:59], v10
    v_sub_f32 v80, v80, v21
    v_exp_f32 v80, v80
    v_sub_f32 v81, v81, v21
    v_exp_f32 v81, v81
    v_sub_f32 v82, v82, v21
    v_exp_f32 v82, v82
    v_sub_f32 v83, v83, v21
    v_exp_f32 v83, v83
    v_smfmac_f32_16x16x64_bf16 v[12:15], v[6:9], v[52:59], v11
    v_sub_f32 v84, v84, v21
    v_exp_f32 v84, v84
    v_sub_f32 v85, v85, v21
    v_exp_f32 v85, v85
    v_perm_b32 v52, v77, v76, s98
    v_perm_b32 v53, v79, v78, s98
    v_perm_b32 v54, v81, v80, s98
    v_perm_b32 v55, v83, v82, s98
    v_sub_f32 v86, v86, v21
    v_exp_f32 v86, v86
    v_sub_f32 v87, v87, v21
    v_exp_f32 v87, v87
    s_waitcnt vmcnt(5)
    ds_read_b64_tr_b16 v[136:137], v24 offset:2048
    ds_read_b64_tr_b16 v[138:139], v24 offset:2560
    s_waitcnt vmcnt(4)
    ds_read_b64_tr_b16 v[140:141], v24 offset:3072
    ds_read_b64_tr_b16 v[142:143], v24 offset:3584
    v_perm_b32 v56, v85, v84, s98
    v_sub_f32 v88, v88, v21
    v_exp_f32 v88, v88
    v_sub_f32 v89, v89, v21
    v_exp_f32 v89, v89
    v_perm_b32 v57, v87, v86, s98
    v_sub_f32 v90, v90, v21
    v_exp_f32 v90, v90
    v_sub_f32 v91, v91, v21
    v_exp_f32 v91, v91
    v_perm_b32 v58, v89, v88, s98
    v_perm_b32 v59, v91, v90, s98
    s_setprio 0
    v_mfma_f32_32x32x16_bf16 v[76:91], v[40:43], v[36:39], 0
    ds_read_b128 v[40:43], v124 offset:45056
    v_sub_f32 v60, v60, v20
    v_exp_f32 v60, v60
    v_sub_f32 v61, v61, v20
    v_exp_f32 v61, v61
    v_sub_f32 v62, v62, v20
    v_exp_f32 v62, v62
    v_sub_f32 v63, v63, v20
    v_exp_f32 v63, v63
    v_smfmac_f32_32x32x32_bf16 v[108:123], v[44:47], v[52:59], v10
    ds_read_b128 v[44:47], v124 offset:44032
    v_sub_f32 v64, v64, v20
    v_exp_f32 v64, v64
    v_sub_f32 v65, v65, v20
    v_exp_f32 v65, v65
    v_sub_f32 v66, v66, v20
    v_exp_f32 v66, v66
    v_sub_f32 v67, v67, v20
    v_exp_f32 v67, v67
    v_smfmac_f32_16x16x64_bf16 v[16:19], v[6:9], v[52:59], v11
    v_sub_f32 v68, v68, v20
    v_exp_f32 v68, v68
    v_sub_f32 v69, v69, v20
    v_exp_f32 v69, v69
    v_perm_b32 v52, v61, v60, s98
    v_perm_b32 v53, v63, v62, s98
    v_perm_b32 v54, v65, v64, s98
    v_perm_b32 v55, v67, v66, s98
    v_sub_f32 v70, v70, v20
    v_exp_f32 v70, v70
    v_sub_f32 v71, v71, v20
    v_exp_f32 v71, v71
    s_add_u32 m0, s83, 0
    s_add_u32 s75, s94, 352256
    buffer_load_dwordx4 v3, s[48:51], s75 offen lds
    s_add_u32 m0, s83, 1024
    s_add_u32 s75, s94, 396288
    buffer_load_dwordx4 v3, s[48:51], s75 offen lds
    v_perm_b32 v56, v69, v68, s98
    v_sub_f32 v72, v72, v20
    v_exp_f32 v72, v72
    v_sub_f32 v73, v73, v20
    v_exp_f32 v73, v73
    v_perm_b32 v57, v71, v70, s98
    v_sub_f32 v74, v74, v20
    v_exp_f32 v74, v74
    v_sub_f32 v75, v75, v20
    v_exp_f32 v75, v75
    v_perm_b32 v58, v73, v72, s98
    v_perm_b32 v59, v75, v74, s98
    s_waitcnt lgkmcnt(1)
    v_mfma_f32_32x32x16_bf16 v[60:75], v[40:43], v[32:35], 0
    v_sub_f32 v76, v76, v21
    v_exp_f32 v76, v76
    v_sub_f32 v77, v77, v21
    v_exp_f32 v77, v77
    v_sub_f32 v78, v78, v21
    v_exp_f32 v78, v78
    v_sub_f32 v79, v79, v21
    v_exp_f32 v79, v79
    s_waitcnt lgkmcnt(0)
    v_smfmac_f32_32x32x32_bf16 v[92:107], v[44:47], v[52:59], v10
    v_sub_f32 v80, v80, v21
    v_exp_f32 v80, v80
    v_sub_f32 v81, v81, v21
    v_exp_f32 v81, v81
    v_sub_f32 v82, v82, v21
    v_exp_f32 v82, v82
    v_sub_f32 v83, v83, v21
    v_exp_f32 v83, v83
    v_smfmac_f32_16x16x64_bf16 v[12:15], v[6:9], v[52:59], v11
    v_sub_f32 v84, v84, v21
    v_exp_f32 v84, v84
    v_sub_f32 v85, v85, v21
    v_exp_f32 v85, v85
    v_perm_b32 v52, v77, v76, s98
    v_perm_b32 v53, v79, v78, s98
    v_perm_b32 v54, v81, v80, s98
    v_perm_b32 v55, v83, v82, s98
    v_sub_f32 v86, v86, v21
    v_exp_f32 v86, v86
    v_sub_f32 v87, v87, v21
    v_exp_f32 v87, v87
    s_waitcnt vmcnt(5)
    ds_read_b64_tr_b16 v[144:145], v24 offset:4096
    ds_read_b64_tr_b16 v[146:147], v24 offset:4608
    s_waitcnt vmcnt(4)
    ds_read_b64_tr_b16 v[148:149], v24 offset:5120
    ds_read_b64_tr_b16 v[150:151], v24 offset:5632
    v_perm_b32 v56, v85, v84, s98
    v_sub_f32 v88, v88, v21
    v_exp_f32 v88, v88
    v_sub_f32 v89, v89, v21
    v_exp_f32 v89, v89
    v_perm_b32 v57, v87, v86, s98
    v_sub_f32 v90, v90, v21
    v_exp_f32 v90, v90
    v_sub_f32 v91, v91, v21
    v_exp_f32 v91, v91
    v_perm_b32 v58, v89, v88, s98
    v_perm_b32 v59, v91, v90, s98
    v_mfma_f32_32x32x16_bf16 v[76:91], v[40:43], v[36:39], 0
    ds_read_b128 v[40:43], v124 offset:47104
    v_sub_f32 v60, v60, v20
    v_exp_f32 v60, v60
    v_sub_f32 v61, v61, v20
    v_exp_f32 v61, v61
    v_sub_f32 v62, v62, v20
    v_exp_f32 v62, v62
    v_sub_f32 v63, v63, v20
    v_exp_f32 v63, v63
    v_smfmac_f32_32x32x32_bf16 v[108:123], v[44:47], v[52:59], v10
    ds_read_b128 v[44:47], v124 offset:46080
    v_sub_f32 v64, v64, v20
    v_exp_f32 v64, v64
    v_sub_f32 v65, v65, v20
    v_exp_f32 v65, v65
    v_sub_f32 v66, v66, v20
    v_exp_f32 v66, v66
    v_sub_f32 v67, v67, v20
    v_exp_f32 v67, v67
    v_smfmac_f32_16x16x64_bf16 v[16:19], v[6:9], v[52:59], v11
    v_sub_f32 v68, v68, v20
    v_exp_f32 v68, v68
    v_sub_f32 v69, v69, v20
    v_exp_f32 v69, v69
    v_perm_b32 v52, v61, v60, s98
    v_perm_b32 v53, v63, v62, s98
    v_perm_b32 v54, v65, v64, s98
    v_perm_b32 v55, v67, v66, s98
    v_sub_f32 v70, v70, v20
    v_exp_f32 v70, v70
    v_sub_f32 v71, v71, v20
    v_exp_f32 v71, v71
    s_add_u32 m0, s83, 2048
    s_add_u32 s75, s94, 440320
    buffer_load_dwordx4 v3, s[48:51], s75 offen lds
    s_add_u32 m0, s83, 3072
    s_add_u32 s75, s94, 484352
    buffer_load_dwordx4 v3, s[48:51], s75 offen lds
    v_perm_b32 v56, v69, v68, s98
    v_sub_f32 v72, v72, v20
    v_exp_f32 v72, v72
    v_sub_f32 v73, v73, v20
    v_exp_f32 v73, v73
    v_perm_b32 v57, v71, v70, s98
    v_sub_f32 v74, v74, v20
    v_exp_f32 v74, v74
    v_sub_f32 v75, v75, v20
    v_exp_f32 v75, v75
    v_perm_b32 v58, v73, v72, s98
    v_perm_b32 v59, v75, v74, s98
    s_waitcnt lgkmcnt(1)
    v_mfma_f32_32x32x16_bf16 v[60:75], v[40:43], v[32:35], 0
    v_sub_f32 v76, v76, v21
    v_exp_f32 v76, v76
    v_sub_f32 v77, v77, v21
    v_exp_f32 v77, v77
    v_sub_f32 v78, v78, v21
    v_exp_f32 v78, v78
    v_sub_f32 v79, v79, v21
    v_exp_f32 v79, v79
    s_waitcnt lgkmcnt(0)
    v_smfmac_f32_32x32x32_bf16 v[92:107], v[44:47], v[52:59], v10
    v_sub_f32 v80, v80, v21
    v_exp_f32 v80, v80
    v_sub_f32 v81, v81, v21
    v_exp_f32 v81, v81
    v_sub_f32 v82, v82, v21
    v_exp_f32 v82, v82
    v_sub_f32 v83, v83, v21
    v_exp_f32 v83, v83
    v_smfmac_f32_16x16x64_bf16 v[12:15], v[6:9], v[52:59], v11
    v_sub_f32 v84, v84, v21
    v_exp_f32 v84, v84
    v_sub_f32 v85, v85, v21
    v_exp_f32 v85, v85
    v_perm_b32 v52, v77, v76, s98
    v_perm_b32 v53, v79, v78, s98
    v_perm_b32 v54, v81, v80, s98
    v_perm_b32 v55, v83, v82, s98
    v_sub_f32 v86, v86, v21
    v_exp_f32 v86, v86
    v_sub_f32 v87, v87, v21
    v_exp_f32 v87, v87
    s_waitcnt vmcnt(5)
    ds_read_b64_tr_b16 v[152:153], v24 offset:6144
    ds_read_b64_tr_b16 v[154:155], v24 offset:6656
    s_waitcnt vmcnt(4)
    ds_read_b64_tr_b16 v[156:157], v24 offset:7168
    ds_read_b64_tr_b16 v[158:159], v24 offset:7680
    v_perm_b32 v56, v85, v84, s98
    v_sub_f32 v88, v88, v21
    v_exp_f32 v88, v88
    v_sub_f32 v89, v89, v21
    v_exp_f32 v89, v89
    v_perm_b32 v57, v87, v86, s98
    v_sub_f32 v90, v90, v21
    v_exp_f32 v90, v90
    v_sub_f32 v91, v91, v21
    v_exp_f32 v91, v91
    v_perm_b32 v58, v89, v88, s98
    v_perm_b32 v59, v91, v90, s98
    s_barrier
    s_setprio 3
    v_mfma_f32_32x32x16_bf16 v[76:91], v[40:43], v[36:39], 0
    ds_read_b128 v[40:43], v125 offset:0
    v_sub_f32 v60, v60, v20
    v_exp_f32 v60, v60
    v_sub_f32 v61, v61, v20
    v_exp_f32 v61, v61
    v_sub_f32 v62, v62, v20
    v_exp_f32 v62, v62
    v_sub_f32 v63, v63, v20
    v_exp_f32 v63, v63
    v_smfmac_f32_32x32x32_bf16 v[108:123], v[44:47], v[52:59], v10
    ds_read_b128 v[44:47], v124 offset:48128
    v_sub_f32 v64, v64, v20
    v_exp_f32 v64, v64
    v_sub_f32 v65, v65, v20
    v_exp_f32 v65, v65
    v_sub_f32 v66, v66, v20
    v_exp_f32 v66, v66
    v_sub_f32 v67, v67, v20
    v_exp_f32 v67, v67
    v_smfmac_f32_16x16x64_bf16 v[16:19], v[6:9], v[52:59], v11
    s_add_u32 m0, s69, 0
    s_add_u32 s75, s69, 163840
    buffer_load_dwordx4 v4, s[56:59], s75 offen sc1 lds
    v_sub_f32 v68, v68, v20
    v_exp_f32 v68, v68
    v_sub_f32 v69, v69, v20
    v_exp_f32 v69, v69
    v_perm_b32 v52, v61, v60, s98
    v_perm_b32 v53, v63, v62, s98
    v_perm_b32 v54, v65, v64, s98
    v_perm_b32 v55, v67, v66, s98
    v_sub_f32 v70, v70, v20
    v_exp_f32 v70, v70
    v_sub_f32 v71, v71, v20
    v_exp_f32 v71, v71
    s_add_u32 m0, s83, 4096
    s_add_u32 s75, s94, 528384
    buffer_load_dwordx4 v3, s[48:51], s75 offen lds
    s_add_u32 m0, s83, 5120
    s_add_u32 s75, s94, 572416
    buffer_load_dwordx4 v3, s[48:51], s75 offen lds
    v_perm_b32 v56, v69, v68, s98
    v_sub_f32 v72, v72, v20
    v_exp_f32 v72, v72
    v_sub_f32 v73, v73, v20
    v_exp_f32 v73, v73
    v_perm_b32 v57, v71, v70, s98
    v_sub_f32 v74, v74, v20
    v_exp_f32 v74, v74
    v_sub_f32 v75, v75, v20
    v_exp_f32 v75, v75
    v_perm_b32 v58, v73, v72, s98
    v_perm_b32 v59, v75, v74, s98
    s_waitcnt lgkmcnt(1)
    v_mfma_f32_32x32x16_bf16 v[60:75], v[40:43], v[32:35], 0
    v_sub_f32 v76, v76, v21
    v_exp_f32 v76, v76
    v_sub_f32 v77, v77, v21
    v_exp_f32 v77, v77
    v_sub_f32 v78, v78, v21
    v_exp_f32 v78, v78
    v_sub_f32 v79, v79, v21
    v_exp_f32 v79, v79
    s_waitcnt lgkmcnt(0)
    v_smfmac_f32_32x32x32_bf16 v[92:107], v[44:47], v[52:59], v10
    v_sub_f32 v80, v80, v21
    v_exp_f32 v80, v80
    v_sub_f32 v81, v81, v21
    v_exp_f32 v81, v81
    v_sub_f32 v82, v82, v21
    v_exp_f32 v82, v82
    v_sub_f32 v83, v83, v21
    v_exp_f32 v83, v83
    v_smfmac_f32_16x16x64_bf16 v[12:15], v[6:9], v[52:59], v11
    s_add_u32 m0, s69, 8192
    s_add_u32 s75, s69, 172032
    buffer_load_dwordx4 v4, s[56:59], s75 offen sc1 lds
    v_sub_f32 v84, v84, v21
    v_exp_f32 v84, v84
    v_sub_f32 v85, v85, v21
    v_exp_f32 v85, v85
    v_perm_b32 v52, v77, v76, s98
    v_perm_b32 v53, v79, v78, s98
    v_perm_b32 v54, v81, v80, s98
    v_perm_b32 v55, v83, v82, s98
    v_sub_f32 v86, v86, v21
    v_exp_f32 v86, v86
    v_sub_f32 v87, v87, v21
    v_exp_f32 v87, v87
    s_waitcnt vmcnt(7)
    ds_read_b64_tr_b16 v[160:161], v24 offset:0
    ds_read_b64_tr_b16 v[162:163], v24 offset:512
    s_waitcnt vmcnt(6)
    ds_read_b64_tr_b16 v[164:165], v24 offset:1024
    ds_read_b64_tr_b16 v[166:167], v24 offset:1536
    v_perm_b32 v56, v85, v84, s98
    v_sub_f32 v88, v88, v21
    v_exp_f32 v88, v88
    v_sub_f32 v89, v89, v21
    v_exp_f32 v89, v89
    v_perm_b32 v57, v87, v86, s98
    v_sub_f32 v90, v90, v21
    v_exp_f32 v90, v90
    v_sub_f32 v91, v91, v21
    v_exp_f32 v91, v91
    v_perm_b32 v58, v89, v88, s98
    v_perm_b32 v59, v91, v90, s98
    v_mfma_f32_32x32x16_bf16 v[76:91], v[40:43], v[36:39], 0
    ds_read_b128 v[40:43], v125 offset:2048
    v_sub_f32 v60, v60, v20
    v_exp_f32 v60, v60
    v_sub_f32 v61, v61, v20
    v_exp_f32 v61, v61
    v_sub_f32 v62, v62, v20
    v_exp_f32 v62, v62
    v_sub_f32 v63, v63, v20
    v_exp_f32 v63, v63
    v_smfmac_f32_32x32x32_bf16 v[108:123], v[44:47], v[52:59], v10
    ds_read_b128 v[44:47], v125 offset:1024
    v_sub_f32 v64, v64, v20
    v_exp_f32 v64, v64
    v_sub_f32 v65, v65, v20
    v_exp_f32 v65, v65
    v_sub_f32 v66, v66, v20
    v_exp_f32 v66, v66
    v_sub_f32 v67, v67, v20
    v_exp_f32 v67, v67
    v_smfmac_f32_16x16x64_bf16 v[16:19], v[6:9], v[52:59], v11
    s_add_u32 m0, s69, 16384
    s_add_u32 s75, s69, 180224
    buffer_load_dwordx4 v4, s[56:59], s75 offen sc1 lds
    v_sub_f32 v68, v68, v20
    v_exp_f32 v68, v68
    v_sub_f32 v69, v69, v20
    v_exp_f32 v69, v69
    v_perm_b32 v52, v61, v60, s98
    v_perm_b32 v53, v63, v62, s98
    v_perm_b32 v54, v65, v64, s98
    v_perm_b32 v55, v67, v66, s98
    v_sub_f32 v70, v70, v20
    v_exp_f32 v70, v70
    v_sub_f32 v71, v71, v20
    v_exp_f32 v71, v71
    s_add_u32 m0, s83, 6144
    s_add_u32 s75, s94, 616448
    buffer_load_dwordx4 v3, s[48:51], s75 offen lds
    s_add_u32 m0, s83, 7168
    s_add_u32 s75, s94, 660480
    buffer_load_dwordx4 v3, s[48:51], s75 offen lds
    v_perm_b32 v56, v69, v68, s98
    v_sub_f32 v72, v72, v20
    v_exp_f32 v72, v72
    v_sub_f32 v73, v73, v20
    v_exp_f32 v73, v73
    v_perm_b32 v57, v71, v70, s98
    v_sub_f32 v74, v74, v20
    v_exp_f32 v74, v74
    v_sub_f32 v75, v75, v20
    v_exp_f32 v75, v75
    v_perm_b32 v58, v73, v72, s98
    v_perm_b32 v59, v75, v74, s98
    s_waitcnt lgkmcnt(1)
    v_mfma_f32_32x32x16_bf16 v[60:75], v[40:43], v[32:35], 0
    v_sub_f32 v76, v76, v21
    v_exp_f32 v76, v76
    v_sub_f32 v77, v77, v21
    v_exp_f32 v77, v77
    v_sub_f32 v78, v78, v21
    v_exp_f32 v78, v78
    v_sub_f32 v79, v79, v21
    v_exp_f32 v79, v79
    s_waitcnt lgkmcnt(0)
    v_smfmac_f32_32x32x32_bf16 v[92:107], v[44:47], v[52:59], v10
    v_sub_f32 v80, v80, v21
    v_exp_f32 v80, v80
    v_sub_f32 v81, v81, v21
    v_exp_f32 v81, v81
    v_sub_f32 v82, v82, v21
    v_exp_f32 v82, v82
    v_sub_f32 v83, v83, v21
    v_exp_f32 v83, v83
    v_smfmac_f32_16x16x64_bf16 v[12:15], v[6:9], v[52:59], v11
    s_add_u32 m0, s69, 24576
    s_add_u32 s75, s69, 188416
    buffer_load_dwordx4 v4, s[56:59], s75 offen sc1 lds
    v_sub_f32 v84, v84, v21
    v_exp_f32 v84, v84
    v_sub_f32 v85, v85, v21
    v_exp_f32 v85, v85
    v_perm_b32 v52, v77, v76, s98
    v_perm_b32 v53, v79, v78, s98
    v_perm_b32 v54, v81, v80, s98
    v_perm_b32 v55, v83, v82, s98
    v_sub_f32 v86, v86, v21
    v_exp_f32 v86, v86
    v_sub_f32 v87, v87, v21
    v_exp_f32 v87, v87
    s_waitcnt vmcnt(9)
    ds_read_b64_tr_b16 v[168:169], v24 offset:2048
    ds_read_b64_tr_b16 v[170:171], v24 offset:2560
    s_waitcnt vmcnt(8)
    ds_read_b64_tr_b16 v[172:173], v24 offset:3072
    ds_read_b64_tr_b16 v[174:175], v24 offset:3584
    v_perm_b32 v56, v85, v84, s98
    v_sub_f32 v88, v88, v21
    v_exp_f32 v88, v88
    v_sub_f32 v89, v89, v21
    v_exp_f32 v89, v89
    v_perm_b32 v57, v87, v86, s98
    v_sub_f32 v90, v90, v21
    v_exp_f32 v90, v90
    v_sub_f32 v91, v91, v21
    v_exp_f32 v91, v91
    v_perm_b32 v58, v89, v88, s98
    v_perm_b32 v59, v91, v90, s98
    s_setprio 2
    v_mfma_f32_32x32x16_bf16 v[76:91], v[40:43], v[36:39], 0
    ds_read_b128 v[40:43], v125 offset:4096
    v_sub_f32 v60, v60, v20
    v_exp_f32 v60, v60
    v_sub_f32 v61, v61, v20
    v_exp_f32 v61, v61
    v_sub_f32 v62, v62, v20
    v_exp_f32 v62, v62
    v_sub_f32 v63, v63, v20
    v_exp_f32 v63, v63
    v_smfmac_f32_32x32x32_bf16 v[108:123], v[44:47], v[52:59], v10
    ds_read_b128 v[44:47], v125 offset:3072
    v_sub_f32 v64, v64, v20
    v_exp_f32 v64, v64
    v_sub_f32 v65, v65, v20
    v_exp_f32 v65, v65
    v_sub_f32 v66, v66, v20
    v_exp_f32 v66, v66
    v_sub_f32 v67, v67, v20
    v_exp_f32 v67, v67
    v_smfmac_f32_16x16x64_bf16 v[16:19], v[6:9], v[52:59], v11
    v_sub_f32 v68, v68, v20
    v_exp_f32 v68, v68
    v_sub_f32 v69, v69, v20
    v_exp_f32 v69, v69
    v_perm_b32 v52, v61, v60, s98
    v_perm_b32 v53, v63, v62, s98
    v_perm_b32 v54, v65, v64, s98
    v_perm_b32 v55, v67, v66, s98
    v_sub_f32 v70, v70, v20
    v_exp_f32 v70, v70
    v_sub_f32 v71, v71, v20
    v_exp_f32 v71, v71
    v_perm_b32 v56, v69, v68, s98
    v_sub_f32 v72, v72, v20
    v_exp_f32 v72, v72
    v_sub_f32 v73, v73, v20
    v_exp_f32 v73, v73
    v_perm_b32 v57, v71, v70, s98
    v_sub_f32 v74, v74, v20
    v_exp_f32 v74, v74
    v_sub_f32 v75, v75, v20
    v_exp_f32 v75, v75
    v_perm_b32 v58, v73, v72, s98
    v_perm_b32 v59, v75, v74, s98
    s_waitcnt lgkmcnt(1)
    v_mfma_f32_32x32x16_bf16 v[60:75], v[40:43], v[32:35], 0
    v_sub_f32 v76, v76, v21
    v_exp_f32 v76, v76
    v_sub_f32 v77, v77, v21
    v_exp_f32 v77, v77
    v_sub_f32 v78, v78, v21
    v_exp_f32 v78, v78
    v_sub_f32 v79, v79, v21
    v_exp_f32 v79, v79
    s_waitcnt lgkmcnt(0)
    v_smfmac_f32_32x32x32_bf16 v[92:107], v[44:47], v[52:59], v10
    v_sub_f32 v80, v80, v21
    v_exp_f32 v80, v80
    v_sub_f32 v81, v81, v21
    v_exp_f32 v81, v81
    v_sub_f32 v82, v82, v21
    v_exp_f32 v82, v82
    v_sub_f32 v83, v83, v21
    v_exp_f32 v83, v83
    v_smfmac_f32_16x16x64_bf16 v[12:15], v[6:9], v[52:59], v11
    v_sub_f32 v84, v84, v21
    v_exp_f32 v84, v84
    v_sub_f32 v85, v85, v21
    v_exp_f32 v85, v85
    v_perm_b32 v52, v77, v76, s98
    v_perm_b32 v53, v79, v78, s98
    v_perm_b32 v54, v81, v80, s98
    v_perm_b32 v55, v83, v82, s98
    v_sub_f32 v86, v86, v21
    v_exp_f32 v86, v86
    v_sub_f32 v87, v87, v21
    v_exp_f32 v87, v87
    s_waitcnt vmcnt(6)
    ds_read_b64_tr_b16 v[176:177], v24 offset:4096
    ds_read_b64_tr_b16 v[178:179], v24 offset:4608
    s_waitcnt vmcnt(5)
    ds_read_b64_tr_b16 v[180:181], v24 offset:5120
    ds_read_b64_tr_b16 v[182:183], v24 offset:5632
    v_perm_b32 v56, v85, v84, s98
    v_sub_f32 v88, v88, v21
    v_exp_f32 v88, v88
    v_sub_f32 v89, v89, v21
    v_exp_f32 v89, v89
    v_perm_b32 v57, v87, v86, s98
    v_sub_f32 v90, v90, v21
    v_exp_f32 v90, v90
    v_sub_f32 v91, v91, v21
    v_exp_f32 v91, v91
    v_perm_b32 v58, v89, v88, s98
    v_perm_b32 v59, v91, v90, s98
    s_add_u32 s72, s89, s80
    s_lshl_b32 s72, s72, 6
    v_mov_b32 v28, s72
    s_lshl_b32 s72, s65, 7
    v_mov_b32 v29, s72
    global_load_dword v26, v28, s[18:19]
    global_load_dword v26, v29, s[22:23]
    v_mfma_f32_32x32x16_bf16 v[76:91], v[40:43], v[36:39], 0
    ds_read_b128 v[40:43], v125 offset:6144
    v_sub_f32 v60, v60, v20
    v_exp_f32 v60, v60
    v_sub_f32 v61, v61, v20
    v_exp_f32 v61, v61
    v_sub_f32 v62, v62, v20
    v_exp_f32 v62, v62
    v_sub_f32 v63, v63, v20
    v_exp_f32 v63, v63
    v_smfmac_f32_32x32x32_bf16 v[108:123], v[44:47], v[52:59], v10
    ds_read_b128 v[44:47], v125 offset:5120
    v_sub_f32 v64, v64, v20
    v_exp_f32 v64, v64
    v_sub_f32 v65, v65, v20
    v_exp_f32 v65, v65
    v_sub_f32 v66, v66, v20
    v_exp_f32 v66, v66
    v_sub_f32 v67, v67, v20
    v_exp_f32 v67, v67
    v_smfmac_f32_16x16x64_bf16 v[16:19], v[6:9], v[52:59], v11
    s_add_u32 s75, s74, 0
    buffer_load_dword v26, v30, s[48:51], s75 offen
    v_sub_f32 v68, v68, v20
    v_exp_f32 v68, v68
    v_sub_f32 v69, v69, v20
    v_exp_f32 v69, v69
    v_perm_b32 v52, v61, v60, s98
    v_perm_b32 v53, v63, v62, s98
    v_perm_b32 v54, v65, v64, s98
    v_perm_b32 v55, v67, v66, s98
    v_sub_f32 v70, v70, v20
    v_exp_f32 v70, v70
    v_sub_f32 v71, v71, v20
    v_exp_f32 v71, v71
    v_perm_b32 v56, v69, v68, s98
    v_sub_f32 v72, v72, v20
    v_exp_f32 v72, v72
    v_sub_f32 v73, v73, v20
    v_exp_f32 v73, v73
    v_perm_b32 v57, v71, v70, s98
    v_sub_f32 v74, v74, v20
    v_exp_f32 v74, v74
    v_sub_f32 v75, v75, v20
    v_exp_f32 v75, v75
    v_perm_b32 v58, v73, v72, s98
    v_perm_b32 v59, v75, v74, s98
    s_waitcnt lgkmcnt(1)
    v_mfma_f32_32x32x16_bf16 v[60:75], v[40:43], v[32:35], 0
    v_sub_f32 v76, v76, v21
    v_exp_f32 v76, v76
    v_sub_f32 v77, v77, v21
    v_exp_f32 v77, v77
    v_sub_f32 v78, v78, v21
    v_exp_f32 v78, v78
    v_sub_f32 v79, v79, v21
    v_exp_f32 v79, v79
    s_waitcnt lgkmcnt(0)
    v_smfmac_f32_32x32x32_bf16 v[92:107], v[44:47], v[52:59], v10
    v_sub_f32 v80, v80, v21
    v_exp_f32 v80, v80
    v_sub_f32 v81, v81, v21
    v_exp_f32 v81, v81
    v_sub_f32 v82, v82, v21
    v_exp_f32 v82, v82
    v_sub_f32 v83, v83, v21
    v_exp_f32 v83, v83
    v_smfmac_f32_16x16x64_bf16 v[12:15], v[6:9], v[52:59], v11
    buffer_load_dwordx2 v[48:49], v27, s[32:35], s68 offen
    v_sub_f32 v84, v84, v21
    v_exp_f32 v84, v84
    v_sub_f32 v85, v85, v21
    v_exp_f32 v85, v85
    v_perm_b32 v52, v77, v76, s98
    v_perm_b32 v53, v79, v78, s98
    v_perm_b32 v54, v81, v80, s98
    v_perm_b32 v55, v83, v82, s98
    v_sub_f32 v86, v86, v21
    v_exp_f32 v86, v86
    v_sub_f32 v87, v87, v21
    v_exp_f32 v87, v87
    s_waitcnt vmcnt(6)
    ds_read_b64_tr_b16 v[184:185], v24 offset:6144
    ds_read_b64_tr_b16 v[186:187], v24 offset:6656
    s_waitcnt vmcnt(5)
    ds_read_b64_tr_b16 v[188:189], v24 offset:7168
    ds_read_b64_tr_b16 v[190:191], v24 offset:7680
    v_perm_b32 v56, v85, v84, s98
    v_sub_f32 v88, v88, v21
    v_exp_f32 v88, v88
    v_sub_f32 v89, v89, v21
    v_exp_f32 v89, v89
    v_perm_b32 v57, v87, v86, s98
    v_sub_f32 v90, v90, v21
    v_exp_f32 v90, v90
    v_sub_f32 v91, v91, v21
    v_exp_f32 v91, v91
    v_perm_b32 v58, v89, v88, s98
    v_perm_b32 v59, v91, v90, s98
    s_setprio 1
    v_mfma_f32_32x32x16_bf16 v[76:91], v[40:43], v[36:39], 0
    ds_read_b128 v[40:43], v125 offset:8192
    v_sub_f32 v60, v60, v20
    v_exp_f32 v60, v60
    v_sub_f32 v61, v61, v20
    v_exp_f32 v61, v61
    v_sub_f32 v62, v62, v20
    v_exp_f32 v62, v62
    v_sub_f32 v63, v63, v20
    v_exp_f32 v63, v63
    v_smfmac_f32_32x32x32_bf16 v[108:123], v[44:47], v[52:59], v10
    ds_read_b128 v[44:47], v125 offset:7168
    v_sub_f32 v64, v64, v20
    v_exp_f32 v64, v64
    v_sub_f32 v65, v65, v20
    v_exp_f32 v65, v65
    v_sub_f32 v66, v66, v20
    v_exp_f32 v66, v66
    v_sub_f32 v67, v67, v20
    v_exp_f32 v67, v67
    v_smfmac_f32_16x16x64_bf16 v[16:19], v[6:9], v[52:59], v11
    buffer_load_dwordx2 v[50:51], v27, s[32:35], s68 offen offset:16
    v_sub_f32 v68, v68, v20
    v_exp_f32 v68, v68
    v_sub_f32 v69, v69, v20
    v_exp_f32 v69, v69
    v_perm_b32 v52, v61, v60, s98
    v_perm_b32 v53, v63, v62, s98
    v_perm_b32 v54, v65, v64, s98
    v_perm_b32 v55, v67, v66, s98
    v_sub_f32 v70, v70, v20
    v_exp_f32 v70, v70
    v_sub_f32 v71, v71, v20
    v_exp_f32 v71, v71
    v_perm_b32 v56, v69, v68, s98
    v_sub_f32 v72, v72, v20
    v_exp_f32 v72, v72
    v_sub_f32 v73, v73, v20
    v_exp_f32 v73, v73
    v_perm_b32 v57, v71, v70, s98
    v_sub_f32 v74, v74, v20
    v_exp_f32 v74, v74
    v_sub_f32 v75, v75, v20
    v_exp_f32 v75, v75
    v_perm_b32 v58, v73, v72, s98
    v_perm_b32 v59, v75, v74, s98
    s_waitcnt lgkmcnt(1)
    v_mfma_f32_32x32x16_bf16 v[60:75], v[40:43], v[32:35], 0
    v_sub_f32 v76, v76, v21
    v_exp_f32 v76, v76
    v_sub_f32 v77, v77, v21
    v_exp_f32 v77, v77
    v_sub_f32 v78, v78, v21
    v_exp_f32 v78, v78
    v_sub_f32 v79, v79, v21
    v_exp_f32 v79, v79
    s_waitcnt lgkmcnt(0)
    v_smfmac_f32_32x32x32_bf16 v[92:107], v[44:47], v[52:59], v10
    v_sub_f32 v80, v80, v21
    v_exp_f32 v80, v80
    v_sub_f32 v81, v81, v21
    v_exp_f32 v81, v81
    v_sub_f32 v82, v82, v21
    v_exp_f32 v82, v82
    v_sub_f32 v83, v83, v21
    v_exp_f32 v83, v83
    v_smfmac_f32_16x16x64_bf16 v[12:15], v[6:9], v[52:59], v11
    s_add_u32 s75, s73, 0
    buffer_load_dword v26, v30, s[52:55], s75 offen
    v_sub_f32 v84, v84, v21
    v_exp_f32 v84, v84
    v_sub_f32 v85, v85, v21
    v_exp_f32 v85, v85
    v_perm_b32 v52, v77, v76, s98
    v_perm_b32 v53, v79, v78, s98
    v_perm_b32 v54, v81, v80, s98
    v_perm_b32 v55, v83, v82, s98
    v_sub_f32 v86, v86, v21
    v_exp_f32 v86, v86
    v_sub_f32 v87, v87, v21
    v_exp_f32 v87, v87
    v_perm_b32 v56, v85, v84, s98
    v_sub_f32 v88, v88, v21
    v_exp_f32 v88, v88
    v_sub_f32 v89, v89, v21
    v_exp_f32 v89, v89
    v_perm_b32 v57, v87, v86, s98
    v_sub_f32 v90, v90, v21
    v_exp_f32 v90, v90
    v_sub_f32 v91, v91, v21
    v_exp_f32 v91, v91
    v_perm_b32 v58, v89, v88, s98
    v_perm_b32 v59, v91, v90, s98
    v_mfma_f32_32x32x16_bf16 v[76:91], v[40:43], v[36:39], 0
    ds_read_b128 v[40:43], v125 offset:10240
    v_sub_f32 v60, v60, v20
    v_exp_f32 v60, v60
    v_sub_f32 v61, v61, v20
    v_exp_f32 v61, v61
    v_sub_f32 v62, v62, v20
    v_exp_f32 v62, v62
    v_sub_f32 v63, v63, v20
    v_exp_f32 v63, v63
    v_smfmac_f32_32x32x32_bf16 v[108:123], v[44:47], v[52:59], v10
    ds_read_b128 v[44:47], v125 offset:9216
    v_sub_f32 v64, v64, v20
    v_exp_f32 v64, v64
    v_sub_f32 v65, v65, v20
    v_exp_f32 v65, v65
    v_sub_f32 v66, v66, v20
    v_exp_f32 v66, v66
    v_sub_f32 v67, v67, v20
    v_exp_f32 v67, v67
    v_smfmac_f32_16x16x64_bf16 v[16:19], v[6:9], v[52:59], v11
    s_add_u32 s75, s73, 32768
    buffer_load_dword v26, v30, s[52:55], s75 offen
    v_sub_f32 v68, v68, v20
    v_exp_f32 v68, v68
    v_sub_f32 v69, v69, v20
    v_exp_f32 v69, v69
    v_perm_b32 v52, v61, v60, s98
    v_perm_b32 v53, v63, v62, s98
    v_perm_b32 v54, v65, v64, s98
    v_perm_b32 v55, v67, v66, s98
    v_sub_f32 v70, v70, v20
    v_exp_f32 v70, v70
    v_sub_f32 v71, v71, v20
    v_exp_f32 v71, v71
    v_perm_b32 v56, v69, v68, s98
    v_sub_f32 v72, v72, v20
    v_exp_f32 v72, v72
    v_sub_f32 v73, v73, v20
    v_exp_f32 v73, v73
    v_perm_b32 v57, v71, v70, s98
    v_sub_f32 v74, v74, v20
    v_exp_f32 v74, v74
    v_sub_f32 v75, v75, v20
    v_exp_f32 v75, v75
    v_perm_b32 v58, v73, v72, s98
    v_perm_b32 v59, v75, v74, s98
    s_waitcnt lgkmcnt(1)
    v_mfma_f32_32x32x16_bf16 v[60:75], v[40:43], v[32:35], 0
    v_sub_f32 v76, v76, v21
    v_exp_f32 v76, v76
    v_sub_f32 v77, v77, v21
    v_exp_f32 v77, v77
    v_sub_f32 v78, v78, v21
    v_exp_f32 v78, v78
    v_sub_f32 v79, v79, v21
    v_exp_f32 v79, v79
    s_waitcnt lgkmcnt(0)
    v_smfmac_f32_32x32x32_bf16 v[92:107], v[44:47], v[52:59], v10
    v_sub_f32 v80, v80, v21
    v_exp_f32 v80, v80
    v_sub_f32 v81, v81, v21
    v_exp_f32 v81, v81
    v_sub_f32 v82, v82, v21
    v_exp_f32 v82, v82
    v_sub_f32 v83, v83, v21
    v_exp_f32 v83, v83
    v_smfmac_f32_16x16x64_bf16 v[12:15], v[6:9], v[52:59], v11
    v_sub_f32 v84, v84, v21
    v_exp_f32 v84, v84
    v_sub_f32 v85, v85, v21
    v_exp_f32 v85, v85
    v_perm_b32 v52, v77, v76, s98
    v_perm_b32 v53, v79, v78, s98
    v_perm_b32 v54, v81, v80, s98
    v_perm_b32 v55, v83, v82, s98
    v_sub_f32 v86, v86, v21
    v_exp_f32 v86, v86
    v_sub_f32 v87, v87, v21
    v_exp_f32 v87, v87
    v_perm_b32 v56, v85, v84, s98
    v_sub_f32 v88, v88, v21
    v_exp_f32 v88, v88
    v_sub_f32 v89, v89, v21
    v_exp_f32 v89, v89
    v_perm_b32 v57, v87, v86, s98
    v_sub_f32 v90, v90, v21
    v_exp_f32 v90, v90
    v_sub_f32 v91, v91, v21
    v_exp_f32 v91, v91
    v_perm_b32 v58, v89, v88, s98
    v_perm_b32 v59, v91, v90, s98
    s_setprio 0
    v_mfma_f32_32x32x16_bf16 v[76:91], v[40:43], v[36:39], 0
    ds_read_b128 v[40:43], v125 offset:12288
    v_sub_f32 v60, v60, v20
    v_exp_f32 v60, v60
    v_sub_f32 v61, v61, v20
    v_exp_f32 v61, v61
    v_sub_f32 v62, v62, v20
    v_exp_f32 v62, v62
    v_sub_f32 v63, v63, v20
    v_exp_f32 v63, v63
    v_smfmac_f32_32x32x32_bf16 v[108:123], v[44:47], v[52:59], v10
    ds_read_b128 v[44:47], v125 offset:11264
    v_sub_f32 v64, v64, v20
    v_exp_f32 v64, v64
    v_sub_f32 v65, v65, v20
    v_exp_f32 v65, v65
    v_sub_f32 v66, v66, v20
    v_exp_f32 v66, v66
    v_sub_f32 v67, v67, v20
    v_exp_f32 v67, v67
    v_smfmac_f32_16x16x64_bf16 v[16:19], v[6:9], v[52:59], v11
    v_sub_f32 v68, v68, v20
    v_exp_f32 v68, v68
    v_sub_f32 v69, v69, v20
    v_exp_f32 v69, v69
    v_perm_b32 v52, v61, v60, s98
    v_perm_b32 v53, v63, v62, s98
    v_perm_b32 v54, v65, v64, s98
    v_perm_b32 v55, v67, v66, s98
    v_sub_f32 v70, v70, v20
    v_exp_f32 v70, v70
    v_sub_f32 v71, v71, v20
    v_exp_f32 v71, v71
    v_perm_b32 v56, v69, v68, s98
    v_sub_f32 v72, v72, v20
    v_exp_f32 v72, v72
    v_sub_f32 v73, v73, v20
    v_exp_f32 v73, v73
    v_perm_b32 v57, v71, v70, s98
    v_sub_f32 v74, v74, v20
    v_exp_f32 v74, v74
    v_sub_f32 v75, v75, v20
    v_exp_f32 v75, v75
    v_perm_b32 v58, v73, v72, s98
    v_perm_b32 v59, v75, v74, s98
    s_waitcnt lgkmcnt(1)
    v_mfma_f32_32x32x16_bf16 v[60:75], v[40:43], v[32:35], 0
    v_sub_f32 v76, v76, v21
    v_exp_f32 v76, v76
    v_sub_f32 v77, v77, v21
    v_exp_f32 v77, v77
    v_sub_f32 v78, v78, v21
    v_exp_f32 v78, v78
    v_sub_f32 v79, v79, v21
    v_exp_f32 v79, v79
    s_waitcnt lgkmcnt(0)
    v_smfmac_f32_32x32x32_bf16 v[92:107], v[44:47], v[52:59], v10
    v_sub_f32 v80, v80, v21
    v_exp_f32 v80, v80
    v_sub_f32 v81, v81, v21
    v_exp_f32 v81, v81
    v_sub_f32 v82, v82, v21
    v_exp_f32 v82, v82
    v_sub_f32 v83, v83, v21
    v_exp_f32 v83, v83
    v_smfmac_f32_16x16x64_bf16 v[12:15], v[6:9], v[52:59], v11
    v_sub_f32 v84, v84, v21
    v_exp_f32 v84, v84
    v_sub_f32 v85, v85, v21
    v_exp_f32 v85, v85
    v_perm_b32 v52, v77, v76, s98
    v_perm_b32 v53, v79, v78, s98
    v_perm_b32 v54, v81, v80, s98
    v_perm_b32 v55, v83, v82, s98
    v_sub_f32 v86, v86, v21
    v_exp_f32 v86, v86
    v_sub_f32 v87, v87, v21
    v_exp_f32 v87, v87
    v_perm_b32 v56, v85, v84, s98
    v_sub_f32 v88, v88, v21
    v_exp_f32 v88, v88
    v_sub_f32 v89, v89, v21
    v_exp_f32 v89, v89
    v_perm_b32 v57, v87, v86, s98
    v_sub_f32 v90, v90, v21
    v_exp_f32 v90, v90
    v_sub_f32 v91, v91, v21
    v_exp_f32 v91, v91
    v_perm_b32 v58, v89, v88, s98
    v_perm_b32 v59, v91, v90, s98
    v_mfma_f32_32x32x16_bf16 v[76:91], v[40:43], v[36:39], 0
    ds_read_b128 v[40:43], v125 offset:14336
    v_sub_f32 v60, v60, v20
    v_exp_f32 v60, v60
    v_sub_f32 v61, v61, v20
    v_exp_f32 v61, v61
    v_sub_f32 v62, v62, v20
    v_exp_f32 v62, v62
    v_sub_f32 v63, v63, v20
    v_exp_f32 v63, v63
    v_smfmac_f32_32x32x32_bf16 v[108:123], v[44:47], v[52:59], v10
    ds_read_b128 v[44:47], v125 offset:13312
    v_sub_f32 v64, v64, v20
    v_exp_f32 v64, v64
    v_sub_f32 v65, v65, v20
    v_exp_f32 v65, v65
    v_sub_f32 v66, v66, v20
    v_exp_f32 v66, v66
    v_sub_f32 v67, v67, v20
    v_exp_f32 v67, v67
    v_smfmac_f32_16x16x64_bf16 v[16:19], v[6:9], v[52:59], v11
    v_sub_f32 v68, v68, v20
    v_exp_f32 v68, v68
    v_sub_f32 v69, v69, v20
    v_exp_f32 v69, v69
    v_perm_b32 v52, v61, v60, s98
    v_perm_b32 v53, v63, v62, s98
    v_perm_b32 v54, v65, v64, s98
    v_perm_b32 v55, v67, v66, s98
    v_sub_f32 v70, v70, v20
    v_exp_f32 v70, v70
    v_sub_f32 v71, v71, v20
    v_exp_f32 v71, v71
    v_perm_b32 v56, v69, v68, s98
    v_sub_f32 v72, v72, v20
    v_exp_f32 v72, v72
    v_sub_f32 v73, v73, v20
    v_exp_f32 v73, v73
    v_perm_b32 v57, v71, v70, s98
    v_sub_f32 v74, v74, v20
    v_exp_f32 v74, v74
    v_sub_f32 v75, v75, v20
    v_exp_f32 v75, v75
    v_perm_b32 v58, v73, v72, s98
    v_perm_b32 v59, v75, v74, s98
    s_waitcnt lgkmcnt(1)
    v_mfma_f32_32x32x16_bf16 v[60:75], v[40:43], v[32:35], 0
    v_sub_f32 v76, v76, v21
    v_exp_f32 v76, v76
    v_sub_f32 v77, v77, v21
    v_exp_f32 v77, v77
    v_sub_f32 v78, v78, v21
    v_exp_f32 v78, v78
    v_sub_f32 v79, v79, v21
    v_exp_f32 v79, v79
    s_waitcnt lgkmcnt(0)
    v_smfmac_f32_32x32x32_bf16 v[92:107], v[44:47], v[52:59], v10
    v_sub_f32 v80, v80, v21
    v_exp_f32 v80, v80
    v_sub_f32 v81, v81, v21
    v_exp_f32 v81, v81
    v_sub_f32 v82, v82, v21
    v_exp_f32 v82, v82
    v_sub_f32 v83, v83, v21
    v_exp_f32 v83, v83
    v_smfmac_f32_16x16x64_bf16 v[12:15], v[6:9], v[52:59], v11
    v_sub_f32 v84, v84, v21
    v_exp_f32 v84, v84
    v_sub_f32 v85, v85, v21
    v_exp_f32 v85, v85
    v_perm_b32 v52, v77, v76, s98
    v_perm_b32 v53, v79, v78, s98
    v_perm_b32 v54, v81, v80, s98
    v_perm_b32 v55, v83, v82, s98
    v_sub_f32 v86, v86, v21
    v_exp_f32 v86, v86
    v_sub_f32 v87, v87, v21
    v_exp_f32 v87, v87
    v_perm_b32 v56, v85, v84, s98
    v_sub_f32 v88, v88, v21
    v_exp_f32 v88, v88
    v_sub_f32 v89, v89, v21
    v_exp_f32 v89, v89
    v_perm_b32 v57, v87, v86, s98
    v_sub_f32 v90, v90, v21
    v_exp_f32 v90, v90
    v_sub_f32 v91, v91, v21
    v_exp_f32 v91, v91
    v_perm_b32 v58, v89, v88, s98
    v_perm_b32 v59, v91, v90, s98
    s_waitcnt vmcnt(7)
    s_waitcnt lgkmcnt(0)
    s_barrier
    s_setprio 3
    v_mfma_f32_32x32x16_bf16 v[76:91], v[40:43], v[36:39], 0
    ds_read_b128 v[40:43], v124 offset:0
    v_sub_f32 v60, v60, v20
    v_exp_f32 v60, v60
    v_sub_f32 v61, v61, v20
    v_exp_f32 v61, v61
    v_sub_f32 v62, v62, v20
    v_exp_f32 v62, v62
    v_sub_f32 v63, v63, v20
    v_exp_f32 v63, v63
    v_smfmac_f32_32x32x32_bf16 v[108:123], v[44:47], v[52:59], v10
    ds_read_b128 v[44:47], v125 offset:15360
    v_sub_f32 v64, v64, v20
    v_exp_f32 v64, v64
    v_sub_f32 v65, v65, v20
    v_exp_f32 v65, v65
    v_sub_f32 v66, v66, v20
    v_exp_f32 v66, v66
    v_sub_f32 v67, v67, v20
    v_exp_f32 v67, v67
    v_smfmac_f32_16x16x64_bf16 v[16:19], v[6:9], v[52:59], v11
    s_add_u32 m0, s69, 114688
    s_add_u32 s75, s87, 704512
    buffer_load_dwordx4 v3, s[48:51], s75 offen lds
    v_sub_f32 v68, v68, v20
    v_exp_f32 v68, v68
    v_sub_f32 v69, v69, v20
    v_exp_f32 v69, v69
    v_perm_b32 v52, v61, v60, s98
    v_perm_b32 v53, v63, v62, s98
    v_perm_b32 v54, v65, v64, s98
    v_perm_b32 v55, v67, v66, s98
    v_sub_f32 v70, v70, v20
    v_exp_f32 v70, v70
    v_sub_f32 v71, v71, v20
    v_exp_f32 v71, v71
    v_perm_b32 v56, v69, v68, s98
    v_sub_f32 v72, v72, v20
    v_exp_f32 v72, v72
    v_sub_f32 v73, v73, v20
    v_exp_f32 v73, v73
    v_perm_b32 v57, v71, v70, s98
    v_sub_f32 v74, v74, v20
    v_exp_f32 v74, v74
    v_sub_f32 v75, v75, v20
    v_exp_f32 v75, v75
    v_perm_b32 v58, v73, v72, s98
    v_perm_b32 v59, v75, v74, s98
    s_waitcnt lgkmcnt(1)
    v_mfma_f32_32x32x16_bf16 v[60:75], v[40:43], v[32:35], 0
    v_sub_f32 v76, v76, v21
    v_exp_f32 v76, v76
    v_sub_f32 v77, v77, v21
    v_exp_f32 v77, v77
    v_sub_f32 v78, v78, v21
    v_exp_f32 v78, v78
    v_sub_f32 v79, v79, v21
    v_exp_f32 v79, v79
    s_waitcnt lgkmcnt(0)
    v_smfmac_f32_32x32x32_bf16 v[92:107], v[44:47], v[52:59], v10
    v_sub_f32 v80, v80, v21
    v_exp_f32 v80, v80
    v_sub_f32 v81, v81, v21
    v_exp_f32 v81, v81
    v_sub_f32 v82, v82, v21
    v_exp_f32 v82, v82
    v_sub_f32 v83, v83, v21
    v_exp_f32 v83, v83
    v_smfmac_f32_16x16x64_bf16 v[12:15], v[6:9], v[52:59], v11
    s_add_u32 m0, s69, 122880
    s_add_u32 s75, s87, 704576
    buffer_load_dwordx4 v3, s[48:51], s75 offen lds
    v_sub_f32 v84, v84, v21
    v_exp_f32 v84, v84
    v_sub_f32 v85, v85, v21
    v_exp_f32 v85, v85
    v_perm_b32 v52, v77, v76, s98
    v_perm_b32 v53, v79, v78, s98
    v_perm_b32 v54, v81, v80, s98
    v_perm_b32 v55, v83, v82, s98
    v_sub_f32 v86, v86, v21
    v_exp_f32 v86, v86
    v_sub_f32 v87, v87, v21
    v_exp_f32 v87, v87
    v_perm_b32 v56, v85, v84, s98
    v_sub_f32 v88, v88, v21
    v_exp_f32 v88, v88
    v_sub_f32 v89, v89, v21
    v_exp_f32 v89, v89
    v_perm_b32 v57, v87, v86, s98
    v_sub_f32 v90, v90, v21
    v_exp_f32 v90, v90
    v_sub_f32 v91, v91, v21
    v_exp_f32 v91, v91
    v_perm_b32 v58, v89, v88, s98
    v_perm_b32 v59, v91, v90, s98
    v_mfma_f32_32x32x16_bf16 v[76:91], v[40:43], v[36:39], 0
    ds_read_b128 v[40:43], v124 offset:2048
    v_sub_f32 v60, v60, v20
    v_exp_f32 v60, v60
    v_sub_f32 v61, v61, v20
    v_exp_f32 v61, v61
    v_sub_f32 v62, v62, v20
    v_exp_f32 v62, v62
    v_sub_f32 v63, v63, v20
    v_exp_f32 v63, v63
    v_smfmac_f32_32x32x32_bf16 v[108:123], v[44:47], v[52:59], v10
    ds_read_b128 v[44:47], v124 offset:1024
    v_sub_f32 v64, v64, v20
    v_exp_f32 v64, v64
    v_sub_f32 v65, v65, v20
    v_exp_f32 v65, v65
    v_sub_f32 v66, v66, v20
    v_exp_f32 v66, v66
    v_sub_f32 v67, v67, v20
    v_exp_f32 v67, v67
    v_smfmac_f32_16x16x64_bf16 v[16:19], v[6:9], v[52:59], v11
    s_add_u32 m0, s69, 131072
    s_add_u32 s75, s87, 704640
    buffer_load_dwordx4 v3, s[48:51], s75 offen lds
    v_sub_f32 v68, v68, v20
    v_exp_f32 v68, v68
    v_sub_f32 v69, v69, v20
    v_exp_f32 v69, v69
    v_perm_b32 v52, v61, v60, s98
    v_perm_b32 v53, v63, v62, s98
    v_perm_b32 v54, v65, v64, s98
    v_perm_b32 v55, v67, v66, s98
    v_sub_f32 v70, v70, v20
    v_exp_f32 v70, v70
    v_sub_f32 v71, v71, v20
    v_exp_f32 v71, v71
    v_perm_b32 v56, v69, v68, s98
    v_sub_f32 v72, v72, v20
    v_exp_f32 v72, v72
    v_sub_f32 v73, v73, v20
    v_exp_f32 v73, v73
    v_perm_b32 v57, v71, v70, s98
    v_sub_f32 v74, v74, v20
    v_exp_f32 v74, v74
    v_sub_f32 v75, v75, v20
    v_exp_f32 v75, v75
    v_perm_b32 v58, v73, v72, s98
    v_perm_b32 v59, v75, v74, s98
    s_waitcnt lgkmcnt(1)
    v_mfma_f32_32x32x16_bf16 v[60:75], v[40:43], v[32:35], 0
    v_sub_f32 v76, v76, v21
    v_exp_f32 v76, v76
    v_sub_f32 v77, v77, v21
    v_exp_f32 v77, v77
    v_sub_f32 v78, v78, v21
    v_exp_f32 v78, v78
    v_sub_f32 v79, v79, v21
    v_exp_f32 v79, v79
    s_waitcnt lgkmcnt(0)
    v_smfmac_f32_32x32x32_bf16 v[92:107], v[44:47], v[52:59], v10
    v_sub_f32 v80, v80, v21
    v_exp_f32 v80, v80
    v_sub_f32 v81, v81, v21
    v_exp_f32 v81, v81
    v_sub_f32 v82, v82, v21
    v_exp_f32 v82, v82
    v_sub_f32 v83, v83, v21
    v_exp_f32 v83, v83
    v_smfmac_f32_16x16x64_bf16 v[12:15], v[6:9], v[52:59], v11
    s_add_u32 m0, s69, 139264
    s_add_u32 s75, s87, 704704
    buffer_load_dwordx4 v3, s[48:51], s75 offen lds
    v_sub_f32 v84, v84, v21
    v_exp_f32 v84, v84
    v_sub_f32 v85, v85, v21
    v_exp_f32 v85, v85
    v_perm_b32 v52, v77, v76, s98
    v_perm_b32 v53, v79, v78, s98
    v_perm_b32 v54, v81, v80, s98
    v_perm_b32 v55, v83, v82, s98
    v_sub_f32 v86, v86, v21
    v_exp_f32 v86, v86
    v_sub_f32 v87, v87, v21
    v_exp_f32 v87, v87
    v_perm_b32 v56, v85, v84, s98
    v_sub_f32 v88, v88, v21
    v_exp_f32 v88, v88
    v_sub_f32 v89, v89, v21
    v_exp_f32 v89, v89
    v_perm_b32 v57, v87, v86, s98
    v_sub_f32 v90, v90, v21
    v_exp_f32 v90, v90
    v_sub_f32 v91, v91, v21
    v_exp_f32 v91, v91
    v_perm_b32 v58, v89, v88, s98
    v_perm_b32 v59, v91, v90, s98
    s_setprio 2
    v_mfma_f32_32x32x16_bf16 v[76:91], v[40:43], v[36:39], 0
    ds_read_b128 v[40:43], v124 offset:4096
    v_sub_f32 v60, v60, v20
    v_exp_f32 v60, v60
    v_sub_f32 v61, v61, v20
    v_exp_f32 v61, v61
    v_sub_f32 v62, v62, v20
    v_exp_f32 v62, v62
    v_sub_f32 v63, v63, v20
    v_exp_f32 v63, v63
    v_smfmac_f32_32x32x32_bf16 v[108:123], v[44:47], v[52:59], v10
    ds_read_b128 v[44:47], v124 offset:3072
    v_sub_f32 v64, v64, v20
    v_exp_f32 v64, v64
    v_sub_f32 v65, v65, v20
    v_exp_f32 v65, v65
    v_sub_f32 v66, v66, v20
    v_exp_f32 v66, v66
    v_sub_f32 v67, v67, v20
    v_exp_f32 v67, v67
    v_smfmac_f32_16x16x64_bf16 v[16:19], v[6:9], v[52:59], v11
    s_add_u32 m0, s69, 147456
    s_add_u32 s75, s87, 704768
    buffer_load_dwordx4 v3, s[48:51], s75 offen lds
    v_sub_f32 v68, v68, v20
    v_exp_f32 v68, v68
    v_sub_f32 v69, v69, v20
    v_exp_f32 v69, v69
    v_perm_b32 v52, v61, v60, s98
    v_perm_b32 v53, v63, v62, s98
    v_perm_b32 v54, v65, v64, s98
    v_perm_b32 v55, v67, v66, s98
    v_sub_f32 v70, v70, v20
    v_exp_f32 v70, v70
    v_sub_f32 v71, v71, v20
    v_exp_f32 v71, v71
    v_perm_b32 v56, v69, v68, s98
    v_sub_f32 v72, v72, v20
    v_exp_f32 v72, v72
    v_sub_f32 v73, v73, v20
    v_exp_f32 v73, v73
    v_perm_b32 v57, v71, v70, s98
    v_sub_f32 v74, v74, v20
    v_exp_f32 v74, v74
    v_sub_f32 v75, v75, v20
    v_exp_f32 v75, v75
    v_perm_b32 v58, v73, v72, s98
    v_perm_b32 v59, v75, v74, s98
    s_waitcnt lgkmcnt(1)
    v_mfma_f32_32x32x16_bf16 v[60:75], v[40:43], v[32:35], 0
    v_sub_f32 v76, v76, v21
    v_exp_f32 v76, v76
    v_sub_f32 v77, v77, v21
    v_exp_f32 v77, v77
    v_sub_f32 v78, v78, v21
    v_exp_f32 v78, v78
    v_sub_f32 v79, v79, v21
    v_exp_f32 v79, v79
    s_waitcnt lgkmcnt(0)
    v_smfmac_f32_32x32x32_bf16 v[92:107], v[44:47], v[52:59], v10
    v_sub_f32 v80, v80, v21
    v_exp_f32 v80, v80
    v_sub_f32 v81, v81, v21
    v_exp_f32 v81, v81
    v_sub_f32 v82, v82, v21
    v_exp_f32 v82, v82
    v_sub_f32 v83, v83, v21
    v_exp_f32 v83, v83
    v_smfmac_f32_16x16x64_bf16 v[12:15], v[6:9], v[52:59], v11
    s_add_u32 m0, s69, 155648
    s_add_u32 s75, s87, 704832
    buffer_load_dwordx4 v3, s[48:51], s75 offen lds
    v_sub_f32 v84, v84, v21
    v_exp_f32 v84, v84
    v_sub_f32 v85, v85, v21
    v_exp_f32 v85, v85
    v_perm_b32 v52, v77, v76, s98
    v_perm_b32 v53, v79, v78, s98
    v_perm_b32 v54, v81, v80, s98
    v_perm_b32 v55, v83, v82, s98
    v_sub_f32 v86, v86, v21
    v_exp_f32 v86, v86
    v_sub_f32 v87, v87, v21
    v_exp_f32 v87, v87
    v_perm_b32 v56, v85, v84, s98
    v_sub_f32 v88, v88, v21
    v_exp_f32 v88, v88
    v_sub_f32 v89, v89, v21
    v_exp_f32 v89, v89
    v_perm_b32 v57, v87, v86, s98
    v_sub_f32 v90, v90, v21
    v_exp_f32 v90, v90
    v_sub_f32 v91, v91, v21
    v_exp_f32 v91, v91
    v_perm_b32 v58, v89, v88, s98
    v_perm_b32 v59, v91, v90, s98
    v_mfma_f32_32x32x16_bf16 v[76:91], v[40:43], v[36:39], 0
    ds_read_b128 v[40:43], v124 offset:6144
    v_sub_f32 v60, v60, v20
    v_exp_f32 v60, v60
    v_sub_f32 v61, v61, v20
    v_exp_f32 v61, v61
    v_sub_f32 v62, v62, v20
    v_exp_f32 v62, v62
    v_sub_f32 v63, v63, v20
    v_exp_f32 v63, v63
    v_smfmac_f32_32x32x32_bf16 v[108:123], v[44:47], v[52:59], v10
    ds_read_b128 v[44:47], v124 offset:5120
    v_sub_f32 v64, v64, v20
    v_exp_f32 v64, v64
    v_sub_f32 v65, v65, v20
    v_exp_f32 v65, v65
    v_sub_f32 v66, v66, v20
    v_exp_f32 v66, v66
    v_sub_f32 v67, v67, v20
    v_exp_f32 v67, v67
    v_smfmac_f32_16x16x64_bf16 v[16:19], v[6:9], v[52:59], v11
    s_add_u32 m0, s69, 49152
    s_add_u32 s75, s87, 1056768
    buffer_load_dwordx4 v3, s[48:51], s75 offen lds
    v_sub_f32 v68, v68, v20
    v_exp_f32 v68, v68
    v_sub_f32 v69, v69, v20
    v_exp_f32 v69, v69
    v_perm_b32 v52, v61, v60, s98
    v_perm_b32 v53, v63, v62, s98
    v_perm_b32 v54, v65, v64, s98
    v_perm_b32 v55, v67, v66, s98
    v_sub_f32 v70, v70, v20
    v_exp_f32 v70, v70
    v_sub_f32 v71, v71, v20
    v_exp_f32 v71, v71
    v_perm_b32 v56, v69, v68, s98
    v_sub_f32 v72, v72, v20
    v_exp_f32 v72, v72
    v_sub_f32 v73, v73, v20
    v_exp_f32 v73, v73
    v_perm_b32 v57, v71, v70, s98
    v_sub_f32 v74, v74, v20
    v_exp_f32 v74, v74
    v_sub_f32 v75, v75, v20
    v_exp_f32 v75, v75
    v_perm_b32 v58, v73, v72, s98
    v_perm_b32 v59, v75, v74, s98
    s_waitcnt lgkmcnt(1)
    v_mfma_f32_32x32x16_bf16 v[60:75], v[40:43], v[32:35], 0
    v_sub_f32 v76, v76, v21
    v_exp_f32 v76, v76
    v_sub_f32 v77, v77, v21
    v_exp_f32 v77, v77
    v_sub_f32 v78, v78, v21
    v_exp_f32 v78, v78
    v_sub_f32 v79, v79, v21
    v_exp_f32 v79, v79
    s_waitcnt lgkmcnt(0)
    v_smfmac_f32_32x32x32_bf16 v[92:107], v[44:47], v[52:59], v10
    v_sub_f32 v80, v80, v21
    v_exp_f32 v80, v80
    v_sub_f32 v81, v81, v21
    v_exp_f32 v81, v81
    v_sub_f32 v82, v82, v21
    v_exp_f32 v82, v82
    v_sub_f32 v83, v83, v21
    v_exp_f32 v83, v83
    v_smfmac_f32_16x16x64_bf16 v[12:15], v[6:9], v[52:59], v11
    s_add_u32 m0, s69, 57344
    s_add_u32 s75, s87, 1056832
    buffer_load_dwordx4 v3, s[48:51], s75 offen lds
    v_sub_f32 v84, v84, v21
    v_exp_f32 v84, v84
    v_sub_f32 v85, v85, v21
    v_exp_f32 v85, v85
    v_perm_b32 v52, v77, v76, s98
    v_perm_b32 v53, v79, v78, s98
    v_perm_b32 v54, v81, v80, s98
    v_perm_b32 v55, v83, v82, s98
    v_sub_f32 v86, v86, v21
    v_exp_f32 v86, v86
    v_sub_f32 v87, v87, v21
    v_exp_f32 v87, v87
    v_perm_b32 v56, v85, v84, s98
    v_sub_f32 v88, v88, v21
    v_exp_f32 v88, v88
    v_sub_f32 v89, v89, v21
    v_exp_f32 v89, v89
    v_perm_b32 v57, v87, v86, s98
    v_sub_f32 v90, v90, v21
    v_exp_f32 v90, v90
    v_sub_f32 v91, v91, v21
    v_exp_f32 v91, v91
    v_perm_b32 v58, v89, v88, s98
    v_perm_b32 v59, v91, v90, s98
    s_setprio 1
    v_mfma_f32_32x32x16_bf16 v[76:91], v[40:43], v[36:39], 0
    ds_read_b128 v[40:43], v124 offset:8192
    v_sub_f32 v60, v60, v20
    v_exp_f32 v60, v60
    v_sub_f32 v61, v61, v20
    v_exp_f32 v61, v61
    v_sub_f32 v62, v62, v20
    v_exp_f32 v62, v62
    v_sub_f32 v63, v63, v20
    v_exp_f32 v63, v63
    v_smfmac_f32_32x32x32_bf16 v[108:123], v[44:47], v[52:59], v10
    ds_read_b128 v[44:47], v124 offset:7168
    v_sub_f32 v64, v64, v20
    v_exp_f32 v64, v64
    v_sub_f32 v65, v65, v20
    v_exp_f32 v65, v65
    v_sub_f32 v66, v66, v20
    v_exp_f32 v66, v66
    v_sub_f32 v67, v67, v20
    v_exp_f32 v67, v67
    v_smfmac_f32_16x16x64_bf16 v[16:19], v[6:9], v[52:59], v11
    v_sub_f32 v68, v68, v20
    v_exp_f32 v68, v68
    v_sub_f32 v69, v69, v20
    v_exp_f32 v69, v69
    v_perm_b32 v52, v61, v60, s98
    v_perm_b32 v53, v63, v62, s98
    v_perm_b32 v54, v65, v64, s98
    v_perm_b32 v55, v67, v66, s98
    v_sub_f32 v70, v70, v20
    v_exp_f32 v70, v70
    v_sub_f32 v71, v71, v20
    v_exp_f32 v71, v71
    v_perm_b32 v56, v69, v68, s98
    v_sub_f32 v72, v72, v20
    v_exp_f32 v72, v72
    v_sub_f32 v73, v73, v20
    v_exp_f32 v73, v73
    v_perm_b32 v57, v71, v70, s98
    v_sub_f32 v74, v74, v20
    v_exp_f32 v74, v74
    v_sub_f32 v75, v75, v20
    v_exp_f32 v75, v75
    v_perm_b32 v58, v73, v72, s98
    v_perm_b32 v59, v75, v74, s98
    s_waitcnt lgkmcnt(1)
    v_mfma_f32_32x32x16_bf16 v[60:75], v[40:43], v[32:35], 0
    v_sub_f32 v76, v76, v21
    v_exp_f32 v76, v76
    v_sub_f32 v77, v77, v21
    v_exp_f32 v77, v77
    v_sub_f32 v78, v78, v21
    v_exp_f32 v78, v78
    v_sub_f32 v79, v79, v21
    v_exp_f32 v79, v79
    s_waitcnt lgkmcnt(0)
    v_smfmac_f32_32x32x32_bf16 v[92:107], v[44:47], v[52:59], v10
    v_sub_f32 v80, v80, v21
    v_exp_f32 v80, v80
    v_sub_f32 v81, v81, v21
    v_exp_f32 v81, v81
    v_sub_f32 v82, v82, v21
    v_exp_f32 v82, v82
    v_sub_f32 v83, v83, v21
    v_exp_f32 v83, v83
    v_smfmac_f32_16x16x64_bf16 v[12:15], v[6:9], v[52:59], v11
    v_sub_f32 v84, v84, v21
    v_exp_f32 v84, v84
    v_sub_f32 v85, v85, v21
    v_exp_f32 v85, v85
    v_perm_b32 v52, v77, v76, s98
    v_perm_b32 v53, v79, v78, s98
    v_perm_b32 v54, v81, v80, s98
    v_perm_b32 v55, v83, v82, s98
    v_sub_f32 v86, v86, v21
    v_exp_f32 v86, v86
    v_sub_f32 v87, v87, v21
    v_exp_f32 v87, v87
    v_perm_b32 v56, v85, v84, s98
    v_sub_f32 v88, v88, v21
    v_exp_f32 v88, v88
    v_sub_f32 v89, v89, v21
    v_exp_f32 v89, v89
    v_perm_b32 v57, v87, v86, s98
    v_sub_f32 v90, v90, v21
    v_exp_f32 v90, v90
    v_sub_f32 v91, v91, v21
    v_exp_f32 v91, v91
    v_perm_b32 v58, v89, v88, s98
    v_perm_b32 v59, v91, v90, s98
    v_mfma_f32_32x32x16_bf16 v[76:91], v[40:43], v[36:39], 0
    ds_read_b128 v[40:43], v124 offset:10240
    v_sub_f32 v60, v60, v20
    v_exp_f32 v60, v60
    v_sub_f32 v61, v61, v20
    v_exp_f32 v61, v61
    v_sub_f32 v62, v62, v20
    v_exp_f32 v62, v62
    v_sub_f32 v63, v63, v20
    v_exp_f32 v63, v63
    v_smfmac_f32_32x32x32_bf16 v[108:123], v[44:47], v[52:59], v10
    ds_read_b128 v[44:47], v124 offset:9216
    v_sub_f32 v64, v64, v20
    v_exp_f32 v64, v64
    v_sub_f32 v65, v65, v20
    v_exp_f32 v65, v65
    v_sub_f32 v66, v66, v20
    v_exp_f32 v66, v66
    v_sub_f32 v67, v67, v20
    v_exp_f32 v67, v67
    v_smfmac_f32_16x16x64_bf16 v[16:19], v[6:9], v[52:59], v11
    v_sub_f32 v68, v68, v20
    v_exp_f32 v68, v68
    v_sub_f32 v69, v69, v20
    v_exp_f32 v69, v69
    v_perm_b32 v52, v61, v60, s98
    v_perm_b32 v53, v63, v62, s98
    v_perm_b32 v54, v65, v64, s98
    v_perm_b32 v55, v67, v66, s98
    v_sub_f32 v70, v70, v20
    v_exp_f32 v70, v70
    v_sub_f32 v71, v71, v20
    v_exp_f32 v71, v71
    v_perm_b32 v56, v69, v68, s98
    v_sub_f32 v72, v72, v20
    v_exp_f32 v72, v72
    v_sub_f32 v73, v73, v20
    v_exp_f32 v73, v73
    v_perm_b32 v57, v71, v70, s98
    v_sub_f32 v74, v74, v20
    v_exp_f32 v74, v74
    v_sub_f32 v75, v75, v20
    v_exp_f32 v75, v75
    v_perm_b32 v58, v73, v72, s98
    v_perm_b32 v59, v75, v74, s98
    s_waitcnt lgkmcnt(1)
    v_mfma_f32_32x32x16_bf16 v[60:75], v[40:43], v[32:35], 0
    v_sub_f32 v76, v76, v21
    v_exp_f32 v76, v76
    v_sub_f32 v77, v77, v21
    v_exp_f32 v77, v77
    v_sub_f32 v78, v78, v21
    v_exp_f32 v78, v78
    v_sub_f32 v79, v79, v21
    v_exp_f32 v79, v79
    s_waitcnt lgkmcnt(0)
    v_smfmac_f32_32x32x32_bf16 v[92:107], v[44:47], v[52:59], v10
    v_sub_f32 v80, v80, v21
    v_exp_f32 v80, v80
    v_sub_f32 v81, v81, v21
    v_exp_f32 v81, v81
    v_sub_f32 v82, v82, v21
    v_exp_f32 v82, v82
    v_sub_f32 v83, v83, v21
    v_exp_f32 v83, v83
    v_smfmac_f32_16x16x64_bf16 v[12:15], v[6:9], v[52:59], v11
    v_sub_f32 v84, v84, v21
    v_exp_f32 v84, v84
    v_sub_f32 v85, v85, v21
    v_exp_f32 v85, v85
    v_perm_b32 v52, v77, v76, s98
    v_perm_b32 v53, v79, v78, s98
    v_perm_b32 v54, v81, v80, s98
    v_perm_b32 v55, v83, v82, s98
    v_sub_f32 v86, v86, v21
    v_exp_f32 v86, v86
    v_sub_f32 v87, v87, v21
    v_exp_f32 v87, v87
    v_perm_b32 v56, v85, v84, s98
    v_sub_f32 v88, v88, v21
    v_exp_f32 v88, v88
    v_sub_f32 v89, v89, v21
    v_exp_f32 v89, v89
    v_perm_b32 v57, v87, v86, s98
    v_sub_f32 v90, v90, v21
    v_exp_f32 v90, v90
    v_sub_f32 v91, v91, v21
    v_exp_f32 v91, v91
    v_perm_b32 v58, v89, v88, s98
    v_perm_b32 v59, v91, v90, s98
    s_setprio 0
    v_mfma_f32_32x32x16_bf16 v[76:91], v[40:43], v[36:39], 0
    ds_read_b128 v[40:43], v124 offset:12288
    v_sub_f32 v60, v60, v20
    v_exp_f32 v60, v60
    v_sub_f32 v61, v61, v20
    v_exp_f32 v61, v61
    v_sub_f32 v62, v62, v20
    v_exp_f32 v62, v62
    v_sub_f32 v63, v63, v20
    v_exp_f32 v63, v63
    v_smfmac_f32_32x32x32_bf16 v[108:123], v[44:47], v[52:59], v10
    ds_read_b128 v[44:47], v124 offset:11264
    v_sub_f32 v64, v64, v20
    v_exp_f32 v64, v64
    v_sub_f32 v65, v65, v20
    v_exp_f32 v65, v65
    v_sub_f32 v66, v66, v20
    v_exp_f32 v66, v66
    v_sub_f32 v67, v67, v20
    v_exp_f32 v67, v67
    v_smfmac_f32_16x16x64_bf16 v[16:19], v[6:9], v[52:59], v11
    v_sub_f32 v68, v68, v20
    v_exp_f32 v68, v68
    v_sub_f32 v69, v69, v20
    v_exp_f32 v69, v69
    v_perm_b32 v52, v61, v60, s98
    v_perm_b32 v53, v63, v62, s98
    v_perm_b32 v54, v65, v64, s98
    v_perm_b32 v55, v67, v66, s98
    v_sub_f32 v70, v70, v20
    v_exp_f32 v70, v70
    v_sub_f32 v71, v71, v20
    v_exp_f32 v71, v71
    v_perm_b32 v56, v69, v68, s98
    v_sub_f32 v72, v72, v20
    v_exp_f32 v72, v72
    v_sub_f32 v73, v73, v20
    v_exp_f32 v73, v73
    v_perm_b32 v57, v71, v70, s98
    v_sub_f32 v74, v74, v20
    v_exp_f32 v74, v74
    v_sub_f32 v75, v75, v20
    v_exp_f32 v75, v75
    v_perm_b32 v58, v73, v72, s98
    v_perm_b32 v59, v75, v74, s98
    s_waitcnt lgkmcnt(1)
    v_mfma_f32_32x32x16_bf16 v[60:75], v[40:43], v[32:35], 0
    v_sub_f32 v76, v76, v21
    v_exp_f32 v76, v76
    v_sub_f32 v77, v77, v21
    v_exp_f32 v77, v77
    v_sub_f32 v78, v78, v21
    v_exp_f32 v78, v78
    v_sub_f32 v79, v79, v21
    v_exp_f32 v79, v79
    s_waitcnt lgkmcnt(0)
    v_smfmac_f32_32x32x32_bf16 v[92:107], v[44:47], v[52:59], v10
    v_sub_f32 v80, v80, v21
    v_exp_f32 v80, v80
    v_sub_f32 v81, v81, v21
    v_exp_f32 v81, v81
    v_sub_f32 v82, v82, v21
    v_exp_f32 v82, v82
    v_sub_f32 v83, v83, v21
    v_exp_f32 v83, v83
    v_smfmac_f32_16x16x64_bf16 v[12:15], v[6:9], v[52:59], v11
    v_sub_f32 v84, v84, v21
    v_exp_f32 v84, v84
    v_sub_f32 v85, v85, v21
    v_exp_f32 v85, v85
    v_perm_b32 v52, v77, v76, s98
    v_perm_b32 v53, v79, v78, s98
    v_perm_b32 v54, v81, v80, s98
    v_perm_b32 v55, v83, v82, s98
    v_sub_f32 v86, v86, v21
    v_exp_f32 v86, v86
    v_sub_f32 v87, v87, v21
    v_exp_f32 v87, v87
    v_perm_b32 v56, v85, v84, s98
    v_sub_f32 v88, v88, v21
    v_exp_f32 v88, v88
    v_sub_f32 v89, v89, v21
    v_exp_f32 v89, v89
    v_perm_b32 v57, v87, v86, s98
    v_sub_f32 v90, v90, v21
    v_exp_f32 v90, v90
    v_sub_f32 v91, v91, v21
    v_exp_f32 v91, v91
    v_perm_b32 v58, v89, v88, s98
    v_perm_b32 v59, v91, v90, s98
    v_mfma_f32_32x32x16_bf16 v[76:91], v[40:43], v[36:39], 0
    ds_read_b128 v[40:43], v124 offset:14336
    v_sub_f32 v60, v60, v20
    v_exp_f32 v60, v60
    v_sub_f32 v61, v61, v20
    v_exp_f32 v61, v61
    v_sub_f32 v62, v62, v20
    v_exp_f32 v62, v62
    v_sub_f32 v63, v63, v20
    v_exp_f32 v63, v63
    v_smfmac_f32_32x32x32_bf16 v[108:123], v[44:47], v[52:59], v10
    ds_read_b128 v[44:47], v124 offset:13312
    v_sub_f32 v64, v64, v20
    v_exp_f32 v64, v64
    v_sub_f32 v65, v65, v20
    v_exp_f32 v65, v65
    v_sub_f32 v66, v66, v20
    v_exp_f32 v66, v66
    v_sub_f32 v67, v67, v20
    v_exp_f32 v67, v67
    v_smfmac_f32_16x16x64_bf16 v[16:19], v[6:9], v[52:59], v11
    v_sub_f32 v68, v68, v20
    v_exp_f32 v68, v68
    v_sub_f32 v69, v69, v20
    v_exp_f32 v69, v69
    v_perm_b32 v52, v61, v60, s98
    v_perm_b32 v53, v63, v62, s98
    v_perm_b32 v54, v65, v64, s98
    v_perm_b32 v55, v67, v66, s98
    v_sub_f32 v70, v70, v20
    v_exp_f32 v70, v70
    v_sub_f32 v71, v71, v20
    v_exp_f32 v71, v71
    v_perm_b32 v56, v69, v68, s98
    v_sub_f32 v72, v72, v20
    v_exp_f32 v72, v72
    v_sub_f32 v73, v73, v20
    v_exp_f32 v73, v73
    v_perm_b32 v57, v71, v70, s98
    v_sub_f32 v74, v74, v20
    v_exp_f32 v74, v74
    v_sub_f32 v75, v75, v20
    v_exp_f32 v75, v75
    v_perm_b32 v58, v73, v72, s98
    v_perm_b32 v59, v75, v74, s98
    s_waitcnt lgkmcnt(1)
    v_mfma_f32_32x32x16_bf16 v[60:75], v[40:43], v[32:35], 0
    v_sub_f32 v76, v76, v21
    v_exp_f32 v76, v76
    v_sub_f32 v77, v77, v21
    v_exp_f32 v77, v77
    v_sub_f32 v78, v78, v21
    v_exp_f32 v78, v78
    v_sub_f32 v79, v79, v21
    v_exp_f32 v79, v79
    s_waitcnt lgkmcnt(0)
    v_smfmac_f32_32x32x32_bf16 v[92:107], v[44:47], v[52:59], v10
    v_sub_f32 v80, v80, v21
    v_exp_f32 v80, v80
    v_sub_f32 v81, v81, v21
    v_exp_f32 v81, v81
    v_sub_f32 v82, v82, v21
    v_exp_f32 v82, v82
    v_sub_f32 v83, v83, v21
    v_exp_f32 v83, v83
    v_smfmac_f32_16x16x64_bf16 v[12:15], v[6:9], v[52:59], v11
    v_sub_f32 v84, v84, v21
    v_exp_f32 v84, v84
    v_sub_f32 v85, v85, v21
    v_exp_f32 v85, v85
    v_perm_b32 v52, v77, v76, s98
    v_perm_b32 v53, v79, v78, s98
    v_perm_b32 v54, v81, v80, s98
    v_perm_b32 v55, v83, v82, s98
    v_sub_f32 v86, v86, v21
    v_exp_f32 v86, v86
    v_sub_f32 v87, v87, v21
    v_exp_f32 v87, v87
    v_perm_b32 v56, v85, v84, s98
    v_sub_f32 v88, v88, v21
    v_exp_f32 v88, v88
    v_sub_f32 v89, v89, v21
    v_exp_f32 v89, v89
    v_perm_b32 v57, v87, v86, s98
    v_sub_f32 v90, v90, v21
    v_exp_f32 v90, v90
    v_sub_f32 v91, v91, v21
    v_exp_f32 v91, v91
    v_perm_b32 v58, v89, v88, s98
    v_perm_b32 v59, v91, v90, s98
    v_mfma_f32_32x32x16_bf16 v[76:91], v[40:43], v[36:39], 0
    v_sub_f32 v60, v60, v20
    v_exp_f32 v60, v60
    v_sub_f32 v61, v61, v20
    v_exp_f32 v61, v61
    v_sub_f32 v62, v62, v20
    v_exp_f32 v62, v62
    v_sub_f32 v63, v63, v20
    v_exp_f32 v63, v63
    v_smfmac_f32_32x32x32_bf16 v[108:123], v[44:47], v[52:59], v10
    ds_read_b128 v[44:47], v124 offset:15360
    v_sub_f32 v64, v64, v20
    v_exp_f32 v64, v64
    v_sub_f32 v65, v65, v20
    v_exp_f32 v65, v65
    v_sub_f32 v66, v66, v20
    v_exp_f32 v66, v66
    v_sub_f32 v67, v67, v20
    v_exp_f32 v67, v67
    v_smfmac_f32_16x16x64_bf16 v[16:19], v[6:9], v[52:59], v11
    v_sub_f32 v68, v68, v20
    v_exp_f32 v68, v68
    v_sub_f32 v69, v69, v20
    v_exp_f32 v69, v69
    v_perm_b32 v52, v61, v60, s98
    v_perm_b32 v53, v63, v62, s98
    v_perm_b32 v54, v65, v64, s98
    v_perm_b32 v55, v67, v66, s98
    v_sub_f32 v70, v70, v20
    v_exp_f32 v70, v70
    v_sub_f32 v71, v71, v20
    v_exp_f32 v71, v71
    v_perm_b32 v56, v69, v68, s98
    v_sub_f32 v72, v72, v20
    v_exp_f32 v72, v72
    v_sub_f32 v73, v73, v20
    v_exp_f32 v73, v73
    v_perm_b32 v57, v71, v70, s98
    v_sub_f32 v74, v74, v20
    v_exp_f32 v74, v74
    v_sub_f32 v75, v75, v20
    v_exp_f32 v75, v75
    v_perm_b32 v58, v73, v72, s98
    v_perm_b32 v59, v75, v74, s98
    v_sub_f32 v76, v76, v21
    v_exp_f32 v76, v76
    v_sub_f32 v77, v77, v21
    v_exp_f32 v77, v77
    v_sub_f32 v78, v78, v21
    v_exp_f32 v78, v78
    v_sub_f32 v79, v79, v21
    v_exp_f32 v79, v79
    s_waitcnt lgkmcnt(0)
    v_smfmac_f32_32x32x32_bf16 v[92:107], v[44:47], v[52:59], v10
    v_sub_f32 v80, v80, v21
    v_exp_f32 v80, v80
    v_sub_f32 v81, v81, v21
    v_exp_f32 v81, v81
    v_sub_f32 v82, v82, v21
    v_exp_f32 v82, v82
    v_sub_f32 v83, v83, v21
    v_exp_f32 v83, v83
    v_smfmac_f32_16x16x64_bf16 v[12:15], v[6:9], v[52:59], v11
    v_sub_f32 v84, v84, v21
    v_exp_f32 v84, v84
    v_sub_f32 v85, v85, v21
    v_exp_f32 v85, v85
    v_perm_b32 v52, v77, v76, s98
    v_perm_b32 v53, v79, v78, s98
    v_perm_b32 v54, v81, v80, s98
    v_perm_b32 v55, v83, v82, s98
    v_sub_f32 v86, v86, v21
    v_exp_f32 v86, v86
    v_sub_f32 v87, v87, v21
    v_exp_f32 v87, v87
    v_perm_b32 v56, v85, v84, s98
    v_sub_f32 v88, v88, v21
    v_exp_f32 v88, v88
    v_sub_f32 v89, v89, v21
    v_exp_f32 v89, v89
    v_perm_b32 v57, v87, v86, s98
    v_sub_f32 v90, v90, v21
    v_exp_f32 v90, v90
    v_sub_f32 v91, v91, v21
    v_exp_f32 v91, v91
    v_perm_b32 v58, v89, v88, s98
    v_perm_b32 v59, v91, v90, s98
    s_setprio 0
    s_nop 1
    v_smfmac_f32_32x32x32_bf16 v[108:123], v[44:47], v[52:59], v10
    v_smfmac_f32_16x16x64_bf16 v[16:19], v[6:9], v[52:59], v11
    s_branch L_attdone
.section .rodata,"a"
.p2align 6
.amdhsa_kernel sequential_preLN__grouped_kv_mqa__dense_activation_squared_relu__prompt_kernel
  .amdhsa_next_free_vgpr 256
  .amdhsa_next_free_sgpr 100
  .amdhsa_accum_offset 256
  .amdhsa_group_segment_fixed_size 0
  .amdhsa_kernarg_size 104
  .amdhsa_user_sgpr_count 2
  .amdhsa_user_sgpr_kernarg_segment_ptr 1
  .amdhsa_system_sgpr_workgroup_id_x 1
.end_amdhsa_kernel
```
